```python
import torch

def _softmax(x, axis=-1):
    return torch.softmax(x, dim=axis)
def _gelu(x):
    return torch.nn.functional.gelu(x, approximate="tanh")
def _silu(x):
    return torch.nn.functional.silu(x)
def _sigmoid(x):
    return torch.sigmoid(x)
def _layernorm(x, axis=-1, eps=1e-5):
    m = x.mean(dim=axis, keepdim=True)
    v = x.var(dim=axis, keepdim=True, unbiased=False)
    return (x - m) / torch.sqrt(v + eps)
def _scatter_add(tgt, idx, src, axis=0):
    return tgt.clone().index_add_(axis, idx, src)
def _segment_sum(src, seg, n):
    out = torch.zeros((n,) + src.shape[1:], dtype=src.dtype)
    return out.index_add_(0, seg, src)
def _pad(x, pw):
    flat = tuple(v for pair in reversed(pw) for v in pair)
    return torch.nn.functional.pad(x, flat)

kernel_name = 'interleave_layers__linear_attn_block__sliding_block__prompt'

def setup_inputs():

    _w = (lambda a: (lambda t: t.to(torch.bfloat16) if t.is_floating_point() else t)(torch.as_tensor(a)))
    def _A_setup():
        B, S, D = 1, 2048, 576
        return {
            "x": _w((lambda *s: torch.randn(*s, dtype=torch.bfloat16) * 0.05)(B, S, D)),
            "wqkv": _w((lambda *s: torch.randn(*s, dtype=torch.bfloat16) * 0.05)(D, 3 * D)),
            "wo": _w((lambda *s: torch.randn(*s, dtype=torch.bfloat16) * 0.05)(D, D)),
        }
    _A_in = _A_setup()

    def _B_setup():
        B, S, D = 1, 2048, 576
        return {
            "x": _w((lambda *s: torch.randn(*s, dtype=torch.bfloat16) * 0.05)(B, S, D)),
            "wqkv": _w((lambda *s: torch.randn(*s, dtype=torch.bfloat16) * 0.1)(D, 3 * D)),
            "wo": _w((lambda *s: torch.randn(*s, dtype=torch.bfloat16) * 0.05)(D, D)),
        }
    _B_in = _B_setup()

    return {
        "A_x": _A_in["x"],
        "A_wqkv": _A_in["wqkv"],
        "A_wo": _A_in["wo"],
        "B_x": _B_in["x"],
        "B_wqkv": _B_in["wqkv"],
        "B_wo": _B_in["wo"],
    }

def reference(A_x, A_wqkv, A_wo, B_x, B_wqkv, B_wo):
    def _A_ref(x, wqkv, wo):
        B, S, D = x.shape
        H = 32; Dh = D // H
        qkv = (lambda x, *d: x.permute(*d))((x @ wqkv).reshape(B, S, 3, H, Dh), 2, 0, 3, 1, 4)
        q, k, v = qkv[0], qkv[1], qkv[2]
        phi = lambda t: torch.where(t > 0, t + 1, torch.exp(t)) + 1e-6
        pq, pk = phi(q), phi(k)
        kv = torch.einsum("bhsd,bhse->bhde", pk, v)
        z = torch.einsum("bhsd->bhd", pk)
        num = torch.einsum("bhqd,bhde->bhqe", pq, kv)
        den = torch.einsum("bhqd,bhd->bhq", pq, z)[..., None] + 1e-6
        o = num / den
        return (lambda x, *d: x.permute(*d))(o, 0, 2, 1, 3).reshape(B, S, D) @ wo

    def _B_ref(x, wqkv, wo):
        B, S, D = x.shape
        H = 32; Dh = D // H; W = 256
        qkv = (lambda x, *d: x.permute(*d))((x @ wqkv).reshape(B, S, 3, H, Dh), 2, 0, 3, 1, 4)
        q, k, v = qkv[0], qkv[1], qkv[2]
        scores = torch.einsum("bhqd,bhkd->bhqk", q, k) * (Dh ** -0.5)
        idx = torch.arange(S)
        mask = (idx[:, None] - idx[None, :] >= 0) & (idx[:, None] - idx[None, :] < W)
        scores = torch.where(mask[None, None], scores, -1e9)
        p = _softmax(scores, axis=-1)
        o = torch.einsum("bhqk,bhkd->bhqd", p, v)
        return (lambda x, *d: x.permute(*d))(o, 0, 2, 1, 3).reshape(B, S, D) @ wo

    x = A_x
    x = x + _A_ref(_layernorm(x, axis=-1), A_wqkv, A_wo)
    x = x + _B_ref(_layernorm(x, axis=-1), B_wqkv, B_wo)
    x = x + _A_ref(_layernorm(x, axis=-1), A_wqkv, A_wo)
    x = x + _B_ref(_layernorm(x, axis=-1), B_wqkv, B_wo)
    return x
```

```asm
; @launch grid=(256,1,1) block=(256,1,1) lds=163840
.amdgcn_target "amdgcn-amd-amdhsa--gfx950"
.text

.globl interleave_layers__linear_attn_block__sliding_block__prompt_kernel
.p2align 8
.type interleave_layers__linear_attn_block__sliding_block__prompt_kernel,@function
interleave_layers__linear_attn_block__sliding_block__prompt_kernel:
    s_cmp_ge_u32 s2, 256
    s_cbranch_scc1 L_end
    s_load_dwordx16 s[80:95], s[0:1], 0
    s_load_dwordx2 s[32:33], s[0:1], 64
    s_getpc_b64 s[22:23]
    v_lshlrev_b32 v24, 5, v0
    v_lshrrev_b32 v27, 6, v0
    global_load_dword v42, v24, s[22:23]
    v_readfirstlane_b32 s38, v27
    v_and_b32 v0, 63, v0
    s_lshr_b32 s59, s2, 3
    s_and_b32 s37, s59, 15
    s_and_b32 s56, s2, 7
    s_lshr_b32 s57, s59, 4
    s_lshl1_add_u32 s36, s56, s57
    v_mul_u32_u24 v34, 6554, v0
    v_lshlrev_b32 v1, 4, v0
    v_lshrrev_b32 v34, 16, v34
    s_mul_i32 s60, s37, 72
    s_and_b32 s60, s60, -16
    v_mul_u32_u24 v36, 3296, v34
    v_add3_u32 v36, v36, v1, s60
    s_mov_b32 vcc_lo, 0x3e0f83e0
    s_mov_b32 vcc_hi, 0x0f83e0f8
    v_add_u32 v2, 1152, v36
    v_add_u32 v3, 2224, v36
    v_cndmask_b32 v2, v2, v3, vcc
    v_mov_b32 v35, 268435456
    v_cndmask_b32 v3, v36, v35, vcc
    s_cmp_eq_u32 s38, 3
    s_cselect_b32 s64, 268435456, 0
    v_or_b32 v7, s64, v2
    v_or_b32 v8, s64, v3
    s_cmp_eq_u32 s57, 0
    s_cselect_b32 s66, s64, 0
    v_or_b32 v2, s66, v2
    v_or_b32 v3, s66, v3
    s_lshl_b32 s61, s36, 5
    s_lshl3_add_u32 s60, s56, s61
    s_mul_i32 s65, s38, 12
    s_add_u32 s60, s60, s65
    s_mul_i32 s97, s60, 3456
    s_add_u32 s98, s97, 19776
    s_mul_i32 s96, s38, 1920
    s_mov_b32 s10, 1990656
    s_mov_b32 s11, 0x20000
    s_mov_b32 s60, 54665216
    s_waitcnt lgkmcnt(0)
    s_mov_b64 s[8:9], s[82:83]
    s_add_u32 m0, s96, 98304
    s_nop 0
    buffer_load_dwordx4 v2, s[8:11], s97 offen nt lds
    buffer_load_dwordx4 v7, s[8:11], s98 offen offset:960 nt lds
    s_add_u32 m0, s96, 106048
    s_nop 0
    buffer_load_dwordx4 v3, s[8:11], s97 offen nt lds
    buffer_load_dwordx4 v8, s[8:11], s98 offen offset:960 nt lds
    s_load_dword s29, s[32:33], s60
    s_and_b32 s39, s37, 7
    s_lshr_b32 s40, s37, 3
    s_lshl2_add_u32 s58, s40, s38
    s_lshl3_add_u32 s57, s36, s58
    s_mul_i32 s54, s57, 18432
    v_mul_u32_u24 v36, 7282, v0
    v_lshrrev_b32 v36, 16, v36
    v_mul_u32_u24 v36, 1008, v36
    s_mul_i32 s62, s39, 144
    v_add3_u32 v20, v36, v1, s62
    s_mul_i32 s63, s38, 2304
    s_add_u32 s63, s63, 139264
    s_add_u32 s56, s54, 7056
    s_add_u32 s57, s54, 14112
    s_mov_b64 s[4:5], s[80:81]
    s_mov_b32 s6, 2359296
    s_mov_b32 s7, 0x20000
    s_mov_b32 m0, s63
    s_mov_b32 exec_hi, 0x7fffffff
    buffer_load_dwordx4 v20, s[4:7], s54 offen nt lds
    buffer_load_dwordx4 v20, s[4:7], s56 offen offset:1008 nt lds
    s_mov_b64 exec, 0x3ffff
    buffer_load_dwordx4 v20, s[4:7], s57 offen offset:2016 nt lds
    s_mul_i32 s31, s36, 1520896
    s_mul_i32 s75, s37, 1164544
    s_lshl2_add_u32 s60, s37, s38
    s_lshl_b32 s61, s36, 6
    s_add_u32 s61, s61, s60
    s_mul_i32 s61, s61, 2304
    v_lshlrev_b32 v11, 7, v0
    s_mov_b64 s[24:25], s[92:93]
    s_mov_b32 s26, 2359296
    s_mov_b32 s27, 0x20000
    buffer_load_dword v42, v11, s[24:27], s61 offen sc1
    s_lshr_b32 s61, s60, 3
    s_mul_i32 s61, s61, 18432
    s_lshl_b32 s60, s60, 7
    s_add_u32 s60, s60, s61
    s_add_u32 s60, s60, s31
    s_add_u32 s94, s60, 18432
    s_lshl_b32 s99, s36, 12
    s_add_u32 s99, s99, 54525952
    s_lshl_b32 s59, s38, 7
    s_add_u32 s59, s59, s99
    s_add_u32 s60, s99, 3584
    s_add_u32 s61, s59, 512
    v_writelane_b32 v11, s94, 0
    v_writelane_b32 v11, s59, 1
    v_writelane_b32 v11, s60, 2
    v_writelane_b32 v11, s61, 3
    s_mov_b32 s34, 67108864
    s_mov_b32 s35, 0x20000
    s_mov_b64 exec, 15
    buffer_load_dword v42, v11, s[32:35], 0 offen sc1
    s_mov_b64 exec, -1
    v_mul_u32_u24 v36, 992, v34
    v_add3_u32 v36, v36, v1, s62
    s_mov_b32 vcc_lo, 0x20080200
    s_mov_b32 vcc_hi, 0x08020080
    v_cndmask_b32 v4, v36, v35, vcc
    v_or_b32 v37, s64, v4
    v_or_b32 v4, s66, v4
    v_or_b32 v125, s64, v1
    s_mul_i32 s60, s36, 36
    s_add_u32 s60, s60, s65
    s_and_b32 s61, s36, 14
    s_mul_i32 s61, s61, 36
    s_add_u32 s61, s61, 16
    s_cmp_eq_u32 s38, 3
    s_cselect_b32 s60, s61, s60
    s_mul_i32 s20, s60, 1152
    s_add_u32 s21, s20, 5952
    s_cmp_eq_u32 s40, 0
    s_cselect_b64 s[12:13], s[84:85], s[90:91]
    s_mov_b64 s[16:17], s[88:89]
    s_mov_b32 s14, 663552
    s_mov_b32 s15, 0x20000
    s_mov_b32 s18, 1990656
    s_mov_b32 s19, 0x20000
    s_mov_b32 exec_hi, 0x0fffffff
    s_add_u32 m0, s96, 129280
    s_nop 0
    buffer_load_dwordx4 v4, s[12:15], s20 offen nt lds
    buffer_load_dwordx4 v37, s[12:15], s21 offen offset:960 nt lds
    s_mov_b32 exec_hi, -1
    s_add_u32 s22, s22, 4095
    s_addc_u32 s23, s23, 0
    s_and_b32 s22, s22, 0xfffff000
    s_lshr_b32 s42, s2, 3
    s_lshl2_add_u32 s42, s42, s38
    s_lshl_b32 s60, s42, 9
    s_add_u32 s60, s60, 4096
    s_mov_b64 exec, 15
    v_lshl_add_u32 v24, v0, 7, s60
    v_min_u32 v24, 0xd8f8, v24
    global_load_dword v42, v24, s[22:23]
    s_mov_b64 exec, -1
    s_mov_b32 s74, 0x3f803f80
    s_mul_i32 s89, s39, 83200
    v_and_b32 v28, 15, v0
    v_lshrrev_b32 v29, 4, v0
    v_lshrrev_b32 v30, 2, v28
    v_and_b32 v31, 3, v0
    v_lshrrev_b32 v33, 5, v0
    v_lshl_add_u32 v16, v28, 2, s59
    v_lshrrev_b32 v34, 2, v0
    v_mul_u32_u24 v34, 160, v34
    v_lshl_add_u32 v5, v31, 3, v34
    v_mul_u32_u24 v34, 10880, v29
    s_movk_i32 s56, 2560
    v_add3_u32 v10, v34, v5, s56
    v_mul_u32_u24 v34, 1920, v33
    v_add_u32 v9, v5, v34
    s_and_b32 s56, s37, 1
    s_lshl_b32 s56, s56, 3
    v_add_u32 v5, s56, v5
    v_lshrrev_b32 v35, 1, v31
    v_lshl_add_u32 v6, v35, 6, v5
    v_add_u32 v6, 32, v6
    s_cmp_lt_u32 s36, 8
    s_cselect_b32 s57, 16, 17
    s_add_u32 s58, s75, 25239552
    s_mul_i32 s59, s40, 665600
    s_add_u32 s59, s59, s89
    s_add_u32 s59, s59, 46137344
    s_lshl_b32 s82, s36, 12
    s_add_u32 s82, s82, s59
    s_lshl_b32 s60, s38, 10
    s_add_u32 s82, s82, s60
    s_lshl_b32 s60, s38, 5
    s_add_u32 s60, s60, 129280
    v_add_u32 v121, s60, v9
    s_add_u32 s81, s59, 73728
    s_bfe_u32 s60, s36, 0x20001
    s_lshl_b32 s60, s60, 8
    v_lshl_add_u32 v81, v28, 4, s60
    s_and_b32 s60, s36, 1
    s_xor_b32 s60, s60, 1
    s_lshl_b32 s60, s60, 28
    s_or_b32 s59, s59, s60
    v_mul_u32_u24 v80, 640, v29
    v_mov_b32 v123, 268435456
    v_mov_b32 v124, 268435456
    s_bitcmp1_b32 s36, 0
    s_cselect_b32 s93, s74, 0
    s_lshl_b32 s61, s38, 2
    s_lshr_b32 s61, 0x4520, s61
    s_and_b32 s61, s61, 15
    s_lshl_b32 s61, s61, 6
    s_lshl_b32 s56, s36, 9
    s_add_u32 s56, s56, s61
    v_lshl_add_u32 v126, v28, 2, s56
    v_lshl_add_u32 v126, v33, 6, v126
    s_cmp_eq_u32 s38, 3
    s_mov_b32 vcc_lo, 0xffff0000
    s_cselect_b32 vcc_hi, -1, vcc_lo
    v_cndmask_b32 v126, v126, v123, vcc
    v_add_u32 v82, 7768, v5
    s_mov_b32 vcc_lo, 0x22222222
    s_mov_b32 vcc_hi, 0x22222222
    v_cndmask_b32 v6, v6, v82, vcc
    v_add_u32 v82, 7816, v5
    s_mov_b32 vcc_lo, 0x88888888
    s_mov_b32 vcc_hi, 0x88888888
    v_cndmask_b32 v6, v6, v82, vcc
    s_cmp_eq_u32 s38, 1
    s_cbranch_scc1 mw_2
    s_cmp_eq_u32 s38, 2
    s_cbranch_scc1 mw_3
    s_cmp_eq_u32 s38, 3
    s_cbranch_scc1 mw_4
    v_add_u32 v118, 98304, v5
    v_mov_b32 v251, v1
    s_mul_i32 s80, s36, 4864
    s_add_u32 s80, s80, s58
    s_add_u32 s80, s80, 768
    s_add_u32 s81, s80, 1024
    v_add_u32 v119, 40, v118
    v_add_u32 v120, 2600, v118
    v_mul_u32_u24 v82, 40, v29
    v_sub_u32 v122, v5, v80
    v_add_u32 v122, v122, v82
    v_add_u32 v122, 103424, v122
    s_mul_i32 s57, s57, 4864
    s_add_u32 s57, s57, 768
    s_add_u32 s57, s57, s58
    s_or_b32 s57, s57, s60
    v_lshl_add_u32 v81, v29, 10, v81
    v_add_u32 v123, s57, v81
    s_nop 2
    s_branch mj_1
mw_2:
    v_add_u32 v118, 98384, v5
    v_mov_b32 v251, v1
    s_mul_i32 s80, s36, 4864
    s_add_u32 s80, s80, s58
    s_add_u32 s80, s80, 2816
    s_add_u32 s81, s80, 1024
    v_add_u32 v119, 40, v118
    v_add_u32 v120, 2600, v118
    v_add_u32 v122, 103424, v6
    v_mul_u32_u24 v82, 40, v29
    v_sub_u32 v82, v82, v80
    v_add_u32 v82, v82, v5
    v_add_u32 v82, 111128, v82
    s_mov_b64 vcc, 0xffff
    s_mul_i32 s61, s57, 4864
    s_bfe_u32 s56, s36, 0x20001
    s_lshl_b32 s56, s56, 6
    s_sub_u32 s61, s61, s56
    s_lshl_b32 s57, s57, 11
    s_add_u32 s57, s57, 91136
    v_cndmask_b32 v122, v82, v122, vcc
    v_lshl_add_u32 v82, v29, 10, s57
    v_mov_b32 v80, s61
    v_cndmask_b32 v82, v82, v80, vcc
    s_or_b32 s58, s58, s60
    v_add3_u32 v82, v82, v81, s58
    s_mov_b32 vcc_lo, 0xffff0fff
    s_mov_b32 vcc_hi, 0xffff
    v_cndmask_b32 v123, v123, v82, vcc
    s_nop 2
    s_branch mj_1
mw_3:
    v_add_u32 v118, 106048, v5
    v_mov_b32 v251, v1
    s_mul_i32 s80, s36, 2048
    s_add_u32 s80, s80, s58
    s_add_u32 s80, s80, 92160
    s_add_u32 s81, s80, 1024
    v_add_u32 v119, 40, v118
    v_add_u32 v120, 2600, v118
    v_mul_u32_u24 v82, 11488, v29
    v_sub_u32 v122, v10, v82
    v_add_u32 v122, 129280, v122
    s_lshl_b32 s57, s57, 12
    s_add_u32 s59, s59, s57
    v_lshl_add_u32 v81, v29, 10, v81
    v_add_u32 v124, s59, v81
    s_nop 2
    s_branch mj_1
mw_4:
    v_add_u32 v118, 98304, v6
    s_mul_i32 s80, s36, 4864
    s_add_u32 s80, s80, s58
    v_lshlrev_b32 v82, 6, v29
    v_sub_u32 v82, v1, v82
    s_mov_b32 vcc_lo, 0x0fff0fff
    s_mov_b32 vcc_hi, 0x0fff0fff
    v_cndmask_b32 v251, v124, v82, vcc
    v_add_u32 v119, 129408, v9
    v_add_u32 v120, 130688, v9
    v_mul_u32_u24 v82, 11520, v29
    v_sub_u32 v122, v10, v82
    v_add_u32 v122, 129408, v122
    s_lshr_b32 s61, s36, 1
    s_lshl_b32 s61, s61, 10
    s_add_u32 s81, s81, s61
    s_and_b32 s61, s36, 1
    s_lshl_b32 s61, s61, 7
    s_add_u32 s81, s81, s61
    s_lshl_b32 s57, s57, 7
    s_add_u32 s59, s59, s57
    s_add_u32 s59, s59, 79872
    s_mov_b64 vcc, 0xff
    v_add_u32 v81, s59, v81
    v_cndmask_b32 v124, v124, v81, vcc
    s_nop 2
mj_1:
    v_mul_u32_u24 v82, 1240, v33
    v_sub_u32 v127, v118, v82
    v_mul_u32_u24 v34, 144, v28
    v_lshl_add_u32 v34, v29, 3, v34
    v_add_u32 v34, s63, v34
    s_waitcnt vmcnt(8)
    s_barrier
    ds_read_b64_tr_b16 v[80:81], v118 offset:0
    ds_read_b64_tr_b16 v[82:83], v118 offset:2560
    ds_read_b64_tr_b16 v[84:85], v119 offset:0
    ds_read_b64_tr_b16 v[86:87], v120 offset:0
    ds_read_b64_tr_b16 v[88:89], v122 offset:0
    ds_read_b64_tr_b16 v[90:91], v122 offset:640
    ds_read_b64_tr_b16 v[92:93], v127 offset:5120
    s_add_u32 s64, s80, 0
    s_waitcnt lgkmcnt(0)
    buffer_store_dwordx4 v[80:83], v251, s[32:35], s64 offen sc1
    s_add_u32 s64, s81, 0
    buffer_store_dwordx4 v[84:87], v125, s[32:35], s64 offen sc1
    s_mov_b32 s64, 0
    buffer_store_dwordx4 v[88:91], v123, s[32:35], s64 offen sc1
    v_dot2_f32_bf16 v96, v80, s74, 0
    v_dot2_f32_bf16 v40, v84, s74, 0
    v_dot2_f32_bf16 v96, v81, s74, v96
    v_dot2_f32_bf16 v40, v85, s74, v40
    v_dot2_f32_bf16 v96, v82, s74, v96
    v_dot2_f32_bf16 v40, v86, s74, v40
    v_dot2_f32_bf16 v96, v83, s74, v96
    v_dot2_f32_bf16 v40, v87, s74, v40
    v_dot2_f32_bf16 v92, v92, s93, 0
    v_dot2_f32_bf16 v92, v93, s93, v92
    s_nop 0
    v_permlane32_swap_b32 v96, v40
    v_add_f32 v96, v96, v40
    v_add_f32 v96, v96, v92
    v_mov_b32 v40, v96
    s_nop 1
    v_permlane16_swap_b32 v96, v40
    v_add_f32 v96, v96, v40
    s_add_u32 s64, s75, 25501696
    buffer_store_dword v96, v126, s[32:35], s64 offen sc1
    s_waitcnt vmcnt(9)
    ds_read_b64 v[140:141], v34 offset:0
    ds_read_b64 v[142:143], v34 offset:32
    ds_read_b64 v[144:145], v34 offset:64
    ds_read_b64 v[146:147], v34 offset:96
    ds_read_b64 v[148:149], v34 offset:128
    s_mov_b32 s70, -1
    s_mov_b32 s71, 0
    s_mov_b32 s3, 0
    s_lshl2_add_u32 s58, s40, s38
    s_mul_i32 s46, s58, 19456
    s_add_u32 s46, s46, s31
    s_lshl_b32 s56, s39, 8
    s_add_u32 s56, s56, 16384
    v_lshlrev_b32 v34, 4, v28
    v_lshl_add_u32 v35, v29, 3, v34
    v_add_u32 v35, s56, v35
    v_lshl_or_b32 v12, v33, 28, v35
    s_lshr_b32 s56, s39, 1
    s_lshl_b32 s56, s56, 8
    s_and_b32 s57, s39, 1
    s_lshl3_add_u32 s91, s57, s56
    s_add_u32 s56, s91, 18432
    v_add_u32 v35, s56, v34
    v_mov_b32 v36, 268435456
    s_mov_b32 vcc_lo, 0x00f0000f
    s_mov_b32 vcc_hi, 0xf0000f00
    v_cndmask_b32 v13, v36, v35, vcc
    v_min_u32 v23, 1, v0
    v_lshlrev_b32 v23, 28, v23
    s_mul_i32 s30, s29, 0x9e3779b1
    s_add_u32 s30, s30, 0x7f4a7c15
    s_and_b32 s30, s30, 0xffffffc0
    s_sub_u32 s56, s29, s30
    s_cmp_lt_u32 s56, 64
    s_cselect_b32 s56, 0x80000000, 0
    s_xor_b32 s30, s30, s56
    s_add_u32 s44, s30, 1
    s_waitcnt lgkmcnt(0)
    v_cndmask_b32 v148, 0, v148, s[70:71]
    v_cndmask_b32 v149, 0, v149, s[70:71]
    s_lshl_b32 s56, s39, 11
    s_add_u32 s56, s56, s54
    buffer_store_dwordx4 v[140:143], v1, s[24:27], s56 offen
    buffer_store_dwordx4 v[144:147], v1, s[24:27], s56 offen offset:1024
    buffer_store_dwordx2 v[148:149], v12, s[24:27], s54 offen
    s_mov_b32 s62, s82
    v_mov_b32 v150, 0
    v_mov_b32 v151, 0
    v_mov_b32 v152, s74
    v_mov_b32 v153, s74
    v_mov_b32 v154, s74
    v_mov_b32 v155, s74
    s_mov_b32 s82, 0x22222222
    s_mov_b32 s83, 0x22222222
    s_mov_b32 s84, 0x44444444
    s_mov_b32 s85, 0x44444444
    s_mov_b32 s86, 0x88888888
    s_mov_b32 s87, 0x88888888
    v_mfma_f32_16x16x32_bf16 v[160:163], v[140:143], v[140:143], 0
    v_mfma_f32_16x16x32_bf16 v[156:159], v[152:155], v[140:143], 0
    v_mfma_f32_16x16x32_bf16 v[160:163], v[144:147], v[144:147], v[160:163]
    v_mfma_f32_16x16x32_bf16 v[156:159], v[152:155], v[144:147], v[156:159]
    v_mfma_f32_16x16x32_bf16 v[160:163], v[148:151], v[148:151], v[160:163]
    v_mfma_f32_16x16x32_bf16 v[156:159], v[152:155], v[148:151], v[156:159]
    v_mov_b32 v26, s44
    s_nop 5
    v_cndmask_b32 v160, v160, v161, s[82:83]
    v_cndmask_b32 v160, v160, v162, s[84:85]
    v_cndmask_b32 v157, v160, v163, s[86:87]
    buffer_store_dwordx2 v[156:157], v13, s[32:35], s46 offen
    s_mov_b32 s82, s62
    s_getreg_b32 s28, hwreg(HW_REG_XCC_ID, 0, 4)
    s_add_u32 s28, s28, s30
    s_add_u32 s28, s28, 16
    s_lshl_b32 s56, s38, 28
    s_lshl2_add_u32 s56, s37, s56
    v_mov_b32 v64, s28
    v_or_b32 v65, s56, v23
    s_lshl1_add_u32 s88, s36, s40
    s_mul_i32 s60, s39, 4352
    s_lshl_b32 s88, s88, 7
    s_add_u32 s88, s88, s60
    s_add_u32 s88, s88, 54591488
    buffer_store_dword v64, v65, s[32:35], s99 offen offset:3584
    s_lshr_b32 s57, s58, 1
    s_lshl_b32 s57, s57, 7
    s_add_u32 s57, s57, s99
    s_and_b32 s61, s58, 1
    s_lshl1_add_u32 s60, s39, s61
    s_lshl2_add_u32 s49, s60, s57
    s_add_u32 s57, s57, 512
    v_lshl_add_u32 v17, v28, 2, s57
    v_lshlrev_b32 v36, 7, v33
    v_lshl_add_u32 v36, v28, 2, v36
    s_add_u32 s56, s99, 3584
    v_add_u32 v36, s56, v36
    s_mov_b32 vcc_lo, 0xffff0000
    s_mov_b32 vcc_hi, 0
    v_mov_b32 v35, s44
    v_cndmask_b32 v36, v36, v16, vcc
    v_cndmask_b32 v34, v64, v35, vcc
    v_lshl_or_b32 v35, v33, 28, v36
    s_mov_b32 s43, 100000
    s_mov_b32 s41, 1
    s_mul_i32 s45, s38, 38912
    s_add_u32 s45, s45, s31
    s_mul_i32 s48, s58, 18432
    s_add_u32 s57, s31, 155648
    s_add_u32 s48, s48, s57
    s_mul_i32 s47, s38, 36864
    s_add_u32 s47, s47, s57
    s_lshl_b32 s59, s38, 7
    s_add_u32 s59, s59, s99
    s_lshl2_add_u32 s50, s37, s59
    s_add_u32 s50, s50, 512
    s_and_b32 s56, s28, -16
    v_mov_b32 v43, s94
    s_mul_i32 s57, s36, 147456
    s_mul_i32 s94, s38, 36864
    s_add_u32 s94, s94, s57
    s_mov_b64 s[4:5], s[24:25]
    s_lshl_b32 s65, s38, 28
    s_add_u32 s65, s65, 0
    v_and_b32 v38, 31, v0
    v_lshl_add_u32 v38, v38, 2, s65
    v_mov_b32 v39, s30
    s_nop 2
    s_branch L_body
L_head_end:
.p2align 12
L_body:
    s_waitcnt vmcnt(5)
    s_barrier
    buffer_store_dword v39, v38, s[32:35], s88 offen sc1
    ds_read_b64_tr_b16 v[236:237], v121 offset:0
    ds_read_b64_tr_b16 v[238:239], v121 offset:1280
    ds_read_b64_tr_b16 v[240:241], v119 offset:0
    ds_read_b64_tr_b16 v[242:243], v120 offset:0
    ds_read_b64_tr_b16 v[244:245], v122 offset:3200
    ds_read_b64_tr_b16 v[246:247], v122 offset:0
    s_waitcnt vmcnt(2)
    buffer_store_dword v26, v23, s[32:35], s49 offen
    s_add_u32 s46, s46, s3
    s_add_u32 s52, s75, 25165824
    s_mul_i32 s61, s36, 1792
    s_add_u32 s51, s52, s61
    s_lshl_b32 s92, s38, 9
    s_cmp_eq_u32 s38, 3
    s_cselect_b32 s92, 268435456, s92
    v_mul_u32_u24 v249, 28160, v33
    v_add3_u32 v249, v249, v1, s92
    v_mov_b32 v252, -1
    v_mov_b32 v253, -1
    v_mov_b32 v254, -1
    v_mov_b32 v255, -1
    s_waitcnt lgkmcnt(4)
    buffer_store_dwordx4 v[236:239], v1, s[32:35], s82 offen sc1
    v_xor_b32 v248, 268435456, v125
    v_and_b32 v250, 8, v0
    v_lshl_or_b32 v248, v250, 25, v248
    s_waitcnt lgkmcnt(2)
    buffer_store_dwordx4 v[240:243], v248, s[32:35], s81 offen sc1
    s_waitcnt lgkmcnt(0)
    buffer_store_dwordx4 v[244:247], v124, s[32:35], 0 offen sc1
    buffer_store_dwordx4 v[252:255], v249, s[32:35], s51 offen sc1
    buffer_load_dword v24, v35, s[32:35], 0 offen sc1
    s_mov_b32 exec_hi, 0x0fffffff
    s_add_u32 m0, s96, 113792
    s_nop 0
    buffer_load_dwordx4 v2, s[16:19], s97 offen nt lds
    buffer_load_dwordx4 v7, s[16:19], s98 offen offset:960 nt lds
    s_add_u32 m0, s96, 121536
    s_nop 0
    buffer_load_dwordx4 v3, s[16:19], s97 offen nt lds
    buffer_load_dwordx4 v8, s[16:19], s98 offen offset:960 nt lds
    s_mov_b32 exec_hi, -1
    v_lshlrev_b32 v44, 16, v140
    v_and_b32 v45, 0xffff0000, v140
    v_lshlrev_b32 v46, 16, v141
    v_and_b32 v47, 0xffff0000, v141
    v_lshlrev_b32 v48, 16, v142
    v_and_b32 v49, 0xffff0000, v142
    v_lshlrev_b32 v50, 16, v143
    v_and_b32 v51, 0xffff0000, v143
    v_lshlrev_b32 v52, 16, v144
    v_and_b32 v53, 0xffff0000, v144
    v_lshlrev_b32 v54, 16, v145
    v_and_b32 v55, 0xffff0000, v145
    v_lshlrev_b32 v56, 16, v146
    v_and_b32 v57, 0xffff0000, v146
    v_lshlrev_b32 v58, 16, v147
    v_and_b32 v59, 0xffff0000, v147
    v_lshlrev_b32 v60, 16, v148
    v_and_b32 v61, 0xffff0000, v148
    v_lshlrev_b32 v62, 16, v149
    v_and_b32 v63, 0xffff0000, v149
    s_nop 2
    s_mov_b64 exec, 0
    s_cmp_eq_u32 s38, 0
    s_cbranch_scc1 L_hop0
    s_cmp_eq_u32 s38, 1
    s_cbranch_scc1 L_hop1
    s_cmp_eq_u32 s38, 2
    s_cbranch_scc1 L_hop2
    s_branch L_hop3
L_hopback:
    s_mov_b64 exec, -1
    s_waitcnt vmcnt(4)
chk_5:
    s_sub_u32 s43, s43, 1
    s_cselect_b64 s[68:69], 0, -1
    s_max_i32 s43, s43, 0
    v_and_b32 v25, -16, v24
    v_cmp_ne_u32 vcc, v34, v24
    v_cmp_eq_u32 s[58:59], s56, v25
    s_and_b64 s[58:59], s[58:59], vcc
    s_cbranch_scc1 L_goslow
    s_mov_b32 vcc_hi, 0
    s_and_b64 vcc, vcc, s[68:69]
    s_cbranch_scc0 ok_7
    s_and_b32 s58, s43, 15
    s_cselect_b64 vcc, -1, 0
    s_cselect_b32 s58, 268435456, 0
    v_cndmask_b32 v25, v36, v35, vcc
    v_or_b32 v26, s58, v65
    buffer_store_dword v64, v26, s[32:35], s99 offen offset:3712 sc1
    buffer_load_dword v24, v25, s[32:35], 0 offen sc1
    s_waitcnt vmcnt(0)
    s_branch chk_5
ok_7:
L_decided:
    v_add_u32 v128, 63488, v1
    v_add_u32 v136, 98304, v1
    v_and_b32 v130, 15, v0
    v_min_u32 v130, 11, v130
    v_lshrrev_b32 v131, 4, v0
    v_mul_u32_u24 v131, 192, v131
    v_lshl_add_u32 v130, v130, 4, v131
    v_add_u32 v131, 63488, v130
    s_cmp_eq_u32 s41, 0
    s_cselect_b32 s94, s45, s94
    s_cselect_b32 s56, 1024, 0
    s_add_u32 s56, s56, 18432
    v_add_u32 v138, s56, v1
    s_add_u32 s57, s94, 4096
    s_add_u32 s58, s94, 8192
    s_add_u32 s59, s94, 12288
    s_add_u32 s60, s94, 16384
    s_add_u32 s86, s45, 18432
    s_add_u32 s87, s45, 37888
    s_mul_i32 s64, s39, 4352
    s_add_u32 s64, s64, 54591488
    s_cmp_eq_u32 s38, 0
    s_cselect_b32 s64, s64, 268435456
    v_and_or_b32 v139, v0, 30, s40
    v_lshl_add_u32 v139, v139, 7, s64
    buffer_load_dword v41, v139, s[32:35], 0 offen sc1
    buffer_load_dwordx4 a[0:3], v1, s[4:7], s94 offen offset:0 sc1
    s_mov_b32 s55, 0
    s_mov_b32 s72, 0xf000f000
    s_mov_b32 s73, 0xf000f000
    s_mov_b32 s78, 0x00003f80
    buffer_load_dwordx4 a[72:75], v138, s[4:7], s94 offen offset:0 sc1
    s_mov_b32 s79, 0x3f800000
    s_mov_b32 s90, 0x3f317218
    s_lshl2_add_u32 s61, s37, s38
    buffer_load_dwordx4 a[4:7], v1, s[4:7], s94 offen offset:1024 sc1
    s_mul_i32 s62, s61, 2304
    v_lshl_add_u32 v34, v0, 7, s62
    v_mov_b32 v35, 268435456
    buffer_load_dwordx4 a[76:79], v138, s[4:7], s94 offen offset:1024 sc1
    s_mov_b64 vcc, 0x3ffff
    v_cndmask_b32 v34, v35, v34, vcc
    s_add_u32 s62, s31, 155648
    buffer_load_dwordx4 a[8:11], v1, s[4:7], s94 offen offset:2048 sc1
    v_add_u32 v35, s62, v34
    s_mov_b64 vcc, 0x40000
    v_cndmask_b32 v43, v35, v43, vcc
    buffer_load_dwordx4 a[80:83], v138, s[4:7], s94 offen offset:2048 sc1
    s_lshl_b32 s61, s38, 7
    s_add_u32 s61, s61, s99
    s_add_u32 s62, s61, 512
    buffer_load_dwordx4 a[12:15], v1, s[4:7], s94 offen offset:3072 sc1
    v_writelane_b32 v43, s61, 19
    v_writelane_b32 v43, s62, 20
    s_mul_i32 s61, s36, 147456
    buffer_load_dwordx4 a[84:87], v138, s[4:7], s94 offen offset:3072 sc1
    s_cmp_eq_u32 s41, 0
    s_cselect_b32 s61, 268435456, s61
    v_add_u32 v2, s61, v34
    buffer_load_dwordx4 v[140:143], v1, s[32:35], s86 offen sc1
    s_lshl2_add_u32 s61, s36, s38
    s_mul_i32 s53, s61, 5120
    s_add_u32 s53, s53, s75
    buffer_load_dwordx4 v[144:147], v1, s[32:35], s87 offen sc1
    s_add_u32 s53, s53, 25542656
    v_mul_u32_u24 v34, 1536, v29
    v_add3_u32 v21, v34, v1, s92
    buffer_load_dwordx4 a[16:19], v1, s[4:7], s57 offen offset:0 sc1
    s_mov_b32 s62, 0x32c98c98
    s_mov_b32 s63, 0x4324
    v_lshlrev_b32 v36, 2, v28
    buffer_load_dwordx4 a[88:91], v138, s[4:7], s57 offen offset:0 sc1
    v_lshrrev_b64 v[34:35], v36, s[62:63]
    v_and_b32 v34, 15, v34
    v_lshl_add_u32 v34, v29, 4, v34
    buffer_load_dwordx4 a[20:23], v1, s[4:7], s57 offen offset:1024 sc1
    v_add_u32 v35, 32, v34
    s_mov_b64 vcc, 0x0e380e38
    v_cndmask_b32 v34, v34, v35, vcc
    buffer_load_dwordx4 a[92:95], v138, s[4:7], s57 offen offset:1024 sc1
    v_lshl_add_u32 v35, v29, 2, v28
    v_min_u32 v35, 16, v35
    v_add_u32 v35, 92, v35
    buffer_load_dwordx4 a[24:27], v1, s[4:7], s57 offen offset:2048 sc1
    v_cndmask_b32 v34, v34, v35, s[72:73]
    v_add_u32 v35, 32, v0
    v_cndmask_b32 v34, v35, v34, s[70:71]
    buffer_load_dwordx4 a[96:99], v138, s[4:7], s57 offen offset:2048 sc1
    s_cmp_eq_u32 s38, 2
    s_cselect_b64 vcc, -1, 0
    v_cndmask_b32 v34, v0, v34, vcc
    buffer_load_dwordx4 a[28:31], v1, s[4:7], s57 offen offset:3072 sc1
    s_lshl_b32 s61, s38, 10
    s_add_u32 s61, s61, 135168
    v_lshl_add_u32 v11, v34, 4, s61
    buffer_load_dwordx4 a[100:103], v138, s[4:7], s57 offen offset:3072 sc1
    v_and_b32 v36, 1, v29
    v_mul_u32_u24 v36, 18432, v36
    v_lshl_add_u32 v36, v28, 4, v36
    buffer_load_dwordx4 a[32:35], v1, s[4:7], s58 offen offset:0 sc1
    s_lshl_b32 s61, s37, 10
    v_lshl_add_u32 v35, v33, 8, v36
    v_add_u32 v14, s61, v35
    buffer_load_dwordx4 a[104:107], v138, s[4:7], s58 offen offset:0 sc1
    s_lshl_b32 s61, s40, 10
    s_add_u32 s61, s61, s91
    s_add_u32 s61, s61, 16384
    buffer_load_dwordx4 a[36:39], v1, s[4:7], s58 offen offset:1024 sc1
    v_add_u32 v36, s61, v36
    v_lshl_or_b32 v15, v33, 28, v36
    v_lshlrev_b32 v34, 6, v33
    buffer_load_dwordx4 a[108:111], v138, s[4:7], s58 offen offset:1024 sc1
    v_xor_b32 v18, v1, v34
    v_add_u32 v34, 640, v1
    v_and_b32 v19, 1023, v34
    v_subrev_u32 v40, 0, v139
    v_cmp_ne_u32 s[64:65], s88, v40
    s_cmp_eq_u32 s38, 0
    s_cselect_b64 s[64:65], s[64:65], 0
chk_9:
    s_sub_u32 s43, s43, 1
    s_cselect_b64 s[68:69], 0, -1
    s_max_i32 s43, s43, 0
    s_waitcnt vmcnt(22)
    v_cmp_ne_u32 vcc, s30, v41
    s_and_b64 vcc, vcc, s[64:65]
    s_and_b64 vcc, vcc, s[68:69]
    s_cbranch_scc0 ok_11
    s_nop 1
    buffer_load_dword v41, v139, s[32:35], 0 offen sc1
    s_waitcnt vmcnt(0)
    s_branch chk_9
ok_11:
    s_barrier
    s_lshl_b32 s67, s38, 10
    s_add_u32 s66, s67, s75
    s_add_u32 m0, s67, 0
    s_add_u32 s66, s66, 25239552
    buffer_load_dwordx4 v1, s[32:35], s66 offen lds
    s_add_u32 m0, s67, 4096
    s_add_u32 s66, s66, 4096
    buffer_load_dwordx4 v1, s[32:35], s66 offen lds
    s_add_u32 m0, s67, 8192
    s_add_u32 s66, s66, 4096
    buffer_load_dwordx4 v1, s[32:35], s66 offen lds
    s_add_u32 m0, s67, 12288
    s_add_u32 s66, s66, 4096
    buffer_load_dwordx4 v1, s[32:35], s66 offen lds
    s_add_u32 m0, s67, 16384
    s_add_u32 s66, s66, 4096
    buffer_load_dwordx4 v1, s[32:35], s66 offen lds
    s_add_u32 m0, s67, 20480
    s_add_u32 s66, s66, 4096
    buffer_load_dwordx4 v1, s[32:35], s66 offen lds
    s_add_u32 m0, s67, 24576
    s_add_u32 s66, s66, 4096
    buffer_load_dwordx4 v1, s[32:35], s66 offen lds
    s_add_u32 m0, s67, 28672
    s_add_u32 s66, s66, 4096
    buffer_load_dwordx4 v1, s[32:35], s66 offen lds
    s_add_u32 m0, s67, 32768
    s_add_u32 s66, s66, 4096
    buffer_load_dwordx4 v1, s[32:35], s66 offen lds
    s_add_u32 m0, s67, 36864
    s_add_u32 s66, s66, 4096
    buffer_load_dwordx4 v1, s[32:35], s66 offen lds
    s_add_u32 m0, s67, 40960
    s_add_u32 s66, s66, 4096
    buffer_load_dwordx4 v1, s[32:35], s66 offen lds
    s_add_u32 m0, s67, 45056
    s_add_u32 s66, s66, 4096
    buffer_load_dwordx4 v1, s[32:35], s66 offen lds
    s_add_u32 m0, s67, 49152
    s_add_u32 s66, s66, 4096
    buffer_load_dwordx4 v1, s[32:35], s66 offen lds
    s_add_u32 m0, s67, 53248
    s_add_u32 s66, s66, 4096
    buffer_load_dwordx4 v1, s[32:35], s66 offen lds
    s_mov_b32 s84, s56
    s_mov_b32 s85, s57
    v_and_b32 v28, 31, v0
    v_lshrrev_b32 v29, 5, v0
    v_and_b32 v30, 1, v28
    v_cmp_lt_u32 vcc, 19, v28
    v_add_u32 v8, 124, v28
    v_mov_b32 v9, 156
    v_cndmask_b32 v30, v30, 2, vcc
    v_cndmask_b32 v31, v8, v9, vcc
    v_mad_u32_u24 v30, v29, 3, v30
    v_cmp_gt_u32 vcc, 16, v28
    v_add_u32 v8, 160, v28
    v_add_u32 v9, 176, v28
    v_cndmask_b32 v8, v31, v8, vcc
    v_cndmask_b32 v9, v31, v9, vcc
    v_add_u32 v31, 128, v30
    v_cndmask_b32 v6, v31, v0, vcc
    v_add_u32 v31, 134, v30
    v_add_u32 v7, 64, v0
    v_cndmask_b32 v7, v31, v7, vcc
    s_mov_b32 s56, 161792
    v_lshl_add_u32 v6, v6, 3, s56
    v_lshl_add_u32 v7, v7, 3, s56
    v_lshl_add_u32 v8, v8, 3, s56
    v_lshl_add_u32 v9, v9, 3, s56
    s_lshl_b32 s57, s38, 9
    s_add_u32 s56, s56, s57
    v_and_b32 v30, 15, v0
    v_lshl_add_u32 v10, v30, 4, s56
    v_lshl_add_u32 v10, v29, 8, v10
    v_bfe_u32 v31, v0, 4, 1
    v_lshl_add_u32 v10, v31, 3, v10
    v_and_b32 v31, 1, v0
    v_lshlrev_b32 v31, 4, v31
    v_lshlrev_b32 v31, v31, s78
    v_lshrrev_b32 v30, 1, v30
    v_cmp_eq_u32 vcc, 0, v30
    s_nop 1
    v_cndmask_b32 v28, 0, v31, vcc
    v_accvgpr_write_b32 a248, v28
    v_cmp_eq_u32 vcc, 1, v30
    s_nop 1
    v_cndmask_b32 v28, 0, v31, vcc
    v_accvgpr_write_b32 a249, v28
    v_cmp_eq_u32 vcc, 2, v30
    s_nop 1
    v_cndmask_b32 v28, 0, v31, vcc
    v_accvgpr_write_b32 a250, v28
    v_cmp_eq_u32 vcc, 3, v30
    s_nop 1
    v_cndmask_b32 v28, 0, v31, vcc
    v_accvgpr_write_b32 a251, v28
    v_cmp_eq_u32 vcc, 4, v30
    s_nop 1
    v_cndmask_b32 v28, 0, v31, vcc
    v_accvgpr_write_b32 a252, v28
    v_cmp_eq_u32 vcc, 5, v30
    s_nop 1
    v_cndmask_b32 v28, 0, v31, vcc
    v_accvgpr_write_b32 a253, v28
    v_cmp_eq_u32 vcc, 6, v30
    s_nop 1
    v_cndmask_b32 v28, 0, v31, vcc
    v_accvgpr_write_b32 a254, v28
    v_cmp_eq_u32 vcc, 7, v30
    s_nop 1
    v_cndmask_b32 v28, 0, v31, vcc
    v_accvgpr_write_b32 a255, v28
    s_mul_i32 s56, s38, 5120
    s_add_u32 s56, s56, 0
    s_add_u32 s57, s56, 4096
    v_add_u32 v3, s56, v1
    v_add_u32 v19, s57, v19
    v_add_u32 v18, s56, v18
    v_lshrrev_b32 v25, 5, v0
    v_bfe_u32 v26, v0, 2, 2
    v_lshl_add_u32 v26, v25, 2, v26
    v_lshlrev_b32 v26, 4, v26
    v_bfe_u32 v27, v0, 1, 1
    v_mul_u32_u24 v27, 576, v27
    v_xor_b32 v4, v26, v27
    v_and_b32 v27, 1, v0
    v_lshl_add_u32 v4, v27, 3, v4
    v_add_u32 v5, 3072, v4
    v_add_u32 v4, 2048, v4
    v_and_b32 v27, 3, v0
    v_min_u32 v27, 1, v27
    v_lshl_add_u32 v26, v27, 3, v26
    v_add_u32 v26, 4224, v26
    s_mov_b32 vcc_lo, 0xffff0000
    s_mov_b32 vcc_hi, 0xffff0000
    v_cndmask_b32 v4, v4, v26, vcc
    v_cndmask_b32 v5, v5, v26, vcc
    v_add_u32 v4, s56, v4
    v_add_u32 v5, s56, v5
    s_mov_b32 s56, s84
    s_mov_b32 s57, s85
    s_lshl_b32 s64, s38, 11
    s_add_u32 s64, s64, s75
    s_add_u32 s64, s64, 25501696
    buffer_load_dwordx4 v[28:31], v1, s[32:35], s64 offen offset:0 sc1
    buffer_load_dwordx4 v[32:35], v1, s[32:35], s64 offen offset:1024 sc1
    s_waitcnt vmcnt(11)
    s_barrier
    ds_read_b128 a[144:147], v1 offset:768
    ds_read_b128 a[148:151], v1 offset:1792
    ds_read_b128 a[152:155], v1 offset:2816
    ds_read_b128 a[156:159], v1 offset:3840
    ds_read_b128 a[160:163], v130 offset:0
    ds_read_b128 a[164:167], v1 offset:5632
    ds_read_b128 a[168:171], v1 offset:6656
    ds_read_b128 a[172:175], v1 offset:7680
    ds_read_b128 a[176:179], v1 offset:8704
    ds_read_b128 a[180:183], v130 offset:4864
    ds_read_b64_tr_b16 v[104:105], v118 offset:15488
    ds_read_b64_tr_b16 v[106:107], v118 offset:18048
    ds_read_b64_tr_b16 v[108:109], v119 offset:15488
    ds_read_b64_tr_b16 v[110:111], v120 offset:15488
    ds_read_b64_tr_b16 v[112:113], v122 offset:15488
    ds_read_b64_tr_b16 v[114:115], v122 offset:16128
    ds_read_b64_tr_b16 v[116:117], v127 offset:20608
    s_waitcnt lgkmcnt(12)
    v_mfma_f32_16x16x32_bf16 v[64:67], a[0:3], a[144:147], 0
    ds_read_b128 a[184:187], v1 offset:10496
    buffer_load_dwordx4 a[40:43], v1, s[4:7], s58 offen offset:2048 sc1
    v_mfma_f32_16x16x32_bf16 v[68:71], a[72:75], a[144:147], 0
    v_mfma_f32_16x16x32_bf16 v[72:75], a[0:3], a[148:151], 0
    ds_read_b128 a[188:191], v1 offset:11520
    v_mfma_f32_16x16x32_bf16 v[76:79], a[72:75], a[148:151], 0
    v_mfma_f32_16x16x32_bf16 v[80:83], a[0:3], a[152:155], 0
    ds_read_b128 a[192:195], v1 offset:12544
    s_add_u32 m0, s67, 63488
    s_add_u32 s66, s66, 4096
    buffer_load_dwordx4 v1, s[32:35], s66 offen lds
    v_mfma_f32_16x16x32_bf16 v[84:87], a[72:75], a[152:155], 0
    v_add_f32 v140, v140, v142
    v_mfma_f32_16x16x32_bf16 v[88:91], a[0:3], a[156:159], 0
    ds_read_b128 a[144:147], v1 offset:13568
    v_add_f32 v141, v141, v143
    v_mfma_f32_16x16x32_bf16 v[92:95], a[72:75], a[156:159], 0
    v_mfma_f32_16x16x32_bf16 v[96:99], a[0:3], a[160:163], 0
    ds_read_b128 a[148:151], v130 offset:9728
    buffer_load_dwordx4 a[112:115], v138, s[4:7], s58 offen offset:2048 sc1
    v_mfma_f32_16x16x32_bf16 v[100:103], a[72:75], a[160:163], 0
    v_add_f32 v144, v144, v146
    s_waitcnt lgkmcnt(12)
    v_mfma_f32_16x16x32_bf16 v[64:67], a[4:7], a[164:167], v[64:67]
    ds_read_b128 a[152:155], v1 offset:15360
    v_add_f32 v145, v145, v147
    v_mfma_f32_16x16x32_bf16 v[68:71], a[76:79], a[164:167], v[68:71]
    v_permlane32_swap_b32 v140, v141
    v_mfma_f32_16x16x32_bf16 v[72:75], a[4:7], a[168:171], v[72:75]
    ds_read_b128 a[156:159], v1 offset:16384
    s_add_u32 m0, s67, 67584
    s_add_u32 s66, s66, 4096
    buffer_load_dwordx4 v1, s[32:35], s66 offen lds
    v_mfma_f32_16x16x32_bf16 v[76:79], a[76:79], a[168:171], v[76:79]
    v_permlane32_swap_b32 v144, v145
    v_mfma_f32_16x16x32_bf16 v[80:83], a[4:7], a[172:175], v[80:83]
    ds_read_b128 a[160:163], v1 offset:17408
    v_mfma_f32_16x16x32_bf16 v[84:87], a[76:79], a[172:175], v[84:87]
    v_add_f32 v140, v140, v141
    v_mfma_f32_16x16x32_bf16 v[88:91], a[4:7], a[176:179], v[88:91]
    ds_read_b128 a[164:167], v1 offset:18432
    buffer_load_dwordx4 a[44:47], v1, s[4:7], s58 offen offset:3072 sc1
    v_mfma_f32_16x16x32_bf16 v[92:95], a[76:79], a[176:179], v[92:95]
    v_add_f32 v144, v144, v145
    v_mfma_f32_16x16x32_bf16 v[96:99], a[4:7], a[180:183], v[96:99]
    ds_read_b128 a[168:171], v130 offset:14592
    v_permlane16_swap_b32 v140, v144
    v_mfma_f32_16x16x32_bf16 v[100:103], a[76:79], a[180:183], v[100:103]
    s_waitcnt vmcnt(11)
    s_barrier
    s_waitcnt lgkmcnt(5)
    v_mfma_f32_16x16x32_bf16 v[64:67], a[8:11], a[184:187], v[64:67]
    ds_read_b128 a[172:175], v1 offset:20224
    s_add_u32 m0, s67, 71680
    s_add_u32 s66, s66, 4096
    buffer_load_dwordx4 v1, s[32:35], s66 offen lds
    v_mfma_f32_16x16x32_bf16 v[68:71], a[80:83], a[184:187], v[68:71]
    v_add_f32 v140, v140, v144
    v_mfma_f32_16x16x32_bf16 v[72:75], a[8:11], a[188:191], v[72:75]
    ds_read_b128 a[176:179], v1 offset:21248
    v_dot2_f32_bf16 v250, v104, s74, 0
    v_mfma_f32_16x16x32_bf16 v[76:79], a[80:83], a[188:191], v[76:79]
    v_mul_f32 v140, 0x3ae38e39, v140
    v_mov_b32 v144, v140
    v_mfma_f32_16x16x32_bf16 v[80:83], a[8:11], a[192:195], v[80:83]
    ds_read_b128 a[180:183], v1 offset:22272
    buffer_load_dwordx4 a[116:119], v138, s[4:7], s58 offen offset:3072 sc1
    v_mfma_f32_16x16x32_bf16 v[84:87], a[80:83], a[192:195], v[84:87]
    v_dot2_f32_bf16 v40, v108, s74, 0
    v_permlane32_swap_b32 v140, v144
    v_mfma_f32_16x16x32_bf16 v[88:91], a[8:11], a[144:147], v[88:91]
    ds_read_b128 a[184:187], v1 offset:23296
    v_dot2_f32_bf16 v250, v105, s74, v250
    v_mfma_f32_16x16x32_bf16 v[92:95], a[80:83], a[144:147], v[92:95]
    v_fma_f32 v144, -v140, v140, v144
    v_mfma_f32_16x16x32_bf16 v[96:99], a[8:11], a[148:151], v[96:99]
    ds_read_b128 a[188:191], v130 offset:19456
    s_add_u32 m0, s67, 75776
    s_add_u32 s66, s66, 4096
    buffer_load_dwordx4 v1, s[32:35], s66 offen lds
    v_mfma_f32_16x16x32_bf16 v[100:103], a[80:83], a[148:151], v[100:103]
    v_dot2_f32_bf16 v40, v109, s74, v40
    s_waitcnt lgkmcnt(5)
    v_mfma_f32_16x16x32_bf16 v[64:67], a[12:15], a[152:155], v[64:67]
    ds_read_b128 a[192:195], v1 offset:25088
    s_waitcnt vmcnt(8)
    v_add_f32 v28, v28, v32
    v_mfma_f32_16x16x32_bf16 v[68:71], a[84:87], a[152:155], v[68:71]
    v_dot2_f32_bf16 v250, v106, s74, v250
    v_max_f32 v144, 0, v144
    v_mfma_f32_16x16x32_bf16 v[72:75], a[12:15], a[156:159], v[72:75]
    ds_read_b128 a[144:147], v1 offset:26112
    buffer_load_dwordx4 a[48:51], v1, s[4:7], s59 offen offset:0 sc1
    v_mfma_f32_16x16x32_bf16 v[76:79], a[84:87], a[156:159], v[76:79]
    v_dot2_f32_bf16 v40, v110, s74, v40
    v_add_f32 v29, v29, v33
    v_mfma_f32_16x16x32_bf16 v[80:83], a[12:15], a[160:163], v[80:83]
    ds_read_b128 a[148:151], v1 offset:27136
    v_add_f32 v144, 0x3727c5ac, v144
    v_mfma_f32_16x16x32_bf16 v[84:87], a[84:87], a[160:163], v[84:87]
    v_rsq_f32 v148, v144
    v_mfma_f32_16x16x32_bf16 v[88:91], a[12:15], a[164:167], v[88:91]
    ds_read_b128 a[152:155], v1 offset:28160
    s_add_u32 m0, s67, 79872
    s_add_u32 s66, s66, 4096
    buffer_load_dwordx4 v1, s[32:35], s66 offen lds
    v_mfma_f32_16x16x32_bf16 v[92:95], a[84:87], a[164:167], v[92:95]
    v_dot2_f32_bf16 v250, v107, s74, v250
    v_add_f32 v30, v30, v34
    v_mfma_f32_16x16x32_bf16 v[96:99], a[12:15], a[168:171], v[96:99]
    ds_read_b128 a[156:159], v130 offset:24320
    v_dot2_f32_bf16 v40, v111, s74, v40
    v_mfma_f32_16x16x32_bf16 v[100:103], a[84:87], a[168:171], v[100:103]
    v_mul_f32 v150, -v140, v148
    s_waitcnt lgkmcnt(5)
    v_mfma_f32_16x16x32_bf16 v[64:67], a[16:19], a[172:175], v[64:67]
    ds_read_b128 a[160:163], v1 offset:29952
    buffer_load_dwordx4 a[120:123], v138, s[4:7], s59 offen offset:0 sc1
    v_mfma_f32_16x16x32_bf16 v[68:71], a[88:91], a[172:175], v[68:71]
    v_dot2_f32_bf16 v116, v116, s93, 0
    v_add_f32 v31, v31, v35
    v_mfma_f32_16x16x32_bf16 v[72:75], a[16:19], a[176:179], v[72:75]
    ds_read_b128 a[164:167], v1 offset:30976
    v_cndmask_b32 v140, v150, v148, s[70:71]
    v_mfma_f32_16x16x32_bf16 v[76:79], a[88:91], a[176:179], v[76:79]
    v_dot2_f32_bf16 v116, v117, s93, v116
    v_mfma_f32_16x16x32_bf16 v[80:83], a[16:19], a[180:183], v[80:83]
    ds_read_b128 a[168:171], v1 offset:32000
    s_add_u32 m0, s67, 83968
    s_add_u32 s66, s66, 4096
    buffer_load_dwordx4 v1, s[32:35], s66 offen lds
    v_mfma_f32_16x16x32_bf16 v[84:87], a[88:91], a[180:183], v[84:87]
    v_permlane32_swap_b32 v250, v40
    v_mfma_f32_16x16x32_bf16 v[88:91], a[16:19], a[184:187], v[88:91]
    ds_read_b128 a[172:175], v1 offset:33024
    v_mfma_f32_16x16x32_bf16 v[92:95], a[88:91], a[184:187], v[92:95]
    s_lshl_b32 s65, s38, 10
    s_add_u32 s65, s65, 57344
    v_mfma_f32_16x16x32_bf16 v[96:99], a[16:19], a[188:191], v[96:99]
    ds_read_b128 a[176:179], v130 offset:29184
    buffer_load_dwordx4 a[52:55], v1, s[4:7], s59 offen offset:1024 sc1
    v_mfma_f32_16x16x32_bf16 v[100:103], a[88:91], a[188:191], v[100:103]
    v_add_f32 v250, v250, v40
    s_waitcnt lgkmcnt(5)
    v_mfma_f32_16x16x32_bf16 v[64:67], a[20:23], a[192:195], v[64:67]
    ds_read_b128 a[180:183], v1 offset:34816
    v_add_f32 v250, v250, v116
    v_mfma_f32_16x16x32_bf16 v[68:71], a[92:95], a[192:195], v[68:71]
    v_add_u32 v32, s65, v1
    v_mfma_f32_16x16x32_bf16 v[72:75], a[20:23], a[144:147], v[72:75]
    ds_read_b128 a[184:187], v1 offset:35840
    s_add_u32 m0, s67, 88064
    s_add_u32 s66, s66, 4096
    buffer_load_dwordx4 v1, s[32:35], s66 offen lds
    v_mfma_f32_16x16x32_bf16 v[76:79], a[92:95], a[144:147], v[76:79]
    ds_write_b128 v32, v[28:31]
    v_mov_b32 v40, v250
    v_mfma_f32_16x16x32_bf16 v[80:83], a[20:23], a[148:151], v[80:83]
    ds_read_b128 a[188:191], v1 offset:36864
    v_mfma_f32_16x16x32_bf16 v[84:87], a[92:95], a[148:151], v[84:87]
    v_permlane16_swap_b32 v250, v40
    v_mfma_f32_16x16x32_bf16 v[88:91], a[20:23], a[152:155], v[88:91]
    ds_read_b128 a[192:195], v1 offset:37888
    buffer_load_dwordx4 a[124:127], v138, s[4:7], s59 offen offset:1024 sc1
    v_mfma_f32_16x16x32_bf16 v[92:95], a[92:95], a[152:155], v[92:95]
    v_add_f32 v250, v250, v40
    v_mfma_f32_16x16x32_bf16 v[96:99], a[20:23], a[156:159], v[96:99]
    ds_read_b128 a[144:147], v130 offset:34048
    v_mfma_f32_16x16x32_bf16 v[100:103], a[92:95], a[156:159], v[100:103]
    s_lshl_b32 s56, s38, 8
    s_add_u32 s56, s56, 160768
    v_lshl_add_u32 v141, v0, 2, s56
    v_and_b32 v142, 48, v0
    v_add_u32 v142, s56, v142
    ds_write_b32 v141, v140
    ds_read_b128 v[152:155], v142
    ds_read_b128 v[156:159], v142 offset:64
    ds_read_b128 v[160:163], v142 offset:128
    ds_read_b128 v[164:167], v142 offset:192
    v_mov_b32 v149, v148
    v_mov_b32 v151, v150
    s_nop 0
    v_permlane16_swap_b32 v148, v149
    v_permlane16_swap_b32 v150, v151
    s_waitcnt vmcnt(13)
    s_waitcnt lgkmcnt(0)
    s_barrier
    v_mfma_f32_16x16x32_bf16 v[64:67], a[24:27], a[160:163], v[64:67]
    ds_read_b128 a[148:151], v1 offset:39680
    s_sub_u32 s66, s66, s67
    s_min_u32 s67, s67, 1024
    s_add_u32 s66, s66, s67
    s_add_u32 m0, s67, 92160
    s_add_u32 s66, s66, 4096
    buffer_load_dwordx4 v1, s[32:35], s66 offen lds
    v_mfma_f32_16x16x32_bf16 v[68:71], a[96:99], a[160:163], v[68:71]
    v_lshrrev_b32 v212, 1, v1
    v_add_u32 v213, 159744, v212
    v_mfma_f32_16x16x32_bf16 v[72:75], a[24:27], a[164:167], v[72:75]
    ds_read_b128 a[152:155], v1 offset:40704
    v_add_u32 v212, 57344, v212
    v_mfma_f32_16x16x32_bf16 v[76:79], a[96:99], a[164:167], v[76:79]
    s_lshl_b32 s61, s38, 12
    s_add_u32 s61, s61, 135168
    v_mfma_f32_16x16x32_bf16 v[80:83], a[24:27], a[168:171], v[80:83]
    ds_read_b128 a[156:159], v1 offset:41728
    buffer_load_dwordx4 a[56:59], v1, s[4:7], s59 offen offset:2048 sc1
    v_mfma_f32_16x16x32_bf16 v[84:87], a[96:99], a[168:171], v[84:87]
    ds_read_b64 v[196:197], v212 offset:0
    ds_read_b64 v[198:199], v212 offset:512
    v_mfma_f32_16x16x32_bf16 v[88:91], a[24:27], a[172:175], v[88:91]
    ds_read_b128 a[160:163], v1 offset:42752
    ds_read_b64 v[200:201], v212 offset:1024
    v_mfma_f32_16x16x32_bf16 v[92:95], a[96:99], a[172:175], v[92:95]
    v_add_u32 v129, s61, v1
    v_mfma_f32_16x16x32_bf16 v[96:99], a[24:27], a[176:179], v[96:99]
    ds_read_b128 a[164:167], v130 offset:38912
    buffer_load_dwordx4 a[128:131], v138, s[4:7], s59 offen offset:2048 sc1
    v_mfma_f32_16x16x32_bf16 v[100:103], a[96:99], a[176:179], v[100:103]
    ds_read_b64 v[202:203], v212 offset:1536
    v_mfma_f32_16x16x32_bf16 v[64:67], a[28:31], a[180:183], v[64:67]
    ds_read_b128 a[168:171], v1 offset:44544
    ds_read_b64 v[204:205], v212 offset:2048
    v_mfma_f32_16x16x32_bf16 v[68:71], a[100:103], a[180:183], v[68:71]
    ds_read_b64 v[206:207], v212 offset:2560
    v_mfma_f32_16x16x32_bf16 v[72:75], a[28:31], a[184:187], v[72:75]
    ds_read_b128 a[172:175], v1 offset:45568
    buffer_load_dwordx4 a[60:63], v1, s[4:7], s59 offen offset:3072 sc1
L_hop0:
    s_cbranch_execz L_hop4
    v_mfma_f32_16x16x32_bf16 v[76:79], a[100:103], a[184:187], v[76:79]
    ds_read_b64 v[208:209], v212 offset:3072
    ds_read_b64 v[210:211], v212 offset:3584
    v_mfma_f32_16x16x32_bf16 v[80:83], a[28:31], a[188:191], v[80:83]
    ds_read_b128 a[176:179], v1 offset:46592
    v_mfma_f32_16x16x32_bf16 v[84:87], a[100:103], a[188:191], v[84:87]
    s_lshl_b32 s61, s38, 8
    s_add_u32 s61, s61, 160768
    v_mfma_f32_16x16x32_bf16 v[88:91], a[28:31], a[192:195], v[88:91]
    ds_read_b128 a[180:183], v1 offset:47616
    buffer_load_dwordx4 a[132:135], v138, s[4:7], s59 offen offset:3072 sc1
    v_mfma_f32_16x16x32_bf16 v[92:95], a[100:103], a[192:195], v[92:95]
    v_and_b32 v134, 3, v0
    v_lshrrev_b32 v135, 4, v0
    v_mfma_f32_16x16x32_bf16 v[96:99], a[28:31], a[144:147], v[96:99]
    ds_read_b128 a[184:187], v130 offset:43776
    v_mfma_f32_16x16x32_bf16 v[100:103], a[100:103], a[144:147], v[100:103]
    s_waitcnt lgkmcnt(10)
    v_mfma_f32_16x16x32_bf16 v[64:67], a[32:35], a[148:151], v[64:67]
    ds_read_b128 a[188:191], v1 offset:49408
    buffer_load_dwordx4 a[64:67], v1, s[4:7], s60 offen offset:0 sc1
    v_mfma_f32_16x16x32_bf16 v[68:71], a[104:107], a[148:151], v[68:71]
    v_lshlrev_b32 v132, 6, v134
    v_mfma_f32_16x16x32_bf16 v[72:75], a[32:35], a[152:155], v[72:75]
    ds_read_b128 a[192:195], v1 offset:50432
    v_mfma_f32_16x16x32_bf16 v[76:79], a[104:107], a[152:155], v[76:79]
    v_mfma_f32_16x16x32_bf16 v[80:83], a[32:35], a[156:159], v[80:83]
    ds_read_b128 a[144:147], v1 offset:51456
    buffer_load_dwordx4 a[136:139], v138, s[4:7], s60 offen offset:0 sc1
    v_mfma_f32_16x16x32_bf16 v[84:87], a[104:107], a[156:159], v[84:87]
    v_add_f32 v196, v196, v198
    v_lshl_add_u32 v132, v135, 3, v132
    v_mfma_f32_16x16x32_bf16 v[88:91], a[32:35], a[160:163], v[88:91]
    ds_read_b128 a[148:151], v1 offset:52480
    v_add_f32 v197, v197, v199
    v_mfma_f32_16x16x32_bf16 v[92:95], a[104:107], a[160:163], v[92:95]
    v_add_f32 v196, v196, v200
    v_mfma_f32_16x16x32_bf16 v[96:99], a[32:35], a[164:167], v[96:99]
    ds_read_b128 a[152:155], v130 offset:48640
    buffer_load_dwordx4 a[68:71], v1, s[4:7], s60 offen offset:1024 sc1
    v_mfma_f32_16x16x32_bf16 v[100:103], a[104:107], a[164:167], v[100:103]
    v_add_f32 v197, v197, v201
    s_waitcnt lgkmcnt(5)
    v_mfma_f32_16x16x32_bf16 v[64:67], a[36:39], a[168:171], v[64:67]
    ds_read_b128 a[156:159], v1 offset:54272
    v_add_f32 v196, v196, v202
    v_mfma_f32_16x16x32_bf16 v[68:71], a[108:111], a[168:171], v[68:71]
    v_add_f32 v197, v197, v203
    v_add_u32 v132, s61, v132
    v_mfma_f32_16x16x32_bf16 v[72:75], a[36:39], a[172:175], v[72:75]
    ds_read_b128 a[160:163], v1 offset:55296
    buffer_load_dwordx4 a[140:143], v138, s[4:7], s60 offen offset:1024 sc1
    v_mfma_f32_16x16x32_bf16 v[76:79], a[108:111], a[172:175], v[76:79]
    v_add_f32 v196, v196, v204
    v_add_f32 v197, v197, v205
    v_mfma_f32_16x16x32_bf16 v[80:83], a[36:39], a[176:179], v[80:83]
    ds_read_b128 a[164:167], v1 offset:56320
    v_add_f32 v196, v196, v206
    v_mfma_f32_16x16x32_bf16 v[84:87], a[108:111], a[176:179], v[84:87]
    v_add_f32 v197, v197, v207
    v_and_b32 v135, 1, v135
    v_mfma_f32_16x16x32_bf16 v[88:91], a[36:39], a[180:183], v[88:91]
    ds_read_b128 a[168:171], v128 offset:0
    s_lshl_b32 s65, s38, 28
    s_add_u32 s65, s65, 34816
    v_mfma_f32_16x16x32_bf16 v[92:95], a[108:111], a[180:183], v[92:95]
    v_add_f32 v196, v196, v208
    v_add_f32 v197, v197, v209
    v_mfma_f32_16x16x32_bf16 v[96:99], a[36:39], a[184:187], v[96:99]
    ds_read_b128 a[172:175], v130 offset:53504
    v_lshlrev_b32 v135, 5, v135
    v_mfma_f32_16x16x32_bf16 v[100:103], a[108:111], a[184:187], v[100:103]
    v_and_b32 v26, 31, v0
    s_waitcnt vmcnt(8)
    s_barrier
    s_waitcnt lgkmcnt(5)
    v_mfma_f32_16x16x32_bf16 v[64:67], a[40:43], a[188:191], v[64:67]
    ds_read_b128 a[176:179], v128 offset:1792
    v_add_f32 v196, v196, v210
    v_mfma_f32_16x16x32_bf16 v[68:71], a[112:115], a[188:191], v[68:71]
    v_add_f32 v197, v197, v211
    v_lshl_add_u32 v134, v134, 3, v135
    v_mfma_f32_16x16x32_bf16 v[72:75], a[40:43], a[192:195], v[72:75]
    ds_read_b128 a[180:183], v128 offset:2816
    v_lshl_add_u32 v26, v26, 2, s65
    v_mfma_f32_16x16x32_bf16 v[76:79], a[112:115], a[192:195], v[76:79]
    ds_write_b64 v213, v[196:197]
    v_and_b32 v24, 15, v0
    v_mfma_f32_16x16x32_bf16 v[80:83], a[40:43], a[144:147], v[80:83]
    ds_read_b128 a[184:187], v128 offset:3840
    v_lshlrev_b32 v24, 2, v24
    v_mfma_f32_16x16x32_bf16 v[84:87], a[112:115], a[144:147], v[84:87]
    v_add_u32 v24, 159744, v24
    v_bfe_u32 v135, v0, 2, 2
    v_mfma_f32_16x16x32_bf16 v[88:91], a[40:43], a[148:151], v[88:91]
    ds_read_b128 a[188:191], v128 offset:4864
    v_mov_b32 v27, s30
    v_mfma_f32_16x16x32_bf16 v[92:95], a[112:115], a[148:151], v[92:95]
    ds_read_b32 v176, v24 offset:0
    ds_read_b32 v177, v24 offset:64
    v_mfma_f32_16x16x32_bf16 v[96:99], a[40:43], a[152:155], v[96:99]
    ds_read_b128 a[192:195], v131 offset:1024
    ds_read_b32 v178, v24 offset:128
    v_mfma_f32_16x16x32_bf16 v[100:103], a[112:115], a[152:155], v[100:103]
    buffer_store_dword v27, v26, s[32:35], s88 offen sc1
    s_waitcnt lgkmcnt(9)
    v_mfma_f32_16x16x32_bf16 v[64:67], a[44:47], a[156:159], v[64:67]
    ds_read_b128 a[144:147], v128 offset:6656
    ds_read_b32 v179, v24 offset:192
    v_mfma_f32_16x16x32_bf16 v[68:71], a[116:119], a[156:159], v[68:71]
    ds_read_b32 v180, v24 offset:256
    v_lshl_add_u32 v134, v135, 6, v134
    v_mfma_f32_16x16x32_bf16 v[72:75], a[44:47], a[160:163], v[72:75]
    ds_read_b128 a[148:151], v128 offset:7680
    s_add_u32 s64, s80, 131072
    buffer_store_dwordx4 v[104:107], v251, s[32:35], s64 offen sc1
    v_mfma_f32_16x16x32_bf16 v[76:79], a[116:119], a[160:163], v[76:79]
    v_add_u32 v133, s61, v134
    v_mfma_f32_16x16x32_bf16 v[80:83], a[44:47], a[164:167], v[80:83]
    ds_read_b128 a[152:155], v128 offset:8704
    v_mfma_f32_16x16x32_bf16 v[84:87], a[116:119], a[164:167], v[84:87]
    s_mul_i32 s63, s38, 5120
    s_add_u32 s63, s63, 36864
    v_mfma_f32_16x16x32_bf16 v[88:91], a[44:47], a[168:171], v[88:91]
    ds_read_b128 a[156:159], v128 offset:9728
    s_add_u32 s64, s81, 131072
    buffer_store_dwordx4 v[108:111], v125, s[32:35], s64 offen sc1
    v_mfma_f32_16x16x32_bf16 v[92:95], a[116:119], a[168:171], v[92:95]
    v_lshl_add_u32 v134, v0, 3, s92
    v_add_u32 v32, s63, v1
    v_mfma_f32_16x16x32_bf16 v[96:99], a[44:47], a[172:175], v[96:99]
    ds_read_b128 a[160:163], v131 offset:5888
    ds_read_b128 a[228:231], v32 offset:0
    v_mfma_f32_16x16x32_bf16 v[100:103], a[116:119], a[172:175], v[100:103]
    s_mov_b32 s64, 131072
    buffer_store_dwordx4 v[112:115], v123, s[32:35], s64 offen sc1
    s_waitcnt lgkmcnt(9)
    v_mfma_f32_16x16x32_bf16 v[64:67], a[48:51], a[176:179], v[64:67]
    ds_read_b128 a[164:167], v128 offset:11520
    ds_read_b128 a[232:235], v32 offset:1024
    v_mfma_f32_16x16x32_bf16 v[68:71], a[120:123], a[176:179], v[68:71]
    ds_read_b128 a[236:239], v32 offset:2048
    v_mfma_f32_16x16x32_bf16 v[72:75], a[48:51], a[180:183], v[72:75]
    ds_read_b128 a[168:171], v128 offset:12544
    v_mul_f32 v168, 0x3fb8aa3b, v152
    v_mfma_f32_16x16x32_bf16 v[76:79], a[120:123], a[180:183], v[76:79]
    s_add_u32 s64, s75, 25513984
    buffer_store_dword v250, v126, s[32:35], s64 offen sc1
    v_mfma_f32_16x16x32_bf16 v[80:83], a[48:51], a[184:187], v[80:83]
    ds_read_b128 a[172:175], v128 offset:13568
    v_mul_f32 v169, 0x3fb8aa3b, v153
    v_mfma_f32_16x16x32_bf16 v[84:87], a[120:123], a[184:187], v[84:87]
    v_mul_f32 v170, 0x3fb8aa3b, v154
    v_mul_f32 v171, 0x3fb8aa3b, v155
    v_mfma_f32_16x16x32_bf16 v[88:91], a[48:51], a[188:191], v[88:91]
    ds_read_b128 a[176:179], v128 offset:14592
    s_mul_i32 s67, s38, 9216
    s_add_u32 s66, s67, s75
    s_add_u32 m0, s67, 98304
    s_add_u32 s66, s66, 25331712
    buffer_load_dwordx4 v1, s[32:35], s66 offen lds
    v_mfma_f32_16x16x32_bf16 v[92:95], a[120:123], a[188:191], v[92:95]
    v_mul_f32 v172, 0x3fb8aa3b, v156
    v_mul_f32 v173, 0x3fb8aa3b, v157
    v_mfma_f32_16x16x32_bf16 v[96:99], a[48:51], a[192:195], v[96:99]
    ds_read_b128 a[180:183], v131 offset:10752
    v_mul_f32 v174, 0x3fb8aa3b, v158
    v_mfma_f32_16x16x32_bf16 v[100:103], a[120:123], a[192:195], v[100:103]
    buffer_load_dwordx4 v1, s[32:35], s66 offen offset:1024 lds
    s_waitcnt lgkmcnt(8)
    v_mfma_f32_16x16x32_bf16 v[64:67], a[52:55], a[144:147], v[64:67]
    ds_read_b128 a[184:187], v128 offset:16384
    v_mul_f32 v175, 0x3fb8aa3b, v159
    v_mfma_f32_16x16x32_bf16 v[68:71], a[124:127], a[144:147], v[68:71]
    v_mov_b32 v181, s74
    v_mul_f32 v184, v160, v180
    v_mfma_f32_16x16x32_bf16 v[72:75], a[52:55], a[148:151], v[72:75]
    ds_read_b128 a[188:191], v128 offset:17408
    v_mul_f32 v185, v161, v180
    v_mfma_f32_16x16x32_bf16 v[76:79], a[124:127], a[148:151], v[76:79]
    buffer_load_dwordx4 v1, s[32:35], s66 offen offset:2048 lds
    v_mul_f32 v186, v162, v180
    v_mfma_f32_16x16x32_bf16 v[80:83], a[52:55], a[152:155], v[80:83]
    ds_read_b128 a[192:195], v128 offset:18432
    v_mul_f32 v187, v163, v180
    v_mfma_f32_16x16x32_bf16 v[84:87], a[124:127], a[152:155], v[84:87]
    v_mul_f32 v188, v164, v180
    v_mul_f32 v189, v165, v180
    v_mfma_f32_16x16x32_bf16 v[88:91], a[52:55], a[156:159], v[88:91]
    ds_read_b128 a[144:147], v128 offset:19456
    buffer_load_dwordx4 v1, s[32:35], s66 offen offset:3072 lds
    v_mfma_f32_16x16x32_bf16 v[92:95], a[124:127], a[156:159], v[92:95]
    v_mul_f32 v190, v166, v180
    v_mul_f32 v191, v167, v180
    v_mfma_f32_16x16x32_bf16 v[96:99], a[52:55], a[160:163], v[96:99]
    ds_read_b128 a[148:151], v131 offset:15616
    v_mul_f32 v176, 0x3fb8aa3b, v176
    v_mfma_f32_16x16x32_bf16 v[100:103], a[124:127], a[160:163], v[100:103]
    v_mul_f32 v177, 0x3fb8aa3b, v177
    s_waitcnt vmcnt(15) lgkmcnt(5)
    v_mfma_f32_16x16x32_bf16 v[64:67], a[56:59], a[164:167], v[64:67]
    ds_read_b128 a[152:155], v128 offset:21248
    s_add_u32 m0, s67, 102400
    s_add_u32 s66, s66, 4096
    buffer_load_dwordx4 v1, s[32:35], s66 offen lds
    v_mfma_f32_16x16x32_bf16 v[68:71], a[128:131], a[164:167], v[68:71]
    v_mul_f32 v180, 0x3fb8aa3b, v180
    v_mul_f32 v196, v160, v176
    v_mfma_f32_16x16x32_bf16 v[72:75], a[56:59], a[168:171], v[72:75]
    ds_read_b128 a[156:159], v128 offset:22272
    v_mul_f32 v197, v161, v176
    v_mfma_f32_16x16x32_bf16 v[76:79], a[128:131], a[168:171], v[76:79]
    buffer_load_dwordx4 v1, s[32:35], s66 offen offset:1024 lds
    v_mul_f32 v198, v162, v176
    v_mfma_f32_16x16x32_bf16 v[80:83], a[56:59], a[172:175], v[80:83]
    ds_read_b128 a[160:163], v128 offset:23296
    v_mul_f32 v199, v163, v176
    v_mfma_f32_16x16x32_bf16 v[84:87], a[128:131], a[172:175], v[84:87]
    ds_read_b128 a[240:243], v32 offset:3072
    v_mul_f32 v200, v164, v176
    v_mfma_f32_16x16x32_bf16 v[88:91], a[56:59], a[176:179], v[88:91]
    ds_read_b128 a[164:167], v128 offset:24320
    buffer_load_dwordx4 v1, s[32:35], s66 offen offset:2048 lds
    v_mfma_f32_16x16x32_bf16 v[92:95], a[128:131], a[176:179], v[92:95]
    v_mul_f32 v201, v165, v176
    v_mul_f32 v202, v166, v176
    v_mfma_f32_16x16x32_bf16 v[96:99], a[56:59], a[180:183], v[96:99]
    ds_read_b128 a[168:171], v131 offset:20480
    v_mul_f32 v203, v167, v176
    v_mfma_f32_16x16x32_bf16 v[100:103], a[128:131], a[180:183], v[100:103]
    v_mul_f32 v204, v160, v177
    s_waitcnt vmcnt(16) lgkmcnt(6)
    v_mfma_f32_16x16x32_bf16 v[64:67], a[60:63], a[184:187], v[64:67]
    ds_read_b128 a[172:175], v128 offset:26112
    buffer_load_dwordx4 v1, s[32:35], s66 offen offset:3072 lds
    v_mfma_f32_16x16x32_bf16 v[68:71], a[132:135], a[184:187], v[68:71]
    v_mul_f32 v205, v161, v177
    v_mul_f32 v206, v162, v177
    v_mfma_f32_16x16x32_bf16 v[72:75], a[60:63], a[188:191], v[72:75]
    ds_read_b128 a[176:179], v128 offset:27136
    v_mul_f32 v207, v163, v177
    v_mfma_f32_16x16x32_bf16 v[76:79], a[132:135], a[188:191], v[76:79]
    s_add_u32 m0, s67, 106496
    s_add_u32 s66, s66, 4096
    buffer_load_dwordx4 v1, s[32:35], s66 offen lds
    v_mfma_f32_16x16x32_bf16 v[80:83], a[60:63], a[192:195], v[80:83]
    ds_read_b128 a[180:183], v128 offset:28160
    v_mul_f32 v208, v164, v177
    v_mfma_f32_16x16x32_bf16 v[84:87], a[132:135], a[192:195], v[84:87]
    v_mul_f32 v209, v165, v177
    v_mul_f32 v210, v166, v177
    v_mfma_f32_16x16x32_bf16 v[88:91], a[60:63], a[144:147], v[88:91]
    ds_read_b128 a[184:187], v128 offset:29184
    v_mul_f32 v211, v167, v177
    v_mfma_f32_16x16x32_bf16 v[92:95], a[132:135], a[144:147], v[92:95]
    buffer_load_dword v42, v43, s[32:35], 0 offen sc1
    v_mul_f32 v212, v160, v178
    v_mfma_f32_16x16x32_bf16 v[96:99], a[60:63], a[148:151], v[96:99]
    ds_read_b128 a[188:191], v131 offset:25344
    v_mul_f32 v213, v161, v178
    v_mfma_f32_16x16x32_bf16 v[100:103], a[132:135], a[148:151], v[100:103]
    v_mul_f32 v214, v162, v178
    s_waitcnt vmcnt(17) lgkmcnt(5)
    v_mfma_f32_16x16x32_bf16 v[64:67], a[64:67], a[152:155], v[64:67]
    s_mul_i32 s64, s39, 4352
    s_add_u32 s64, s64, 54626304
    s_cmp_eq_u32 s38, 0
    s_cselect_b32 s64, s64, 268435456
    v_mfma_f32_16x16x32_bf16 v[68:71], a[136:139], a[152:155], v[68:71]
    v_mul_f32 v215, v163, v178
    v_mul_f32 v216, v164, v178
    v_mfma_f32_16x16x32_bf16 v[72:75], a[64:67], a[156:159], v[72:75]
    v_mul_f32 v217, v165, v178
    v_mul_f32 v218, v166, v178
    v_mfma_f32_16x16x32_bf16 v[76:79], a[136:139], a[156:159], v[76:79]
    v_and_b32 v139, 31, v0
    v_mul_f32 v219, v167, v178
    v_mfma_f32_16x16x32_bf16 v[80:83], a[64:67], a[160:163], v[80:83]
    ds_read_b128 a[244:247], v32 offset:4096
    v_mul_f32 v220, v160, v179
    v_mfma_f32_16x16x32_bf16 v[84:87], a[136:139], a[160:163], v[84:87]
    v_mul_f32 v221, v161, v179
    v_mfma_f32_16x16x32_bf16 v[88:91], a[64:67], a[164:167], v[88:91]
    v_mul_f32 v222, v162, v179
    v_mfma_f32_16x16x32_bf16 v[92:95], a[136:139], a[164:167], v[92:95]
    v_lshl_add_u32 v139, v139, 7, s64
    v_mul_f32 v223, v163, v179
    v_mfma_f32_16x16x32_bf16 v[96:99], a[64:67], a[168:171], v[96:99]
    v_mul_f32 v224, v164, v179
    v_mfma_f32_16x16x32_bf16 v[100:103], a[136:139], a[168:171], v[100:103]
    v_mul_f32 v225, v165, v179
    s_mul_i32 s63, s38, 8192
    s_min_u32 s63, s63, 22528
    s_add_u32 s63, s63, 63488
    v_add_u32 v33, s63, v1
    ds_read_b128 a[196:199], v33 offset:0
    ds_read_b128 a[200:203], v33 offset:1024
    ds_read_b128 a[204:207], v33 offset:2048
    ds_read_b128 a[208:211], v33 offset:3072
    ds_read_b128 a[212:215], v33 offset:4096
    ds_read_b128 a[216:219], v33 offset:5120
    ds_read_b128 a[220:223], v33 offset:6144
    ds_read_b128 a[224:227], v33 offset:7168
    s_waitcnt vmcnt(15) lgkmcnt(9)
    v_mfma_f32_16x16x32_bf16 v[64:67], a[68:71], a[172:175], v[64:67]
    buffer_load_dword v41, v139, s[32:35], 0 offen sc1
    v_mul_f32 v226, v166, v179
    v_mfma_f32_16x16x32_bf16 v[68:71], a[140:143], a[172:175], v[68:71]
    v_mul_f32 v227, v167, v179
    v_mfma_f32_16x16x32_bf16 v[72:75], a[68:71], a[176:179], v[72:75]
    v_mul_f32 v228, v160, v180
    v_mfma_f32_16x16x32_bf16 v[76:79], a[140:143], a[176:179], v[76:79]
    v_mul_f32 v229, v161, v180
    v_mfma_f32_16x16x32_bf16 v[80:83], a[68:71], a[180:183], v[80:83]
    v_mul_f32 v230, v162, v180
    v_mfma_f32_16x16x32_bf16 v[84:87], a[140:143], a[180:183], v[84:87]
    v_mul_f32 v231, v163, v180
    v_mfma_f32_16x16x32_bf16 v[88:91], a[68:71], a[184:187], v[88:91]
    v_mul_f32 v232, v164, v180
    v_mfma_f32_16x16x32_bf16 v[92:95], a[140:143], a[184:187], v[92:95]
    v_mul_f32 v233, v165, v180
    v_mfma_f32_16x16x32_bf16 v[96:99], a[68:71], a[188:191], v[96:99]
    v_mul_f32 v234, v166, v180
    v_mfma_f32_16x16x32_bf16 v[100:103], a[140:143], a[188:191], v[100:103]
    v_mul_f32 v235, v167, v180
    s_add_u32 s45, s45, s3
    v_pk_fma_f32 v[64:65], v[64:65], v[168:169], v[196:197]
    v_pk_fma_f32 v[66:67], v[66:67], v[170:171], v[198:199]
    v_pk_fma_f32 v[68:69], v[68:69], v[172:173], v[200:201]
    v_pk_fma_f32 v[70:71], v[70:71], v[174:175], v[202:203]
    v_pk_fma_f32 v[72:73], v[72:73], v[168:169], v[204:205]
    v_pk_fma_f32 v[74:75], v[74:75], v[170:171], v[206:207]
    v_pk_fma_f32 v[76:77], v[76:77], v[172:173], v[208:209]
    v_pk_fma_f32 v[78:79], v[78:79], v[174:175], v[210:211]
    v_pk_fma_f32 v[80:81], v[80:81], v[152:153], v[212:213]
    v_pk_fma_f32 v[82:83], v[82:83], v[154:155], v[214:215]
    v_pk_fma_f32 v[84:85], v[84:85], v[156:157], v[216:217]
    v_pk_fma_f32 v[86:87], v[86:87], v[158:159], v[218:219]
    v_pk_fma_f32 v[88:89], v[88:89], v[152:153], v[220:221]
    v_pk_fma_f32 v[90:91], v[90:91], v[154:155], v[222:223]
    v_pk_fma_f32 v[92:93], v[92:93], v[156:157], v[224:225]
    v_pk_fma_f32 v[94:95], v[94:95], v[158:159], v[226:227]
    v_pk_fma_f32 v[184:185], v[96:97], v[152:153], v[184:185]
    v_pk_fma_f32 v[186:187], v[98:99], v[154:155], v[186:187]
    v_pk_fma_f32 v[188:189], v[100:101], v[156:157], v[188:189]
    v_pk_fma_f32 v[190:191], v[102:103], v[158:159], v[190:191]
    v_pk_fma_f32 v[96:97], v[96:97], v[168:169], v[228:229]
    v_pk_fma_f32 v[98:99], v[98:99], v[170:171], v[230:231]
    v_pk_fma_f32 v[100:101], v[100:101], v[172:173], v[232:233]
    v_pk_fma_f32 v[102:103], v[102:103], v[174:175], v[234:235]
    v_cvt_pk_bf16_f32 v36, v184, v185
    v_cvt_pk_bf16_f32 v37, v186, v187
    v_cvt_pk_bf16_f32 v38, v188, v189
    v_cvt_pk_bf16_f32 v39, v190, v191
    v_cndmask_b32 v36, v36, v181, s[72:73]
    v_cndmask_b32 v37, v37, v181, s[72:73]
    v_cndmask_b32 v38, v38, v181, s[72:73]
    v_cndmask_b32 v39, v39, v181, s[72:73]
    v_cvt_pk_bf16_f32 v244, v80, v81
    v_cvt_pk_bf16_f32 v245, v82, v83
    v_cvt_pk_bf16_f32 v246, v84, v85
    v_cvt_pk_bf16_f32 v247, v86, v87
    v_cvt_pk_bf16_f32 v248, v88, v89
    v_cvt_pk_bf16_f32 v249, v90, v91
    v_cvt_pk_bf16_f32 v250, v92, v93
    v_cvt_pk_bf16_f32 v251, v94, v95
    v_exp_f32 v26, v96 clamp
    v_exp_f32 v27, v97 clamp
    v_max_f32 v96, 0x35c1a2a0, v96
    v_max_f32 v97, 0x35c1a2a0, v97
    v_pk_fma_f32 v[96:97], v[96:97], s[90:91], v[26:27] op_sel:[0,0,0] op_sel_hi:[1,0,1]
    v_cvt_pk_bf16_f32 v252, v96, v97
    v_exp_f32 v26, v98 clamp
    v_exp_f32 v27, v99 clamp
    v_max_f32 v98, 0x35c1a2a0, v98
    v_max_f32 v99, 0x35c1a2a0, v99
    v_pk_fma_f32 v[98:99], v[98:99], s[90:91], v[26:27] op_sel:[0,0,0] op_sel_hi:[1,0,1]
    v_cvt_pk_bf16_f32 v253, v98, v99
    v_exp_f32 v26, v100 clamp
    v_exp_f32 v27, v101 clamp
    v_max_f32 v100, 0x35c1a2a0, v100
    v_max_f32 v101, 0x35c1a2a0, v101
    v_pk_fma_f32 v[100:101], v[100:101], s[90:91], v[26:27] op_sel:[0,0,0] op_sel_hi:[1,0,1]
    v_cvt_pk_bf16_f32 v254, v100, v101
    v_exp_f32 v26, v102 clamp
    v_exp_f32 v27, v103 clamp
    v_max_f32 v102, 0x35c1a2a0, v102
    v_max_f32 v103, 0x35c1a2a0, v103
    v_pk_fma_f32 v[102:103], v[102:103], s[90:91], v[26:27] op_sel:[0,0,0] op_sel_hi:[1,0,1]
    v_cvt_pk_bf16_f32 v255, v102, v103
    s_nop 1
    v_mfma_f32_16x16x32_bf16 v[220:223], v[252:255], v[244:247], 0
    v_mfma_f32_16x16x32_bf16 v[224:227], v[252:255], v[248:251], 0
    v_mfma_f32_16x16x32_bf16 v[228:231], v[252:255], v[36:39], 0
    v_exp_f32 v26, v64 clamp
    v_exp_f32 v27, v65 clamp
    v_max_f32 v64, 0x35c1a2a0, v64
    v_max_f32 v65, 0x35c1a2a0, v65
    v_pk_fma_f32 v[64:65], v[64:65], s[90:91], v[26:27] op_sel:[0,0,0] op_sel_hi:[1,0,1]
    v_cvt_pk_bf16_f32 v236, v64, v65
    v_exp_f32 v26, v66 clamp
    v_exp_f32 v27, v67 clamp
    v_max_f32 v66, 0x35c1a2a0, v66
    v_max_f32 v67, 0x35c1a2a0, v67
    v_pk_fma_f32 v[66:67], v[66:67], s[90:91], v[26:27] op_sel:[0,0,0] op_sel_hi:[1,0,1]
    v_cvt_pk_bf16_f32 v237, v66, v67
    v_exp_f32 v26, v68 clamp
    v_exp_f32 v27, v69 clamp
    v_max_f32 v68, 0x35c1a2a0, v68
    v_max_f32 v69, 0x35c1a2a0, v69
    v_pk_fma_f32 v[68:69], v[68:69], s[90:91], v[26:27] op_sel:[0,0,0] op_sel_hi:[1,0,1]
    v_cvt_pk_bf16_f32 v238, v68, v69
    v_exp_f32 v26, v70 clamp
    v_exp_f32 v27, v71 clamp
    v_max_f32 v70, 0x35c1a2a0, v70
    v_max_f32 v71, 0x35c1a2a0, v71
    v_pk_fma_f32 v[70:71], v[70:71], s[90:91], v[26:27] op_sel:[0,0,0] op_sel_hi:[1,0,1]
    v_cvt_pk_bf16_f32 v239, v70, v71
    s_nop 1
    v_mfma_f32_16x16x32_bf16 v[204:207], v[236:239], v[244:247], 0
    v_mfma_f32_16x16x32_bf16 v[212:215], v[236:239], v[36:39], 0
    s_mov_b64 exec, 0xffff
    ds_write_b128 v129, v[220:223] offset:3072
    ds_write_b128 v129, v[224:227] offset:3328
    s_mov_b64 exec, 0x1f00
    ds_write_b128 v129, v[228:231] offset:3584
    s_mov_b64 exec, -1
    v_exp_f32 v26, v72 clamp
    v_exp_f32 v27, v73 clamp
    v_max_f32 v72, 0x35c1a2a0, v72
    v_max_f32 v73, 0x35c1a2a0, v73
    v_pk_fma_f32 v[72:73], v[72:73], s[90:91], v[26:27] op_sel:[0,0,0] op_sel_hi:[1,0,1]
    v_cvt_pk_bf16_f32 v240, v72, v73
    v_exp_f32 v26, v74 clamp
    v_exp_f32 v27, v75 clamp
    v_max_f32 v74, 0x35c1a2a0, v74
    v_max_f32 v75, 0x35c1a2a0, v75
    v_pk_fma_f32 v[74:75], v[74:75], s[90:91], v[26:27] op_sel:[0,0,0] op_sel_hi:[1,0,1]
    v_cvt_pk_bf16_f32 v241, v74, v75
    v_exp_f32 v26, v76 clamp
    v_exp_f32 v27, v77 clamp
    v_max_f32 v76, 0x35c1a2a0, v76
    v_max_f32 v77, 0x35c1a2a0, v77
    v_pk_fma_f32 v[76:77], v[76:77], s[90:91], v[26:27] op_sel:[0,0,0] op_sel_hi:[1,0,1]
    v_cvt_pk_bf16_f32 v242, v76, v77
    v_exp_f32 v26, v78 clamp
    v_exp_f32 v27, v79 clamp
    v_max_f32 v78, 0x35c1a2a0, v78
    v_max_f32 v79, 0x35c1a2a0, v79
    v_pk_fma_f32 v[78:79], v[78:79], s[90:91], v[26:27] op_sel:[0,0,0] op_sel_hi:[1,0,1]
    v_cvt_pk_bf16_f32 v243, v78, v79
    s_nop 1
    v_mfma_f32_16x16x32_bf16 v[208:211], v[240:243], v[248:251], 0
    v_mfma_f32_16x16x32_bf16 v[216:219], v[240:243], v[36:39], 0
    ds_write_b128 v129, v[204:207]
    s_mov_b32 exec_lo, 0x1f001f00
    s_mov_b32 exec_hi, 0x1f001f00
    ds_write_b128 v129, v[212:215] offset:2048
    s_mov_b64 exec, -1
    s_waitcnt vmcnt(11)
    s_nop 0
    ds_write_b128 v129, v[208:211] offset:1024
    s_mov_b32 exec_lo, 0x1f001f00
    s_mov_b32 exec_hi, 0x1f001f00
    ds_write_b128 v129, v[216:219] offset:1920
    s_mov_b64 exec, -1
    s_waitcnt lgkmcnt(0)
    s_barrier
    ds_read_b128 v[196:199], v11 offset:0
    ds_read_b128 v[200:203], v11 offset:4096
    ds_read_b128 v[204:207], v11 offset:8192
    ds_read_b128 v[208:211], v11 offset:12288
    s_mov_b32 exec_lo, 0x00f000f0
    s_mov_b32 exec_hi, 0x00f000f0
    ds_write_b64 v132, v[252:253]
    ds_write_b64 v132, v[254:255] offset:32
    s_mov_b64 exec, -1
    ds_read_b64_tr_b16 v[30:31], v133
    s_waitcnt lgkmcnt(5)
    v_pk_add_f32 v[196:197], v[196:197], v[200:201]
    v_pk_add_f32 v[198:199], v[198:199], v[202:203]
    s_waitcnt lgkmcnt(3)
    v_pk_add_f32 v[204:205], v[204:205], v[208:209]
    v_pk_add_f32 v[206:207], v[206:207], v[210:211]
    v_pk_add_f32 v[196:197], v[196:197], v[204:205]
    v_pk_add_f32 v[198:199], v[198:199], v[206:207]
    v_cvt_pk_bf16_f32 v200, v196, v197
    v_cvt_pk_bf16_f32 v201, v198, v199
    buffer_store_dwordx2 v[200:201], v134, s[32:35], s51 offen sc1
    s_waitcnt vmcnt(3)
    s_barrier
    ds_read_b128 a[144:147], v136 offset:0
    ds_read_b128 a[148:151], v136 offset:1024
    ds_read_b128 a[152:155], v136 offset:2048
    ds_read_b128 a[156:159], v136 offset:3072
    v_subrev_u32 v40, 34816, v139
    v_cmp_ne_u32 s[64:65], s88, v40
    s_cmp_eq_u32 s38, 0
    s_cselect_b64 s[64:65], s[64:65], 0
chk_12:
    s_sub_u32 s43, s43, 1
    s_cselect_b64 s[68:69], 0, -1
    s_max_i32 s43, s43, 0
    s_waitcnt vmcnt(1)
    v_cmp_ne_u32 vcc, s30, v41
    s_and_b64 vcc, vcc, s[64:65]
    s_and_b64 vcc, vcc, s[68:69]
    s_cbranch_scc0 ok_14
    s_nop 1
    buffer_load_dword v41, v139, s[32:35], 0 offen sc1
    s_waitcnt vmcnt(0)
    s_branch chk_12
ok_14:
    s_barrier
    s_waitcnt lgkmcnt(2)
    v_mfma_f32_16x16x32_bf16 v[104:107], a[144:147], a[0:3], 0
    ds_read_b128 a[160:163], v136 offset:4096
    s_mul_i32 s67, s38, 14336
    s_add_u32 s66, s67, s89
    s_add_u32 m0, s67, 0
    s_add_u32 s66, s66, 46137344
    buffer_load_dwordx4 v1, s[32:35], s66 offen lds
    v_mfma_f32_16x16x32_bf16 v[108:111], a[144:147], a[72:75], 0
    v_and_b32 v140, 48, v0
    v_add_u32 v140, 160064, v140
    v_mfma_f32_16x16x32_bf16 v[112:115], a[148:151], a[0:3], 0
    ds_read_b128 a[164:167], v136 offset:5120
    ds_read_b128 v[176:179], v140 offset:0
    v_mfma_f32_16x16x32_bf16 v[116:119], a[148:151], a[72:75], 0
    ds_read_b128 v[180:183], v140 offset:64
    s_waitcnt lgkmcnt(4)
    v_mfma_f32_16x16x32_bf16 v[104:107], a[152:155], a[4:7], v[104:107]
    ds_read_b128 a[168:171], v136 offset:6144
    buffer_load_dwordx4 v1, s[32:35], s66 offen offset:1024 lds
    v_mfma_f32_16x16x32_bf16 v[108:111], a[152:155], a[76:79], v[108:111]
    v_mul_f32 v148, 0x3fb8aa3b, v148
    v_mul_f32 v149, 0x3fb8aa3b, v149
    v_mfma_f32_16x16x32_bf16 v[112:115], a[156:159], a[4:7], v[112:115]
    ds_read_b128 a[172:175], v136 offset:7168
    v_mul_f32 v150, 0x3fb8aa3b, v150
    v_mfma_f32_16x16x32_bf16 v[116:119], a[156:159], a[76:79], v[116:119]
    v_mul_f32 v151, 0x3fb8aa3b, v151
    s_waitcnt lgkmcnt(4)
    v_mfma_f32_16x16x32_bf16 v[104:107], a[160:163], a[8:11], v[104:107]
    ds_read_b128 a[176:179], v136 offset:8192
    buffer_load_dwordx4 v1, s[32:35], s66 offen offset:2048 lds
    v_mfma_f32_16x16x32_bf16 v[108:111], a[160:163], a[80:83], v[108:111]
    v_mfma_f32_16x16x32_bf16 v[112:115], a[164:167], a[8:11], v[112:115]
    ds_read_b128 a[180:183], v136 offset:9216
    v_mfma_f32_16x16x32_bf16 v[116:119], a[164:167], a[80:83], v[116:119]
    s_waitcnt lgkmcnt(2)
    v_mfma_f32_16x16x32_bf16 v[104:107], a[168:171], a[12:15], v[104:107]
    ds_read_b128 a[184:187], v136 offset:10240
    buffer_load_dwordx4 v1, s[32:35], s66 offen offset:3072 lds
    v_mfma_f32_16x16x32_bf16 v[108:111], a[168:171], a[84:87], v[108:111]
    v_mfma_f32_16x16x32_bf16 v[112:115], a[172:175], a[12:15], v[112:115]
    ds_read_b128 a[188:191], v136 offset:11264
    v_mfma_f32_16x16x32_bf16 v[116:119], a[172:175], a[84:87], v[116:119]
    s_waitcnt lgkmcnt(2)
    v_mfma_f32_16x16x32_bf16 v[104:107], a[176:179], a[16:19], v[104:107]
    ds_read_b128 a[192:195], v136 offset:12288
    v_mul_f32 v152, v150, v176
    v_mfma_f32_16x16x32_bf16 v[108:111], a[176:179], a[88:91], v[108:111]
    s_add_u32 m0, s67, 4096
    s_add_u32 s66, s66, 4096
    buffer_load_dwordx4 v1, s[32:35], s66 offen lds
    v_mfma_f32_16x16x32_bf16 v[112:115], a[180:183], a[16:19], v[112:115]
    ds_read_b128 a[144:147], v136 offset:13312
    v_mul_f32 v153, v150, v177
    v_mfma_f32_16x16x32_bf16 v[116:119], a[180:183], a[88:91], v[116:119]
    v_mul_f32 v154, v150, v178
    s_waitcnt lgkmcnt(2)
    v_mfma_f32_16x16x32_bf16 v[104:107], a[184:187], a[20:23], v[104:107]
    ds_read_b128 a[148:151], v136 offset:14336
    v_mfma_f32_16x16x32_bf16 v[108:111], a[184:187], a[92:95], v[108:111]
    buffer_load_dwordx4 v1, s[32:35], s66 offen offset:1024 lds
    v_mul_f32 v155, v150, v179
    v_mfma_f32_16x16x32_bf16 v[112:115], a[188:191], a[20:23], v[112:115]
    ds_read_b128 a[152:155], v136 offset:15360
    v_mfma_f32_16x16x32_bf16 v[116:119], a[188:191], a[92:95], v[116:119]
    v_mul_f32 v156, v151, v176
    s_waitcnt lgkmcnt(2)
    v_mfma_f32_16x16x32_bf16 v[104:107], a[192:195], a[24:27], v[104:107]
L_hop1:
    s_cbranch_execz L_hop5
    ds_read_b128 a[156:159], v136 offset:16384
    v_mfma_f32_16x16x32_bf16 v[108:111], a[192:195], a[96:99], v[108:111]
    buffer_load_dwordx4 v1, s[32:35], s66 offen offset:2048 lds
    v_mul_f32 v157, v151, v177
    v_mfma_f32_16x16x32_bf16 v[112:115], a[144:147], a[24:27], v[112:115]
    ds_read_b128 a[160:163], v136 offset:17408
    v_mfma_f32_16x16x32_bf16 v[116:119], a[144:147], a[96:99], v[116:119]
    v_mul_f32 v158, v151, v178
    s_waitcnt lgkmcnt(2)
    v_mfma_f32_16x16x32_bf16 v[104:107], a[148:151], a[28:31], v[104:107]
    ds_read_b128 a[164:167], v136 offset:18432
    v_mfma_f32_16x16x32_bf16 v[108:111], a[148:151], a[100:103], v[108:111]
    v_mul_f32 v159, v151, v179
    v_mfma_f32_16x16x32_bf16 v[112:115], a[152:155], a[28:31], v[112:115]
    ds_read_b128 a[168:171], v136 offset:19456
    buffer_load_dwordx4 v1, s[32:35], s66 offen offset:3072 lds
    v_mfma_f32_16x16x32_bf16 v[116:119], a[152:155], a[100:103], v[116:119]
    v_mul_f32 v160, v150, v180
    s_waitcnt lgkmcnt(2)
    v_mfma_f32_16x16x32_bf16 v[104:107], a[156:159], a[32:35], v[104:107]
    ds_read_b128 a[172:175], v136 offset:20480
    v_mul_f32 v161, v150, v181
    v_mfma_f32_16x16x32_bf16 v[108:111], a[156:159], a[104:107], v[108:111]
    v_mfma_f32_16x16x32_bf16 v[112:115], a[160:163], a[32:35], v[112:115]
    ds_read_b128 a[176:179], v136 offset:21504
    s_add_u32 m0, s67, 8192
    s_add_u32 s66, s66, 4096
    buffer_load_dwordx4 v1, s[32:35], s66 offen lds
    v_mfma_f32_16x16x32_bf16 v[116:119], a[160:163], a[104:107], v[116:119]
    v_mul_f32 v162, v150, v182
    s_waitcnt lgkmcnt(2)
    v_mfma_f32_16x16x32_bf16 v[104:107], a[164:167], a[36:39], v[104:107]
    ds_read_b128 a[180:183], v136 offset:22528
    v_mul_f32 v163, v150, v183
    v_mfma_f32_16x16x32_bf16 v[108:111], a[164:167], a[108:111], v[108:111]
    v_mfma_f32_16x16x32_bf16 v[112:115], a[168:171], a[36:39], v[112:115]
    ds_read_b128 a[184:187], v136 offset:23552
    buffer_load_dwordx4 v1, s[32:35], s66 offen offset:1024 lds
    v_mfma_f32_16x16x32_bf16 v[116:119], a[168:171], a[108:111], v[116:119]
    v_mul_f32 v164, v151, v180
    s_waitcnt lgkmcnt(2)
    v_mfma_f32_16x16x32_bf16 v[104:107], a[172:175], a[40:43], v[104:107]
    ds_read_b128 a[188:191], v136 offset:24576
    v_mul_f32 v165, v151, v181
    v_mfma_f32_16x16x32_bf16 v[108:111], a[172:175], a[112:115], v[108:111]
    v_mfma_f32_16x16x32_bf16 v[112:115], a[176:179], a[40:43], v[112:115]
    ds_read_b128 a[192:195], v136 offset:25600
    v_mul_f32 v166, v151, v182
    v_mfma_f32_16x16x32_bf16 v[116:119], a[176:179], a[112:115], v[116:119]
    buffer_load_dwordx4 v1, s[32:35], s66 offen offset:2048 lds
    s_waitcnt lgkmcnt(2)
    v_mfma_f32_16x16x32_bf16 v[104:107], a[180:183], a[44:47], v[104:107]
    ds_read_b128 a[144:147], v136 offset:26624
    v_mul_f32 v167, v151, v183
    v_mfma_f32_16x16x32_bf16 v[108:111], a[180:183], a[116:119], v[108:111]
    v_add_u32 v38, 0, v1
    v_mfma_f32_16x16x32_bf16 v[112:115], a[184:187], a[44:47], v[112:115]
    ds_read_b128 a[148:151], v136 offset:27648
    v_mfma_f32_16x16x32_bf16 v[116:119], a[184:187], a[116:119], v[116:119]
    buffer_load_dwordx4 v1, s[32:35], s66 offen offset:3072 lds
    s_waitcnt lgkmcnt(2)
    v_mfma_f32_16x16x32_bf16 v[104:107], a[188:191], a[48:51], v[104:107]
    ds_read_b128 a[152:155], v136 offset:28672
    v_add_u32 v39, 63488, v1
    v_mfma_f32_16x16x32_bf16 v[108:111], a[188:191], a[120:123], v[108:111]
    v_mov_b32 v193, 0
    v_mfma_f32_16x16x32_bf16 v[112:115], a[192:195], a[48:51], v[112:115]
    ds_read_b128 a[156:159], v136 offset:29696
    v_mfma_f32_16x16x32_bf16 v[116:119], a[192:195], a[120:123], v[116:119]
    s_add_u32 m0, s67, 12288
    s_add_u32 s66, s66, 4096
    buffer_load_dwordx4 v1, s[32:35], s66 offen lds
    s_waitcnt lgkmcnt(2)
    v_mfma_f32_16x16x32_bf16 v[104:107], a[144:147], a[52:55], v[104:107]
    ds_read_b128 a[160:163], v136 offset:30720
    v_mov_b32 v194, 0
    v_mfma_f32_16x16x32_bf16 v[108:111], a[144:147], a[124:127], v[108:111]
    v_mov_b32 v195, 0
    v_mfma_f32_16x16x32_bf16 v[112:115], a[148:151], a[52:55], v[112:115]
    ds_read_b128 a[164:167], v136 offset:31744
    v_mfma_f32_16x16x32_bf16 v[116:119], a[148:151], a[124:127], v[116:119]
    v_mov_b32 v196, 0
    s_waitcnt lgkmcnt(2)
    v_mfma_f32_16x16x32_bf16 v[104:107], a[152:155], a[56:59], v[104:107]
    ds_read_b128 a[168:171], v136 offset:32768
    buffer_load_dwordx4 v[224:227], v21, s[32:35], s52 offen offset:0 sc1
    v_mfma_f32_16x16x32_bf16 v[108:111], a[152:155], a[128:131], v[108:111]
    v_mov_b32 v198, 0
    v_mfma_f32_16x16x32_bf16 v[112:115], a[156:159], a[56:59], v[112:115]
    ds_read_b128 a[172:175], v136 offset:33792
    buffer_load_dwordx4 v[228:231], v21, s[32:35], s52 offen offset:256 sc1
    v_mfma_f32_16x16x32_bf16 v[116:119], a[156:159], a[128:131], v[116:119]
    v_mov_b32 v199, 0
    s_waitcnt lgkmcnt(2)
    v_mfma_f32_16x16x32_bf16 v[104:107], a[160:163], a[60:63], v[104:107]
    ds_read_b128 a[176:179], v136 offset:34816
    s_add_u32 s56, s52, 7168
    buffer_load_dwordx4 v[232:235], v21, s[32:35], s56 offen offset:0 sc1
    v_mfma_f32_16x16x32_bf16 v[108:111], a[160:163], a[132:135], v[108:111]
    v_cndmask_b32 v192, 0, v30, s[70:71]
    v_mfma_f32_16x16x32_bf16 v[112:115], a[164:167], a[60:63], v[112:115]
    ds_read_b128 a[180:183], v136 offset:35840
    buffer_load_dwordx4 v[236:239], v21, s[32:35], s56 offen offset:256 sc1
    v_mfma_f32_16x16x32_bf16 v[116:119], a[164:167], a[132:135], v[116:119]
    v_cndmask_b32 v197, 0, v31, s[70:71]
    s_waitcnt lgkmcnt(2)
    v_mfma_f32_16x16x32_bf16 v[104:107], a[168:171], a[64:67], v[104:107]
    s_add_u32 s56, s52, 14336
    buffer_load_dwordx4 v[240:243], v21, s[32:35], s56 offen offset:0 sc1
    v_mfma_f32_16x16x32_bf16 v[108:111], a[168:171], a[136:139], v[108:111]
    v_mov_b32 v206, 0
    v_mfma_f32_16x16x32_bf16 v[112:115], a[172:175], a[64:67], v[112:115]
    buffer_load_dwordx4 v[244:247], v21, s[32:35], s56 offen offset:256 sc1
    v_mov_b32 v207, 0
    v_mfma_f32_16x16x32_bf16 v[116:119], a[172:175], a[136:139], v[116:119]
    s_waitcnt lgkmcnt(0)
    v_mfma_f32_16x16x32_bf16 v[104:107], a[176:179], a[68:71], v[104:107]
    s_add_u32 s56, s52, 21504
    buffer_load_dwordx4 v[248:251], v21, s[32:35], s56 offen offset:0 sc1
    v_mfma_f32_16x16x32_bf16 v[108:111], a[176:179], a[140:143], v[108:111]
    v_mov_b32 v214, 0
    v_mfma_f32_16x16x32_bf16 v[112:115], a[180:183], a[68:71], v[112:115]
    buffer_load_dwordx4 v[252:255], v21, s[32:35], s56 offen offset:256 sc1
    v_mov_b32 v215, 0
    v_mfma_f32_16x16x32_bf16 v[116:119], a[180:183], a[140:143], v[116:119]
    v_pk_fma_f32 v[104:105], v[104:105], v[148:149], v[152:153] op_sel:[0,0,0] op_sel_hi:[1,0,1]
    buffer_load_dwordx4 v1, s[32:35], s66 offen offset:1024 lds
    v_pk_fma_f32 v[106:107], v[106:107], v[148:149], v[154:155] op_sel:[0,0,0] op_sel_hi:[1,0,1]
    v_pk_fma_f32 v[108:109], v[108:109], v[148:149], v[156:157] op_sel:[0,1,0] op_sel_hi:[1,1,1]
    v_pk_fma_f32 v[110:111], v[110:111], v[148:149], v[158:159] op_sel:[0,1,0] op_sel_hi:[1,1,1]
    v_exp_f32 v26, v104 clamp
    v_exp_f32 v27, v105 clamp
    v_max_f32 v104, 0x35c1a2a0, v104
    v_max_f32 v105, 0x35c1a2a0, v105
    v_pk_fma_f32 v[104:105], v[104:105], s[90:91], v[26:27] op_sel:[0,0,0] op_sel_hi:[1,0,1]
    v_exp_f32 v26, v106 clamp
    v_exp_f32 v27, v107 clamp
    v_max_f32 v106, 0x35c1a2a0, v106
    v_max_f32 v107, 0x35c1a2a0, v107
    v_pk_fma_f32 v[106:107], v[106:107], s[90:91], v[26:27] op_sel:[0,0,0] op_sel_hi:[1,0,1]
    v_exp_f32 v26, v108 clamp
    v_exp_f32 v27, v109 clamp
    s_mul_i32 s67, s38, 7168
    s_min_u32 s67, s67, 18432
    s_add_u32 s66, s67, s89
    s_add_u32 m0, s67, 63488
    s_add_u32 s66, s66, 46194688
    buffer_load_dwordx4 v1, s[32:35], s66 offen lds
    v_max_f32 v108, 0x35c1a2a0, v108
    v_max_f32 v109, 0x35c1a2a0, v109
    v_pk_fma_f32 v[108:109], v[108:109], s[90:91], v[26:27] op_sel:[0,0,0] op_sel_hi:[1,0,1]
    v_exp_f32 v26, v110 clamp
    v_exp_f32 v27, v111 clamp
    v_max_f32 v110, 0x35c1a2a0, v110
    v_max_f32 v111, 0x35c1a2a0, v111
    v_pk_fma_f32 v[110:111], v[110:111], s[90:91], v[26:27] op_sel:[0,0,0] op_sel_hi:[1,0,1]
    v_cvt_pk_bf16_f32 v184, v104, v105
    v_cvt_pk_bf16_f32 v186, v108, v109
    v_cvt_pk_bf16_f32 v185, v106, v107
    v_cvt_pk_bf16_f32 v187, v110, v111
    v_pk_fma_f32 v[112:113], v[112:113], v[148:149], v[160:161] op_sel:[0,0,0] op_sel_hi:[1,0,1]
    v_pk_fma_f32 v[114:115], v[114:115], v[148:149], v[162:163] op_sel:[0,0,0] op_sel_hi:[1,0,1]
    v_pk_fma_f32 v[116:117], v[116:117], v[148:149], v[164:165] op_sel:[0,1,0] op_sel_hi:[1,1,1]
    buffer_load_dwordx4 v1, s[32:35], s66 offen offset:1024 lds
    v_pk_fma_f32 v[118:119], v[118:119], v[148:149], v[166:167] op_sel:[0,1,0] op_sel_hi:[1,1,1]
    v_exp_f32 v26, v112 clamp
    v_exp_f32 v27, v113 clamp
    v_max_f32 v112, 0x35c1a2a0, v112
    v_max_f32 v113, 0x35c1a2a0, v113
    v_pk_fma_f32 v[112:113], v[112:113], s[90:91], v[26:27] op_sel:[0,0,0] op_sel_hi:[1,0,1]
    v_exp_f32 v26, v114 clamp
    v_exp_f32 v27, v115 clamp
    v_max_f32 v114, 0x35c1a2a0, v114
    v_max_f32 v115, 0x35c1a2a0, v115
    v_pk_fma_f32 v[114:115], v[114:115], s[90:91], v[26:27] op_sel:[0,0,0] op_sel_hi:[1,0,1]
    v_exp_f32 v26, v116 clamp
    v_exp_f32 v27, v117 clamp
    v_max_f32 v116, 0x35c1a2a0, v116
    v_max_f32 v117, 0x35c1a2a0, v117
    buffer_load_dwordx4 v1, s[32:35], s66 offen offset:2048 lds
    v_pk_fma_f32 v[116:117], v[116:117], s[90:91], v[26:27] op_sel:[0,0,0] op_sel_hi:[1,0,1]
    v_exp_f32 v26, v118 clamp
    v_exp_f32 v27, v119 clamp
    v_max_f32 v118, 0x35c1a2a0, v118
    v_max_f32 v119, 0x35c1a2a0, v119
    v_pk_fma_f32 v[118:119], v[118:119], s[90:91], v[26:27] op_sel:[0,0,0] op_sel_hi:[1,0,1]
    v_cvt_pk_bf16_f32 v188, v112, v113
    v_cvt_pk_bf16_f32 v190, v116, v117
    v_cvt_pk_bf16_f32 v189, v114, v115
    v_cvt_pk_bf16_f32 v191, v118, v119
    v_permlane16_swap_b32 v184, v186
    v_permlane16_swap_b32 v185, v187
    v_permlane16_swap_b32 v188, v190
    v_permlane16_swap_b32 v189, v191
    s_waitcnt vmcnt(11)
    v_mfma_f32_16x16x32_bf16 v[28:31], a[248:251], v[224:227], 0
    s_waitcnt vmcnt(10)
    v_mfma_f32_16x16x32_bf16 v[28:31], a[252:255], v[228:231], v[28:31]
    buffer_load_dwordx4 v1, s[32:35], s66 offen offset:3072 lds
    s_waitcnt vmcnt(10)
    v_mfma_f32_16x16x32_bf16 v[28:31], a[248:251], v[232:235], v[28:31]
    s_add_u32 m0, s67, 67584
    s_add_u32 s66, s66, 4096
    buffer_load_dwordx4 v1, s[32:35], s66 offen lds
    s_waitcnt vmcnt(10)
    v_mfma_f32_16x16x32_bf16 v[28:31], a[252:255], v[236:239], v[28:31]
    buffer_load_dwordx4 v1, s[32:35], s66 offen offset:1024 lds
    s_waitcnt vmcnt(10)
    v_mfma_f32_16x16x32_bf16 v[28:31], a[248:251], v[240:243], v[28:31]
    s_waitcnt vmcnt(9)
    v_mfma_f32_16x16x32_bf16 v[28:31], a[252:255], v[244:247], v[28:31]
    buffer_load_dwordx4 v1, s[32:35], s66 offen offset:2048 lds
    s_waitcnt vmcnt(9)
    v_mfma_f32_16x16x32_bf16 v[28:31], a[248:251], v[248:251], v[28:31]
    buffer_load_dword v42, v43, s[32:35], 0 offen sc1
    s_waitcnt vmcnt(9)
    v_mfma_f32_16x16x32_bf16 v[28:31], a[252:255], v[252:255], v[28:31]
    buffer_load_dword v42, v2, s[24:27], 0 offen sc1
chk_15:
    s_sub_u32 s43, s43, 1
    s_cselect_b64 s[68:69], 0, -1
    s_max_i32 s43, s43, 0
    s_nop 3
    v_cmp_u_f32 vcc, v28, v28
    v_cvt_pk_bf16_f32 v32, v28, v29
    v_cvt_pk_bf16_f32 v33, v30, v31
    s_and_b64 vcc, vcc, s[68:69]
    s_cbranch_scc0 ok_17
    s_nop 0
    buffer_load_dwordx4 v[224:227], v21, s[32:35], s52 offen offset:0 sc1
    buffer_load_dwordx4 v[228:231], v21, s[32:35], s52 offen offset:256 sc1
    s_add_u32 s56, s52, 7168
    buffer_load_dwordx4 v[232:235], v21, s[32:35], s56 offen offset:0 sc1
    buffer_load_dwordx4 v[236:239], v21, s[32:35], s56 offen offset:256 sc1
    s_add_u32 s56, s52, 14336
    buffer_load_dwordx4 v[240:243], v21, s[32:35], s56 offen offset:0 sc1
    buffer_load_dwordx4 v[244:247], v21, s[32:35], s56 offen offset:256 sc1
    s_add_u32 s56, s52, 21504
    buffer_load_dwordx4 v[248:251], v21, s[32:35], s56 offen offset:0 sc1
    buffer_load_dwordx4 v[252:255], v21, s[32:35], s56 offen offset:256 sc1
    s_waitcnt vmcnt(0)
    v_mfma_f32_16x16x32_bf16 v[28:31], a[248:251], v[224:227], 0
    v_mfma_f32_16x16x32_bf16 v[28:31], a[252:255], v[228:231], v[28:31]
    v_mfma_f32_16x16x32_bf16 v[28:31], a[248:251], v[232:235], v[28:31]
    v_mfma_f32_16x16x32_bf16 v[28:31], a[252:255], v[236:239], v[28:31]
    v_mfma_f32_16x16x32_bf16 v[28:31], a[248:251], v[240:243], v[28:31]
    v_mfma_f32_16x16x32_bf16 v[28:31], a[252:255], v[244:247], v[28:31]
    v_mfma_f32_16x16x32_bf16 v[28:31], a[248:251], v[248:251], v[28:31]
    v_mfma_f32_16x16x32_bf16 v[28:31], a[252:255], v[252:255], v[28:31]
    s_nop 7
    s_branch chk_15
ok_17:
    ds_write_b64 v10, v[32:33]
    s_add_u32 s52, s52, 28672
    s_add_u32 s51, s51, 28672
    s_waitcnt lgkmcnt(0)
    s_barrier
    ds_read2_b64 v[200:203], v6 offset1:16
    ds_read_b64 v[204:205], v8
    ds_read2_b64 v[208:211], v7 offset1:16
    ds_read_b64 v[212:213], v9
    s_waitcnt lgkmcnt(3)
    v_mfma_f32_32x32x16_bf16 v[224:239], v[200:203], v[184:187], 0
    s_waitcnt lgkmcnt(2)
    v_mfma_f32_32x32x16_bf16 v[224:239], v[204:207], v[192:195], v[224:239]
    s_waitcnt lgkmcnt(1)
    v_mfma_f32_32x32x16_bf16 v[240:255], v[208:211], v[188:191], 0
    s_waitcnt lgkmcnt(0)
    v_mfma_f32_32x32x16_bf16 v[240:255], v[212:215], v[196:199], v[240:255]
    s_nop 7
    v_add_f32 v236, 0x358637bd, v236
    v_rcp_f32 v238, v236
    v_mov_b32 v24, s44
    v_pk_mul_f32 v[224:225], v[224:225], v[238:239] op_sel_hi:[1,0]
    v_pk_mul_f32 v[226:227], v[226:227], v[238:239] op_sel_hi:[1,0]
    v_pk_mul_f32 v[228:229], v[228:229], v[238:239] op_sel_hi:[1,0]
    v_pk_mul_f32 v[230:231], v[230:231], v[238:239] op_sel_hi:[1,0]
    v_pk_mul_f32 v[232:233], v[232:233], v[238:239] op_sel_hi:[1,0]
    v_cvt_pk_bf16_f32 v28, v224, v225
    v_cvt_pk_bf16_f32 v29, v226, v227
    v_cvt_pk_bf16_f32 v30, v228, v229
    v_cvt_pk_bf16_f32 v31, v230, v231
    v_cvt_pk_bf16_f32 v36, v232, v233
    v_add_f32 v252, 0x358637bd, v252
    v_rcp_f32 v254, v252
    v_mov_b32 v24, s44
    v_pk_mul_f32 v[240:241], v[240:241], v[254:255] op_sel_hi:[1,0]
    v_pk_mul_f32 v[242:243], v[242:243], v[254:255] op_sel_hi:[1,0]
    v_pk_mul_f32 v[244:245], v[244:245], v[254:255] op_sel_hi:[1,0]
    v_pk_mul_f32 v[246:247], v[246:247], v[254:255] op_sel_hi:[1,0]
    v_pk_mul_f32 v[250:251], v[250:251], v[254:255] op_sel_hi:[1,0]
    v_cvt_pk_bf16_f32 v32, v240, v241
    v_cvt_pk_bf16_f32 v33, v242, v243
    v_cvt_pk_bf16_f32 v34, v244, v245
    v_cvt_pk_bf16_f32 v35, v246, v247
    v_cvt_pk_bf16_f32 v37, v250, v251
    s_cmp_eq_u32 s41, 0
    s_cbranch_scc1 slow_18
    buffer_store_dwordx4 v[28:31], v14, s[32:35], s47 offen
    buffer_store_dwordx4 v[32:35], v14, s[32:35], s47 offen offset:512
    buffer_store_dwordx2 v[36:37], v15, s[32:35], s47 offen
join_19:
    s_waitcnt vmcnt(5)
    s_barrier
    ds_read_b128 a[0:3], v38 offset:0
    ds_read_b128 a[4:7], v38 offset:1024
    ds_read_b128 a[8:11], v38 offset:2048
    ds_read_b128 a[12:15], v38 offset:3072
    ds_read_b128 a[16:19], v39 offset:16384
    ds_read_b128 a[20:23], v38 offset:4096
    ds_read_b128 a[24:27], v38 offset:5120
    ds_read_b128 a[28:31], v38 offset:6144
    ds_read_b128 a[32:35], v38 offset:7168
    ds_read_b128 a[36:39], v38 offset:8192
    ds_read_b128 a[40:43], v38 offset:9216
    ds_read_b128 a[44:47], v38 offset:10240
    ds_read_b128 a[48:51], v38 offset:11264
    ds_read_b128 a[52:55], v39 offset:17408
    ds_read_b128 a[56:59], v38 offset:12288
    ds_read_b128 a[60:63], v38 offset:13312
    ds_read_b128 a[64:67], v38 offset:14336
    ds_read_b128 a[68:71], v38 offset:15360
    ds_read_b128 a[72:75], v38 offset:16384
    ds_read_b128 a[76:79], v38 offset:17408
    s_cmp_eq_u32 s41, 0
    s_cbranch_scc1 slow_20
    s_waitcnt vmcnt(0)
    buffer_store_dword v24, v23, s[32:35], s50 offen
join_21:
L_mark0:
    ds_read_b128 a[80:83], v38 offset:18432
    s_lshl_b32 s64, s38, 11
    s_add_u32 s64, s64, s75
    s_add_u32 s64, s64, 25513984
    buffer_load_dwordx4 v[26:29], v1, s[32:35], s64 offen offset:0 sc1
    ds_read_b128 a[84:87], v38 offset:19456
    ds_read_b128 a[88:91], v39 offset:18432
    buffer_load_dwordx4 v[30:33], v1, s[32:35], s64 offen offset:1024 sc1
    ds_read_b128 a[92:95], v38 offset:20480
    ds_read_b128 a[96:99], v38 offset:21504
    ds_read_b128 a[100:103], v38 offset:22528
    s_mul_i32 s67, s38, 14336
    s_add_u32 s66, s67, s75
    s_add_u32 m0, s67, 100352
    s_add_u32 s66, s66, 25401600
    buffer_load_dwordx4 v1, s[32:35], s66 offen lds
    ds_read_b128 a[104:107], v38 offset:23552
    ds_read_b128 a[108:111], v38 offset:24576
    buffer_load_dwordx4 v1, s[32:35], s66 offen offset:1024 lds
    ds_read_b128 a[112:115], v38 offset:25600
    ds_read_b128 a[116:119], v38 offset:26624
    ds_read_b128 a[120:123], v38 offset:27648
    buffer_load_dwordx4 v1, s[32:35], s66 offen offset:2048 lds
    ds_read_b128 a[124:127], v39 offset:19456
    ds_read_b128 a[128:131], v38 offset:28672
    buffer_load_dwordx4 v1, s[32:35], s66 offen offset:3072 lds
    ds_read_b128 a[132:135], v38 offset:29696
    ds_read_b128 a[136:139], v38 offset:30720
    ds_read_b128 a[140:143], v38 offset:31744
    s_add_u32 m0, s67, 104448
    s_add_u32 s66, s66, 4096
    buffer_load_dwordx4 v1, s[32:35], s66 offen lds
    ds_read_b128 a[144:147], v38 offset:32768
    ds_read_b128 a[148:151], v38 offset:33792
    buffer_load_dwordx4 v1, s[32:35], s66 offen offset:1024 lds
    ds_read_b128 a[152:155], v38 offset:34816
    ds_read_b128 a[156:159], v38 offset:35840
    s_add_u32 s57, s48, 4096
    s_add_u32 s58, s48, 8192
    s_add_u32 s59, s48, 12288
    s_add_u32 s60, s48, 16384
poll_22:
    buffer_load_dword v24, v17, s[32:35], 0 offen sc1
    s_sub_u32 s43, s43, 1
    s_cselect_b64 s[68:69], 0, -1
    s_max_i32 s43, s43, 0
    s_waitcnt vmcnt(0)
    v_cmp_ne_u32 vcc, s44, v24
    s_and_b64 vcc, vcc, s[68:69]
    s_cbranch_scc1 poll_22
    buffer_load_dwordx4 v[184:187], v1, s[32:35], s48 offen offset:0 sc1
    ds_read_b128 a[160:163], v39 offset:20480
    ds_read_b128 a[164:167], v38 offset:36864
    ds_read_b128 a[168:171], v38 offset:37888
    buffer_load_dwordx4 v[188:191], v1, s[32:35], s48 offen offset:1024 sc1
    ds_read_b128 a[172:175], v38 offset:38912
    ds_read_b128 a[176:179], v38 offset:39936
    ds_read_b128 a[180:183], v38 offset:40960
    buffer_load_dwordx4 v[192:195], v1, s[32:35], s48 offen offset:2048 sc1
    ds_read_b128 a[184:187], v38 offset:41984
    ds_read_b128 a[188:191], v38 offset:43008
    ds_read_b128 a[192:195], v38 offset:44032
    buffer_load_dwordx4 v[196:199], v1, s[32:35], s48 offen offset:3072 sc1
    ds_read_b128 v[68:71], v39 offset:21504
    ds_read_b128 v[72:75], v38 offset:45056
    ds_read_b128 v[76:79], v38 offset:46080
    buffer_load_dwordx4 v[200:203], v1, s[32:35], s57 offen offset:0 sc1
    ds_read_b128 v[80:83], v38 offset:47104
    ds_read_b128 v[84:87], v38 offset:48128
    ds_read_b128 v[88:91], v38 offset:49152
    buffer_load_dwordx4 v[204:207], v1, s[32:35], s57 offen offset:1024 sc1
    ds_read_b128 v[92:95], v38 offset:50176
    ds_read_b128 v[96:99], v38 offset:51200
    ds_read_b128 v[100:103], v38 offset:52224
    buffer_load_dwordx4 v[208:211], v1, s[32:35], s57 offen offset:2048 sc1
    ds_read_b128 v[104:107], v39 offset:22528
    ds_read_b128 v[108:111], v38 offset:53248
    s_waitcnt vmcnt(6) lgkmcnt(15)
    v_mfma_f32_16x16x32_bf16 v[44:47], a[0:3], v[184:187], v[44:47]
    buffer_load_dwordx4 v[212:215], v1, s[32:35], s57 offen offset:3072 sc1
    ds_read_b128 v[112:115], v38 offset:54272
    v_mfma_f32_16x16x32_bf16 v[48:51], a[4:7], v[184:187], v[48:51]
    v_mfma_f32_16x16x32_bf16 v[52:55], a[8:11], v[184:187], v[52:55]
    ds_read_b128 v[116:119], v38 offset:55296
    v_mfma_f32_16x16x32_bf16 v[56:59], a[12:15], v[184:187], v[56:59]
    v_mfma_f32_16x16x32_bf16 v[60:63], a[16:19], v[184:187], v[60:63]
    buffer_load_dwordx4 v[216:219], v1, s[32:35], s58 offen offset:0 sc1
    s_waitcnt vmcnt(7)
    v_mfma_f32_16x16x32_bf16 v[44:47], a[20:23], v[188:191], v[44:47]
    ds_read_b128 v[120:123], v38 offset:56320
    v_mfma_f32_16x16x32_bf16 v[48:51], a[24:27], v[188:191], v[48:51]
    v_mfma_f32_16x16x32_bf16 v[52:55], a[28:31], v[188:191], v[52:55]
    v_mfma_f32_16x16x32_bf16 v[56:59], a[32:35], v[188:191], v[56:59]
    buffer_load_dwordx4 v[220:223], v1, s[32:35], s58 offen offset:1024 sc1
    ds_read_b128 v[124:127], v39 offset:0
    v_mfma_f32_16x16x32_bf16 v[64:67], a[16:19], v[188:191], 0
    s_waitcnt vmcnt(7)
    v_mfma_f32_16x16x32_bf16 v[44:47], a[36:39], v[192:195], v[44:47]
    v_mfma_f32_16x16x32_bf16 v[48:51], a[40:43], v[192:195], v[48:51]
    ds_read_b128 v[128:131], v39 offset:1024
    v_mfma_f32_16x16x32_bf16 v[52:55], a[44:47], v[192:195], v[52:55]
    buffer_load_dwordx4 v[224:227], v1, s[32:35], s58 offen offset:2048 sc1
    v_mfma_f32_16x16x32_bf16 v[56:59], a[48:51], v[192:195], v[56:59]
    v_mfma_f32_16x16x32_bf16 v[60:63], a[52:55], v[192:195], v[60:63]
    ds_read_b128 v[132:135], v39 offset:2048
    s_waitcnt vmcnt(7)
    v_mfma_f32_16x16x32_bf16 v[44:47], a[56:59], v[196:199], v[44:47]
    v_mfma_f32_16x16x32_bf16 v[48:51], a[60:63], v[196:199], v[48:51]
    buffer_load_dwordx4 v[228:231], v1, s[32:35], s58 offen offset:3072 sc1
    v_mfma_f32_16x16x32_bf16 v[52:55], a[64:67], v[196:199], v[52:55]
    ds_read_b128 v[136:139], v39 offset:3072
    v_mfma_f32_16x16x32_bf16 v[56:59], a[68:71], v[196:199], v[56:59]
    v_mfma_f32_16x16x32_bf16 v[64:67], a[52:55], v[196:199], v[64:67]
    s_waitcnt vmcnt(7)
    v_mfma_f32_16x16x32_bf16 v[44:47], a[72:75], v[200:203], v[44:47]
    buffer_load_dwordx4 v[232:235], v1, s[32:35], s59 offen offset:0 sc1
    ds_read_b128 v[140:143], v39 offset:23552
    v_mfma_f32_16x16x32_bf16 v[48:51], a[76:79], v[200:203], v[48:51]
    v_add_f32 v26, v26, v30
    v_mfma_f32_16x16x32_bf16 v[52:55], a[80:83], v[200:203], v[52:55]
    v_mfma_f32_16x16x32_bf16 v[56:59], a[84:87], v[200:203], v[56:59]
    ds_read_b128 v[144:147], v39 offset:4096
    v_mfma_f32_16x16x32_bf16 v[60:63], a[88:91], v[200:203], v[60:63]
    buffer_load_dwordx4 v[236:239], v1, s[32:35], s59 offen offset:1024 sc1
    s_waitcnt vmcnt(8)
    v_mfma_f32_16x16x32_bf16 v[44:47], a[92:95], v[204:207], v[44:47]
    v_add_f32 v27, v27, v31
    v_mfma_f32_16x16x32_bf16 v[48:51], a[96:99], v[204:207], v[48:51]
    ds_read_b128 v[148:151], v39 offset:5120
    v_mfma_f32_16x16x32_bf16 v[52:55], a[100:103], v[204:207], v[52:55]
    v_mfma_f32_16x16x32_bf16 v[56:59], a[104:107], v[204:207], v[56:59]
    buffer_load_dwordx4 v[240:243], v1, s[32:35], s59 offen offset:2048 sc1
    v_mfma_f32_16x16x32_bf16 v[64:67], a[88:91], v[204:207], v[64:67]
    ds_read_b128 v[152:155], v39 offset:6144
    s_waitcnt vmcnt(8)
    v_mfma_f32_16x16x32_bf16 v[44:47], a[108:111], v[208:211], v[44:47]
    v_mfma_f32_16x16x32_bf16 v[48:51], a[112:115], v[208:211], v[48:51]
    v_add_f32 v28, v28, v32
    v_mfma_f32_16x16x32_bf16 v[52:55], a[116:119], v[208:211], v[52:55]
    buffer_load_dwordx4 v[244:247], v1, s[32:35], s59 offen offset:3072 sc1
    ds_read_b128 v[156:159], v39 offset:7168
    v_mfma_f32_16x16x32_bf16 v[56:59], a[120:123], v[208:211], v[56:59]
    v_mfma_f32_16x16x32_bf16 v[60:63], a[124:127], v[208:211], v[60:63]
    s_waitcnt vmcnt(8)
    v_mfma_f32_16x16x32_bf16 v[44:47], a[128:131], v[212:215], v[44:47]
    ds_read_b128 v[160:163], v39 offset:8192
    v_mfma_f32_16x16x32_bf16 v[48:51], a[132:135], v[212:215], v[48:51]
    buffer_load_dwordx4 v[248:251], v1, s[32:35], s60 offen offset:0 sc1
    v_mfma_f32_16x16x32_bf16 v[52:55], a[136:139], v[212:215], v[52:55]
    v_add_f32 v29, v29, v33
    v_mfma_f32_16x16x32_bf16 v[56:59], a[140:143], v[212:215], v[56:59]
    ds_read_b128 v[164:167], v39 offset:9216
    v_mfma_f32_16x16x32_bf16 v[64:67], a[124:127], v[212:215], v[64:67]
    s_waitcnt vmcnt(8)
    v_mfma_f32_16x16x32_bf16 v[44:47], a[144:147], v[216:219], v[44:47]
    buffer_load_dwordx4 v[252:255], v1, s[32:35], s60 offen offset:1024 sc1
    s_add_u32 s47, s47, s3
    v_mfma_f32_16x16x32_bf16 v[48:51], a[148:151], v[216:219], v[48:51]
    ds_read_b128 v[168:171], v39 offset:10240
    v_mfma_f32_16x16x32_bf16 v[52:55], a[152:155], v[216:219], v[52:55]
    s_lshl_b32 s65, s38, 10
    s_add_u32 s65, s65, 57344
    v_mfma_f32_16x16x32_bf16 v[56:59], a[156:159], v[216:219], v[56:59]
    s_add_u32 s44, s44, 1
    v_mfma_f32_16x16x32_bf16 v[60:63], a[160:163], v[216:219], v[60:63]
    ds_read_b128 v[172:175], v39 offset:11264
    s_mul_i32 s67, s38, 14336
    s_add_u32 s66, s67, s75
    s_add_u32 m0, s67, 106496
    s_add_u32 s66, s66, 25407744
    buffer_load_dwordx4 v1, s[32:35], s66 offen lds
    s_waitcnt vmcnt(9)
    v_mfma_f32_16x16x32_bf16 v[44:47], a[164:167], v[220:223], v[44:47]
    s_cmp_eq_u32 s41, 0
    s_cselect_b32 s61, s46, s54
    v_mfma_f32_16x16x32_bf16 v[48:51], a[168:171], v[220:223], v[48:51]
    v_mfma_f32_16x16x32_bf16 v[52:55], a[172:175], v[220:223], v[52:55]
    ds_read_b128 v[176:179], v39 offset:24576
    buffer_load_dwordx4 v1, s[32:35], s66 offen offset:1024 lds
    v_mfma_f32_16x16x32_bf16 v[56:59], a[176:179], v[220:223], v[56:59]
    v_add_u32 v30, s65, v1
    v_mfma_f32_16x16x32_bf16 v[64:67], a[160:163], v[220:223], v[64:67]
    s_waitcnt vmcnt(9) lgkmcnt(15)
    v_mfma_f32_16x16x32_bf16 v[44:47], a[180:183], v[224:227], v[44:47]
    ds_read_b128 v[180:183], v39 offset:12288
    buffer_load_dwordx4 v1, s[32:35], s66 offen offset:2048 lds
    v_mfma_f32_16x16x32_bf16 v[48:51], a[184:187], v[224:227], v[48:51]
    s_lshl_b32 s56, s39, 11
    s_add_u32 s56, s56, s61
    v_mfma_f32_16x16x32_bf16 v[52:55], a[188:191], v[224:227], v[52:55]
    s_mov_b32 s82, 0x22222222
    v_mfma_f32_16x16x32_bf16 v[56:59], a[192:195], v[224:227], v[56:59]
    ds_read_b128 a[0:3], v39 offset:13312
    buffer_load_dwordx4 v1, s[32:35], s66 offen offset:3072 lds
    v_mfma_f32_16x16x32_bf16 v[60:63], v[68:71], v[224:227], v[60:63]
    ds_write_b128 v30, v[26:29]
    s_waitcnt vmcnt(10)
    v_mfma_f32_16x16x32_bf16 v[44:47], v[72:75], v[228:231], v[44:47]
    s_mov_b32 s83, 0x22222222
    v_mfma_f32_16x16x32_bf16 v[48:51], v[76:79], v[228:231], v[48:51]
    ds_read_b128 a[4:7], v39 offset:14336
    s_mov_b32 s84, 0x44444444
    v_mfma_f32_16x16x32_bf16 v[52:55], v[80:83], v[228:231], v[52:55]
    s_add_u32 m0, s67, 110592
    s_add_u32 s66, s66, 4096
    buffer_load_dwordx4 v1, s[32:35], s66 offen lds
    v_mfma_f32_16x16x32_bf16 v[56:59], v[84:87], v[228:231], v[56:59]
    v_mfma_f32_16x16x32_bf16 v[64:67], v[68:71], v[228:231], v[64:67]
    ds_read_b128 a[8:11], v39 offset:15360
    s_waitcnt vmcnt(10)
    v_mfma_f32_16x16x32_bf16 v[44:47], v[88:91], v[232:235], v[44:47]
    buffer_load_dwordx4 v1, s[32:35], s66 offen offset:1024 lds
    s_mov_b32 s85, 0x44444444
    v_mfma_f32_16x16x32_bf16 v[48:51], v[92:95], v[232:235], v[48:51]
    v_mfma_f32_16x16x32_bf16 v[52:55], v[96:99], v[232:235], v[52:55]
    s_mov_b32 s86, 0x88888888
    v_mfma_f32_16x16x32_bf16 v[56:59], v[100:103], v[232:235], v[56:59]
    buffer_load_dwordx4 v1, s[32:35], s66 offen offset:2048 lds
    v_mfma_f32_16x16x32_bf16 v[60:63], v[104:107], v[232:235], v[60:63]
    s_waitcnt vmcnt(11) lgkmcnt(15)
    v_mfma_f32_16x16x32_bf16 v[44:47], v[108:111], v[236:239], v[44:47]
    s_mov_b32 s87, 0x88888888
    v_mfma_f32_16x16x32_bf16 v[48:51], v[112:115], v[236:239], v[48:51]
    buffer_load_dwordx4 v1, s[32:35], s66 offen offset:3072 lds
    v_mfma_f32_16x16x32_bf16 v[52:55], v[116:119], v[236:239], v[52:55]
    v_mfma_f32_16x16x32_bf16 v[56:59], v[120:123], v[236:239], v[56:59]
    v_mfma_f32_16x16x32_bf16 v[64:67], v[104:107], v[236:239], v[64:67]
    s_waitcnt vmcnt(8)
    s_waitcnt lgkmcnt(0)
    s_cmp_eq_u32 s41, 0
    s_cbranch_scc1 slow_23
    v_mfma_f32_16x16x32_bf16 v[60:63], v[140:143], v[240:243], v[60:63]
    v_mfma_f32_16x16x32_bf16 v[64:67], v[140:143], v[244:247], v[64:67]
    v_mfma_f32_16x16x32_bf16 v[60:63], v[176:179], v[248:251], v[60:63]
    v_mfma_f32_16x16x32_bf16 v[64:67], v[176:179], v[252:255], v[64:67]
    v_mov_b32 v194, 0
    v_mov_b32 v195, 0
    v_mfma_f32_16x16x32_bf16 v[44:47], v[124:127], v[240:243], v[44:47]
    v_mov_b32 v196, s74
    v_mov_b32 v197, s74
    v_mfma_f32_16x16x32_bf16 v[44:47], v[144:147], v[244:247], v[44:47]
    v_mov_b32 v198, s74
    v_mov_b32 v199, s74
    v_mfma_f32_16x16x32_bf16 v[44:47], v[160:163], v[248:251], v[44:47]
    v_permlane32_swap_b32 v64, v68
    v_permlane32_swap_b32 v65, v69
    v_mfma_f32_16x16x32_bf16 v[44:47], v[180:183], v[252:255], v[44:47]
    v_permlane32_swap_b32 v66, v70
    v_permlane32_swap_b32 v67, v71
    v_mfma_f32_16x16x32_bf16 v[48:51], v[128:131], v[240:243], v[48:51]
L_hop2:
    s_cbranch_execz L_hop6
    v_add_f32 v60, v60, v68
    v_mfma_f32_16x16x32_bf16 v[48:51], v[148:151], v[244:247], v[48:51]
    v_add_f32 v61, v61, v69
    v_add_f32 v62, v62, v70
    v_mfma_f32_16x16x32_bf16 v[48:51], v[164:167], v[248:251], v[48:51]
    v_add_f32 v63, v63, v71
    v_cvt_pk_bf16_f32 v192, v60, v61
    v_mfma_f32_16x16x32_bf16 v[48:51], a[0:3], v[252:255], v[48:51]
    v_cvt_pk_bf16_f32 v193, v62, v63
    v_mfma_f32_16x16x32_bf16 v[52:55], v[132:135], v[240:243], v[52:55]
    v_cndmask_b32 v192, 0, v192, s[70:71]
    v_cndmask_b32 v193, 0, v193, s[70:71]
    v_mfma_f32_16x16x32_bf16 v[52:55], v[152:155], v[244:247], v[52:55]
    buffer_store_dwordx2 v[192:193], v12, s[4:7], s61 offen
    v_cvt_pk_bf16_f32 v184, v44, v45
    v_mfma_f32_16x16x32_bf16 v[52:55], v[168:171], v[248:251], v[52:55]
    v_cvt_pk_bf16_f32 v185, v46, v47
    v_mfma_f32_16x16x32_bf16 v[52:55], a[4:7], v[252:255], v[52:55]
    v_cvt_pk_bf16_f32 v186, v48, v49
    v_mfma_f32_16x16x32_bf16 v[56:59], v[136:139], v[240:243], v[56:59]
    v_cvt_pk_bf16_f32 v187, v50, v51
    v_mfma_f32_16x16x32_bf16 v[56:59], v[156:159], v[244:247], v[56:59]
    buffer_store_dwordx4 v[184:187], v1, s[4:7], s56 offen offset:0
    v_mfma_f32_16x16x32_bf16 v[56:59], v[172:175], v[248:251], v[56:59]
    s_nop 1
    v_mfma_f32_16x16x32_bf16 v[56:59], a[8:11], v[252:255], v[56:59]
    v_cvt_pk_bf16_f32 v188, v52, v53
    v_mfma_f32_16x16x32_bf16 v[204:207], v[192:195], v[192:195], 0
    v_cvt_pk_bf16_f32 v189, v54, v55
    v_mfma_f32_16x16x32_bf16 v[200:203], v[196:199], v[192:195], 0
    s_nop 1
    v_mfma_f32_16x16x32_bf16 v[204:207], v[184:187], v[184:187], v[204:207]
    s_nop 1
    v_mfma_f32_16x16x32_bf16 v[200:203], v[196:199], v[184:187], v[200:203]
    v_cvt_pk_bf16_f32 v190, v56, v57
    v_cvt_pk_bf16_f32 v191, v58, v59
    s_nop 1
    v_mfma_f32_16x16x32_bf16 v[204:207], v[188:191], v[188:191], v[204:207]
    buffer_store_dwordx4 v[188:191], v1, s[4:7], s56 offen offset:1024
    v_mfma_f32_16x16x32_bf16 v[200:203], v[196:199], v[188:191], v[200:203]
    v_mov_b32 v26, s44
    s_nop 4
    v_cndmask_b32 v204, v204, v205, s[82:83]
    v_cndmask_b32 v204, v204, v206, s[84:85]
    v_cndmask_b32 v201, v204, v207, s[86:87]
    buffer_store_dwordx2 v[200:201], v13, s[32:35], s46 offen
    s_barrier
    s_mul_i32 s67, s38, 8192
    s_min_u32 s67, s67, 23552
    s_add_u32 s66, s67, s75
    s_add_u32 m0, s67, 0
    s_add_u32 s66, s66, 25370624
    buffer_load_dwordx4 v1, s[32:35], s66 offen lds
    buffer_load_dwordx4 v1, s[32:35], s66 offen offset:1024 lds
    buffer_load_dwordx4 v1, s[32:35], s66 offen offset:2048 lds
    s_waitcnt vmcnt(3)
    buffer_store_dword v26, v23, s[32:35], s49 offen
join_24:
    s_add_u32 s46, s46, s3
    s_add_u32 s48, s48, s3
    buffer_load_dwordx4 v1, s[32:35], s66 offen offset:3072 lds
    s_add_u32 m0, s67, 4096
    s_add_u32 s66, s66, 4096
    buffer_load_dwordx4 v1, s[32:35], s66 offen lds
    buffer_load_dwordx4 v1, s[32:35], s66 offen offset:1024 lds
    buffer_load_dwordx4 v1, s[32:35], s66 offen offset:2048 lds
    buffer_load_dwordx4 v1, s[32:35], s66 offen offset:3072 lds
    v_add_u32 v128, 100352, v1
    v_add_u32 v136, 63488, v1
    v_and_b32 v130, 15, v0
    v_min_u32 v130, 11, v130
    v_lshrrev_b32 v131, 4, v0
    v_mul_u32_u24 v131, 192, v131
    v_lshl_add_u32 v130, v130, 4, v131
    v_add_u32 v131, 100352, v130
    s_cmp_eq_u32 s41, 0
    s_cselect_b32 s94, s45, s94
    s_cselect_b32 s56, 1024, 0
    s_add_u32 s56, s56, 18432
    v_add_u32 v138, s56, v1
    s_add_u32 s57, s94, 4096
    s_add_u32 s58, s94, 8192
    s_add_u32 s59, s94, 12288
    s_add_u32 s60, s94, 16384
    s_add_u32 s86, s45, 18432
    s_add_u32 s87, s45, 37888
poll_25:
    buffer_load_dword v24, v16, s[32:35], 0 offen sc1
    s_sub_u32 s43, s43, 1
    s_cselect_b64 s[68:69], 0, -1
    s_max_i32 s43, s43, 0
    s_waitcnt vmcnt(0)
    v_cmp_ne_u32 vcc, s44, v24
    s_and_b64 vcc, vcc, s[68:69]
    s_cbranch_scc1 poll_25
    buffer_load_dwordx4 a[0:3], v1, s[4:7], s94 offen offset:0 sc1
    buffer_load_dwordx4 a[72:75], v138, s[4:7], s94 offen offset:0 sc1
    s_barrier
    buffer_load_dwordx4 a[4:7], v1, s[4:7], s94 offen offset:1024 sc1
    ds_read_b128 a[144:147], v1 offset:768
    ds_read_b128 a[148:151], v1 offset:1792
    ds_read_b128 a[152:155], v1 offset:2816
    buffer_load_dwordx4 a[76:79], v138, s[4:7], s94 offen offset:1024 sc1
    ds_read_b128 a[156:159], v1 offset:3840
    ds_read_b128 a[160:163], v130 offset:0
    buffer_load_dwordx4 a[8:11], v1, s[4:7], s94 offen offset:2048 sc1
    ds_read_b128 a[164:167], v1 offset:5632
    ds_read_b128 a[168:171], v1 offset:6656
    ds_read_b128 a[172:175], v1 offset:7680
    buffer_load_dwordx4 a[80:83], v138, s[4:7], s94 offen offset:2048 sc1
    ds_read_b128 a[176:179], v1 offset:8704
    ds_read_b128 a[180:183], v130 offset:4864
    s_waitcnt vmcnt(4) lgkmcnt(5)
    v_mfma_f32_16x16x32_bf16 v[64:67], a[144:147], a[0:3], 0
    ds_read_b128 a[184:187], v1 offset:10496
    buffer_load_dwordx4 a[12:15], v1, s[4:7], s94 offen offset:3072 sc1
    v_mfma_f32_16x16x32_bf16 v[68:71], a[144:147], a[72:75], 0
    v_lshrrev_b32 v212, 1, v1
    v_add_u32 v213, 160256, v212
    v_mfma_f32_16x16x32_bf16 v[72:75], a[148:151], a[0:3], 0
    ds_read_b128 a[188:191], v1 offset:11520
    v_add_u32 v212, 57344, v212
    v_mfma_f32_16x16x32_bf16 v[76:79], a[148:151], a[72:75], 0
    buffer_load_dwordx4 a[84:87], v138, s[4:7], s94 offen offset:3072 sc1
    v_mfma_f32_16x16x32_bf16 v[80:83], a[152:155], a[0:3], 0
    ds_read_b128 a[192:195], v1 offset:12544
    ds_read_b64 v[196:197], v212 offset:0
    v_mfma_f32_16x16x32_bf16 v[84:87], a[152:155], a[72:75], 0
    ds_read_b64 v[198:199], v212 offset:512
    v_mfma_f32_16x16x32_bf16 v[88:91], a[156:159], a[0:3], 0
    ds_read_b128 a[144:147], v1 offset:13568
    ds_read_b64 v[200:201], v212 offset:1024
    v_mfma_f32_16x16x32_bf16 v[92:95], a[156:159], a[72:75], 0
    buffer_load_dwordx4 a[16:19], v1, s[4:7], s57 offen offset:0 sc1
    v_mfma_f32_16x16x32_bf16 v[96:99], a[160:163], a[0:3], 0
    ds_read_b128 a[148:151], v130 offset:9728
    ds_read_b64 v[202:203], v212 offset:1536
    v_mfma_f32_16x16x32_bf16 v[100:103], a[160:163], a[72:75], 0
    ds_read_b64 v[204:205], v212 offset:2048
    s_waitcnt vmcnt(5) lgkmcnt(10)
    v_mfma_f32_16x16x32_bf16 v[64:67], a[164:167], a[4:7], v[64:67]
    ds_read_b128 a[152:155], v1 offset:15360
    ds_read_b64 v[206:207], v212 offset:2560
    v_mfma_f32_16x16x32_bf16 v[68:71], a[164:167], a[76:79], v[68:71]
    buffer_load_dwordx4 a[88:91], v138, s[4:7], s57 offen offset:0 sc1
    v_lshrrev_b32 v35, 5, v0
    v_mfma_f32_16x16x32_bf16 v[72:75], a[168:171], a[4:7], v[72:75]
    ds_read_b128 a[156:159], v1 offset:16384
    ds_read_b64 v[208:209], v212 offset:3072
    v_mfma_f32_16x16x32_bf16 v[76:79], a[168:171], a[76:79], v[76:79]
    ds_read_b64 v[210:211], v212 offset:3584
    v_mul_u32_u24 v35, 36, v35
    v_mfma_f32_16x16x32_bf16 v[80:83], a[172:175], a[4:7], v[80:83]
    ds_read_b128 a[160:163], v1 offset:17408
    v_sub_u32 v34, v0, v35
    v_mfma_f32_16x16x32_bf16 v[84:87], a[172:175], a[76:79], v[84:87]
    buffer_load_dwordx4 a[20:23], v1, s[4:7], s57 offen offset:1024 sc1
    v_cvt_f32_i32 v34, v34
    v_mfma_f32_16x16x32_bf16 v[88:91], a[176:179], a[4:7], v[88:91]
    ds_read_b128 a[164:167], v1 offset:18432
    v_mfma_f32_16x16x32_bf16 v[92:95], a[176:179], a[76:79], v[92:95]
    v_mul_f32 v34, 0x7249f2ca, v34
    v_mfma_f32_16x16x32_bf16 v[96:99], a[180:183], a[4:7], v[96:99]
    ds_read_b128 a[168:171], v130 offset:14592
    v_mfma_f32_16x16x32_bf16 v[100:103], a[180:183], a[76:79], v[100:103]
    buffer_load_dwordx4 a[92:95], v138, s[4:7], s57 offen offset:1024 sc1
    s_waitcnt vmcnt(6) lgkmcnt(10)
    v_mfma_f32_16x16x32_bf16 v[64:67], a[184:187], a[8:11], v[64:67]
    ds_read_b128 a[172:175], v1 offset:20224
    v_mov_b32 v35, 0xf149f2ca
    v_mfma_f32_16x16x32_bf16 v[68:71], a[184:187], a[80:83], v[68:71]
    v_add_f32 v160, 0x7149f2ca, v34
    v_mfma_f32_16x16x32_bf16 v[72:75], a[188:191], a[8:11], v[72:75]
    ds_read_b128 a[176:179], v1 offset:21248
    v_mfma_f32_16x16x32_bf16 v[76:79], a[188:191], a[80:83], v[76:79]
    buffer_load_dwordx4 a[24:27], v1, s[4:7], s57 offen offset:2048 sc1
    v_med3_f32 v160, v160, v35, 0
    v_mfma_f32_16x16x32_bf16 v[80:83], a[192:195], a[8:11], v[80:83]
    ds_read_b128 a[180:183], v1 offset:22272
    v_mfma_f32_16x16x32_bf16 v[84:87], a[192:195], a[80:83], v[84:87]
    v_add_f32 v196, v196, v198
    v_add_f32 v161, 0xf2177617, v34
    v_mfma_f32_16x16x32_bf16 v[88:91], a[144:147], a[8:11], v[88:91]
    ds_read_b128 a[184:187], v1 offset:23296
    v_add_f32 v197, v197, v199
    v_mfma_f32_16x16x32_bf16 v[92:95], a[144:147], a[80:83], v[92:95]
    buffer_load_dwordx4 a[96:99], v138, s[4:7], s57 offen offset:2048 sc1
    v_add_f32 v196, v196, v200
    v_mfma_f32_16x16x32_bf16 v[96:99], a[148:151], a[8:11], v[96:99]
    ds_read_b128 a[188:191], v130 offset:19456
    v_med3_f32 v161, v161, v35, 0
    v_mfma_f32_16x16x32_bf16 v[100:103], a[148:151], a[80:83], v[100:103]
    v_add_f32 v197, v197, v201
    s_waitcnt vmcnt(6) lgkmcnt(5)
    v_mfma_f32_16x16x32_bf16 v[64:67], a[152:155], a[12:15], v[64:67]
    ds_read_b128 a[192:195], v1 offset:25088
    v_add_f32 v196, v196, v202
    v_mfma_f32_16x16x32_bf16 v[68:71], a[152:155], a[84:87], v[68:71]
    buffer_load_dwordx4 a[28:31], v1, s[4:7], s57 offen offset:3072 sc1
    v_add_f32 v197, v197, v203
    v_mfma_f32_16x16x32_bf16 v[72:75], a[156:159], a[12:15], v[72:75]
    ds_read_b128 a[144:147], v1 offset:26112
    v_add_f32 v162, 0xf2b0b471, v34
    v_mfma_f32_16x16x32_bf16 v[76:79], a[156:159], a[84:87], v[76:79]
    v_add_f32 v196, v196, v204
    v_med3_f32 v162, v162, v35, 0
    v_mfma_f32_16x16x32_bf16 v[80:83], a[160:163], a[12:15], v[80:83]
    ds_read_b128 a[148:151], v1 offset:27136
    v_add_f32 v197, v197, v205
    v_mfma_f32_16x16x32_bf16 v[84:87], a[160:163], a[84:87], v[84:87]
    buffer_load_dwordx4 a[100:103], v138, s[4:7], s57 offen offset:3072 sc1
    v_add_f32 v196, v196, v206
    v_mfma_f32_16x16x32_bf16 v[88:91], a[164:167], a[12:15], v[88:91]
    ds_read_b128 a[152:155], v1 offset:28160
    v_add_f32 v163, 0xf30ad6eb, v34
    v_mfma_f32_16x16x32_bf16 v[92:95], a[164:167], a[84:87], v[92:95]
    v_add_f32 v197, v197, v207
    v_med3_f32 v163, v163, v35, 0
    v_mfma_f32_16x16x32_bf16 v[96:99], a[168:171], a[12:15], v[96:99]
    ds_read_b128 a[156:159], v130 offset:24320
    v_add_f32 v196, v196, v208
    v_mfma_f32_16x16x32_bf16 v[100:103], a[168:171], a[84:87], v[100:103]
    buffer_load_dwordx4 a[32:35], v1, s[4:7], s58 offen offset:0 sc1
    s_waitcnt vmcnt(7) lgkmcnt(5)
    v_mfma_f32_16x16x32_bf16 v[64:67], a[172:175], a[16:19], v[64:67]
    ds_read_b128 a[160:163], v1 offset:29952
    v_add_f32 v197, v197, v209
    v_mfma_f32_16x16x32_bf16 v[68:71], a[172:175], a[88:91], v[68:71]
    v_add_f32 v196, v196, v210
    v_add_f32 v164, 0xf3c3a333, v34
    v_mfma_f32_16x16x32_bf16 v[72:75], a[176:179], a[16:19], v[72:75]
    ds_read_b128 a[164:167], v128 offset:0
    buffer_load_dwordx4 a[104:107], v138, s[4:7], s58 offen offset:0 sc1
    v_mfma_f32_16x16x32_bf16 v[76:79], a[176:179], a[88:91], v[76:79]
    v_add_f32 v197, v197, v211
    v_med3_f32 v164, v164, v35, 0
    v_mfma_f32_16x16x32_bf16 v[80:83], a[180:183], a[16:19], v[80:83]
    ds_read_b128 a[168:171], v128 offset:1024
    ds_write_b64 v213, v[196:197]
    v_mfma_f32_16x16x32_bf16 v[84:87], a[180:183], a[88:91], v[84:87]
    v_and_b32 v24, 48, v0
    v_add_f32 v165, 0xf3dce18d, v34
    v_mfma_f32_16x16x32_bf16 v[88:91], a[184:187], a[16:19], v[88:91]
    ds_read_b128 a[172:175], v128 offset:2048
    buffer_load_dwordx4 v[140:143], v1, s[32:35], s86 offen sc1
    v_mfma_f32_16x16x32_bf16 v[92:95], a[184:187], a[88:91], v[92:95]
    v_add_u32 v24, 160256, v24
    s_mov_b32 vcc_lo, 0xffff0000
    v_mfma_f32_16x16x32_bf16 v[96:99], a[188:191], a[16:19], v[96:99]
    ds_read_b128 a[176:179], v130 offset:29184
    v_med3_f32 v165, v165, v35, 0
    v_mfma_f32_16x16x32_bf16 v[100:103], a[188:191], a[88:91], v[100:103]
    s_mov_b32 vcc_hi, 0
    s_waitcnt vmcnt(7) lgkmcnt(6)
    v_mfma_f32_16x16x32_bf16 v[64:67], a[192:195], a[20:23], v[64:67]
    ds_read_b128 a[180:183], v128 offset:3840
    buffer_load_dwordx4 v[144:147], v1, s[32:35], s87 offen sc1
    v_mfma_f32_16x16x32_bf16 v[68:71], a[192:195], a[92:95], v[68:71]
    v_mov_b32 v26, 0x3eae1a93
    v_cndmask_b32 v26, 1.0, v26, vcc
    v_mfma_f32_16x16x32_bf16 v[72:75], a[144:147], a[20:23], v[72:75]
    ds_read_b128 a[184:187], v128 offset:4864
    v_add_f32 v166, 0xf3f61fe6, v34
    v_mfma_f32_16x16x32_bf16 v[76:79], a[144:147], a[92:95], v[76:79]
    ds_read_b128 v[176:179], v24 offset:0
    v_med3_f32 v166, v166, v35, 0
    v_mfma_f32_16x16x32_bf16 v[80:83], a[148:151], a[20:23], v[80:83]
    ds_read_b128 a[188:191], v128 offset:5888
    buffer_load_dwordx4 a[36:39], v1, s[4:7], s58 offen offset:1024 sc1
    v_mfma_f32_16x16x32_bf16 v[84:87], a[148:151], a[92:95], v[84:87]
    ds_read_b128 v[180:183], v24 offset:64
    ds_read_b128 v[184:187], v24 offset:128
    v_mfma_f32_16x16x32_bf16 v[88:91], a[152:155], a[20:23], v[88:91]
    ds_read_b128 a[192:195], v128 offset:6912
    v_add_f32 v167, 0xf407af20, v34
    v_mfma_f32_16x16x32_bf16 v[92:95], a[152:155], a[92:95], v[92:95]
    ds_read_b128 v[188:191], v24 offset:192
    v_med3_f32 v167, v167, v35, 0
    v_mfma_f32_16x16x32_bf16 v[96:99], a[156:159], a[20:23], v[96:99]
    ds_read_b128 a[144:147], v131 offset:3072
    buffer_load_dwordx4 a[108:111], v138, s[4:7], s58 offen offset:1024 sc1
    v_mfma_f32_16x16x32_bf16 v[100:103], a[156:159], a[92:95], v[100:103]
    ds_read_b128 v[192:195], v24 offset:256
    s_waitcnt vmcnt(8) lgkmcnt(10)
    v_mfma_f32_16x16x32_bf16 v[64:67], a[160:163], a[24:27], v[64:67]
    ds_read_b128 a[148:151], v128 offset:8704
    v_add_f32 v168, 0xf446caff, v34
    v_mfma_f32_16x16x32_bf16 v[68:71], a[160:163], a[96:99], v[68:71]
    v_med3_f32 v168, v168, v35, 0
    v_add_f32 v169, 0xf4536a2b, v34
    v_mfma_f32_16x16x32_bf16 v[72:75], a[164:167], a[24:27], v[72:75]
    ds_read_b128 a[152:155], v128 offset:9728
    buffer_load_dwordx4 a[40:43], v1, s[4:7], s58 offen offset:2048 sc1
    v_mfma_f32_16x16x32_bf16 v[76:79], a[164:167], a[96:99], v[76:79]
    v_med3_f32 v169, v169, v35, 0
    v_add_f32 v170, 0xf4600958, v34
    v_mfma_f32_16x16x32_bf16 v[80:83], a[168:171], a[24:27], v[80:83]
    ds_read_b128 a[156:159], v128 offset:10752
    v_med3_f32 v170, v170, v35, 0
    v_mfma_f32_16x16x32_bf16 v[84:87], a[168:171], a[96:99], v[84:87]
    v_add_f32 v171, 0xf46ca884, v34
    v_med3_f32 v171, v171, v35, 0
    v_mfma_f32_16x16x32_bf16 v[88:91], a[172:175], a[24:27], v[88:91]
    ds_read_b128 a[160:163], v128 offset:11776
    buffer_load_dwordx4 a[112:115], v138, s[4:7], s58 offen offset:2048 sc1
    v_mfma_f32_16x16x32_bf16 v[92:95], a[172:175], a[96:99], v[92:95]
    v_add_f32 v172, 0xf495e232, v34
    v_mfma_f32_16x16x32_bf16 v[96:99], a[176:179], a[24:27], v[96:99]
    ds_read_b128 a[164:167], v131 offset:7936
    v_med3_f32 v172, v172, v35, 0
    v_mfma_f32_16x16x32_bf16 v[100:103], a[176:179], a[96:99], v[100:103]
    s_waitcnt vmcnt(8) lgkmcnt(6)
    v_mfma_f32_16x16x32_bf16 v[64:67], a[180:183], a[28:31], v[64:67]
    ds_read_b128 a[168:171], v128 offset:13568
    buffer_load_dwordx4 a[44:47], v1, s[4:7], s58 offen offset:3072 sc1
    v_mfma_f32_16x16x32_bf16 v[68:71], a[180:183], a[100:103], v[68:71]
    v_add_f32 v173, 0xf49c31c8, v34
    v_mfma_f32_16x16x32_bf16 v[72:75], a[184:187], a[28:31], v[72:75]
    ds_read_b128 a[172:175], v128 offset:14592
    v_med3_f32 v173, v173, v35, 0
    v_mfma_f32_16x16x32_bf16 v[76:79], a[184:187], a[100:103], v[76:79]
    v_mfma_f32_16x16x32_bf16 v[80:83], a[188:191], a[28:31], v[80:83]
    ds_read_b128 a[176:179], v128 offset:15616
    buffer_load_dwordx4 a[116:119], v138, s[4:7], s58 offen offset:3072 sc1
    v_mfma_f32_16x16x32_bf16 v[84:87], a[188:191], a[100:103], v[84:87]
    v_add_f32 v174, 0xf4a2815e, v34
    v_mfma_f32_16x16x32_bf16 v[88:91], a[192:195], a[28:31], v[88:91]
    ds_read_b128 a[180:183], v128 offset:16640
    v_med3_f32 v174, v174, v35, 0
    v_mfma_f32_16x16x32_bf16 v[92:95], a[192:195], a[100:103], v[92:95]
    v_mfma_f32_16x16x32_bf16 v[96:99], a[144:147], a[28:31], v[96:99]
    ds_read_b128 a[184:187], v131 offset:12800
    buffer_load_dwordx4 a[48:51], v1, s[4:7], s59 offen offset:0 sc1
    v_mfma_f32_16x16x32_bf16 v[100:103], a[144:147], a[100:103], v[100:103]
    v_add_f32 v175, 0xf4a8d0f5, v34
    s_waitcnt vmcnt(9) lgkmcnt(5)
    v_mfma_f32_16x16x32_bf16 v[64:67], a[148:151], a[32:35], v[64:67]
    ds_read_b128 a[188:191], v128 offset:18432
    v_med3_f32 v175, v175, v35, 0
    v_mfma_f32_16x16x32_bf16 v[68:71], a[148:151], a[104:107], v[68:71]
    v_mfma_f32_16x16x32_bf16 v[72:75], a[152:155], a[32:35], v[72:75]
    ds_read_b128 a[192:195], v128 offset:19456
    buffer_load_dwordx4 a[120:123], v138, s[4:7], s59 offen offset:0 sc1
    v_mfma_f32_16x16x32_bf16 v[76:79], a[152:155], a[104:107], v[76:79]
    s_waitcnt vmcnt(9)
    v_add_f32 v140, v140, v142
    v_add_f32 v141, v141, v143
    v_mfma_f32_16x16x32_bf16 v[80:83], a[156:159], a[32:35], v[80:83]
    ds_read_b128 a[144:147], v128 offset:20480
    s_waitcnt vmcnt(8)
    v_add_f32 v144, v144, v146
    v_mfma_f32_16x16x32_bf16 v[84:87], a[156:159], a[104:107], v[84:87]
    buffer_load_dwordx4 a[52:55], v1, s[4:7], s59 offen offset:1024 sc1
    v_mfma_f32_16x16x32_bf16 v[88:91], a[160:163], a[32:35], v[88:91]
    ds_read_b128 a[148:151], v128 offset:21504
    v_add_f32 v145, v145, v147
    v_mfma_f32_16x16x32_bf16 v[92:95], a[160:163], a[104:107], v[92:95]
    v_permlane32_swap_b32 v140, v141
    v_mfma_f32_16x16x32_bf16 v[96:99], a[164:167], a[32:35], v[96:99]
    ds_read_b128 a[152:155], v131 offset:17664
    v_permlane32_swap_b32 v144, v145
    v_mfma_f32_16x16x32_bf16 v[100:103], a[164:167], a[104:107], v[100:103]
    buffer_load_dwordx4 a[124:127], v138, s[4:7], s59 offen offset:1024 sc1
    s_waitcnt vmcnt(8) lgkmcnt(5)
    v_mfma_f32_16x16x32_bf16 v[64:67], a[168:171], a[36:39], v[64:67]
    ds_read_b128 a[156:159], v128 offset:23296
    v_add_f32 v140, v140, v141
    v_mfma_f32_16x16x32_bf16 v[68:71], a[168:171], a[108:111], v[68:71]
    v_add_f32 v144, v144, v145
    v_mfma_f32_16x16x32_bf16 v[72:75], a[172:175], a[36:39], v[72:75]
    ds_read_b128 a[160:163], v128 offset:24320
    v_permlane16_swap_b32 v140, v144
    v_mfma_f32_16x16x32_bf16 v[76:79], a[172:175], a[108:111], v[76:79]
    buffer_load_dwordx4 a[56:59], v1, s[4:7], s59 offen offset:2048 sc1
    v_mfma_f32_16x16x32_bf16 v[80:83], a[176:179], a[36:39], v[80:83]
    ds_read_b128 a[164:167], v128 offset:25344
    v_add_f32 v140, v140, v144
    v_mfma_f32_16x16x32_bf16 v[84:87], a[176:179], a[108:111], v[84:87]
    v_mul_f32 v140, 0x3ae38e39, v140
    v_mfma_f32_16x16x32_bf16 v[88:91], a[180:183], a[36:39], v[88:91]
    ds_read_b128 a[168:171], v128 offset:26368
    v_mfma_f32_16x16x32_bf16 v[92:95], a[180:183], a[108:111], v[92:95]
    buffer_load_dwordx4 a[128:131], v138, s[4:7], s59 offen offset:2048 sc1
    v_mov_b32 v144, v140
    v_mfma_f32_16x16x32_bf16 v[96:99], a[184:187], a[36:39], v[96:99]
    ds_read_b128 a[172:175], v131 offset:22528
    v_permlane32_swap_b32 v140, v144
    v_mfma_f32_16x16x32_bf16 v[100:103], a[184:187], a[108:111], v[100:103]
    v_fma_f32 v144, -v140, v140, v144
    s_waitcnt vmcnt(8) lgkmcnt(5)
    v_mfma_f32_16x16x32_bf16 v[64:67], a[188:191], a[40:43], v[64:67]
    ds_read_b128 a[176:179], v128 offset:28160
    v_mfma_f32_16x16x32_bf16 v[68:71], a[188:191], a[112:115], v[68:71]
    buffer_load_dwordx4 a[60:63], v1, s[4:7], s59 offen offset:3072 sc1
    v_max_f32 v144, 0, v144
    v_mfma_f32_16x16x32_bf16 v[72:75], a[192:195], a[40:43], v[72:75]
    ds_read_b128 a[180:183], v128 offset:29184
    v_add_f32 v144, 0x3727c5ac, v144
    v_mfma_f32_16x16x32_bf16 v[76:79], a[192:195], a[112:115], v[76:79]
    v_rsq_f32 v148, v144
    v_mfma_f32_16x16x32_bf16 v[80:83], a[144:147], a[40:43], v[80:83]
    ds_read_b128 a[184:187], v128 offset:30208
    v_mfma_f32_16x16x32_bf16 v[84:87], a[144:147], a[112:115], v[84:87]
    buffer_load_dwordx4 a[132:135], v138, s[4:7], s59 offen offset:3072 sc1
    v_mul_f32 v150, -v140, v148
    v_mfma_f32_16x16x32_bf16 v[88:91], a[148:151], a[40:43], v[88:91]
    ds_read_b128 a[188:191], v128 offset:31232
    v_mov_b32 v149, v148
    v_mfma_f32_16x16x32_bf16 v[92:95], a[148:151], a[112:115], v[92:95]
    v_mov_b32 v151, v150
    v_mfma_f32_16x16x32_bf16 v[96:99], a[152:155], a[40:43], v[96:99]
    ds_read_b128 a[192:195], v131 offset:27392
    v_mfma_f32_16x16x32_bf16 v[100:103], a[152:155], a[112:115], v[100:103]
    buffer_load_dwordx4 a[64:67], v1, s[4:7], s60 offen offset:0 sc1
    s_waitcnt vmcnt(9) lgkmcnt(5)
    v_mfma_f32_16x16x32_bf16 v[64:67], a[156:159], a[44:47], v[64:67]
    ds_read_b128 a[144:147], v128 offset:33024
    v_permlane16_swap_b32 v148, v149
    v_mfma_f32_16x16x32_bf16 v[68:71], a[156:159], a[116:119], v[68:71]
    v_permlane16_swap_b32 v150, v151
    v_mfma_f32_16x16x32_bf16 v[72:75], a[160:163], a[44:47], v[72:75]
    ds_read_b128 a[148:151], v128 offset:34048
    v_mfma_f32_16x16x32_bf16 v[76:79], a[160:163], a[116:119], v[76:79]
    buffer_load_dwordx4 a[136:139], v138, s[4:7], s60 offen offset:0 sc1
    v_mfma_f32_16x16x32_bf16 v[80:83], a[164:167], a[44:47], v[80:83]
    ds_read_b128 a[152:155], v128 offset:35072
    v_mfma_f32_16x16x32_bf16 v[84:87], a[164:167], a[116:119], v[84:87]
    v_mfma_f32_16x16x32_bf16 v[88:91], a[168:171], a[44:47], v[88:91]
    ds_read_b128 a[156:159], v128 offset:36096
    v_mfma_f32_16x16x32_bf16 v[92:95], a[168:171], a[116:119], v[92:95]
    buffer_load_dwordx4 a[68:71], v1, s[4:7], s60 offen offset:1024 sc1
    v_mul_f32 v152, v26, v148
    v_mfma_f32_16x16x32_bf16 v[96:99], a[172:175], a[44:47], v[96:99]
    ds_read_b128 a[160:163], v131 offset:32256
    v_mul_f32 v153, v26, v149
    v_mfma_f32_16x16x32_bf16 v[100:103], a[172:175], a[116:119], v[100:103]
    v_mul_f32 v154, v26, v150
    s_waitcnt vmcnt(9) lgkmcnt(5)
    v_mfma_f32_16x16x32_bf16 v[64:67], a[176:179], a[48:51], v[64:67]
    ds_read_b128 a[164:167], v128 offset:37888
    v_mfma_f32_16x16x32_bf16 v[68:71], a[176:179], a[120:123], v[68:71]
    buffer_load_dwordx4 a[140:143], v138, s[4:7], s60 offen offset:1024 sc1
    v_mul_f32 v155, v26, v151
    v_mfma_f32_16x16x32_bf16 v[72:75], a[180:183], a[48:51], v[72:75]
    ds_read_b128 a[168:171], v128 offset:38912
    v_mul_f32 v196, v150, v176
    v_mfma_f32_16x16x32_bf16 v[76:79], a[180:183], a[120:123], v[76:79]
    v_mfma_f32_16x16x32_bf16 v[80:83], a[184:187], a[48:51], v[80:83]
    ds_read_b128 a[172:175], v128 offset:39936
    v_mul_f32 v197, v150, v177
    v_mfma_f32_16x16x32_bf16 v[84:87], a[184:187], a[120:123], v[84:87]
    s_lshl_b32 s67, s38, 10
    s_add_u32 s66, s67, s75
    s_add_u32 m0, s67, 63488
    s_add_u32 s66, s66, 25462784
    buffer_load_dwordx4 v1, s[32:35], s66 offen lds
    v_mfma_f32_16x16x32_bf16 v[88:91], a[188:191], a[48:51], v[88:91]
    ds_read_b128 a[176:179], v128 offset:40960
    v_mul_f32 v198, v150, v178
    v_mfma_f32_16x16x32_bf16 v[92:95], a[188:191], a[120:123], v[92:95]
    v_mul_f32 v199, v150, v179
    v_mfma_f32_16x16x32_bf16 v[96:99], a[192:195], a[48:51], v[96:99]
    ds_read_b128 a[180:183], v131 offset:37120
    v_mul_f32 v200, v151, v176
    v_mfma_f32_16x16x32_bf16 v[100:103], a[192:195], a[120:123], v[100:103]
    s_add_u32 m0, s67, 67584
    s_add_u32 s66, s66, 4096
    buffer_load_dwordx4 v1, s[32:35], s66 offen lds
    s_waitcnt vmcnt(10) lgkmcnt(5)
    v_mfma_f32_16x16x32_bf16 v[64:67], a[144:147], a[52:55], v[64:67]
    ds_read_b128 a[184:187], v128 offset:42752
    v_mul_f32 v201, v151, v177
    v_mfma_f32_16x16x32_bf16 v[68:71], a[144:147], a[124:127], v[68:71]
    v_mul_f32 v202, v151, v178
    v_mfma_f32_16x16x32_bf16 v[72:75], a[148:151], a[52:55], v[72:75]
    ds_read_b128 a[188:191], v128 offset:43776
    v_mul_f32 v203, v151, v179
    v_mfma_f32_16x16x32_bf16 v[76:79], a[148:151], a[124:127], v[76:79]
    s_add_u32 m0, s67, 71680
    s_add_u32 s66, s66, 4096
    buffer_load_dwordx4 v1, s[32:35], s66 offen lds
    v_mfma_f32_16x16x32_bf16 v[80:83], a[152:155], a[52:55], v[80:83]
    ds_read_b128 a[192:195], v128 offset:44800
    v_mul_f32 v204, v150, v180
    v_mfma_f32_16x16x32_bf16 v[84:87], a[152:155], a[124:127], v[84:87]
    v_mul_f32 v205, v150, v181
    v_mfma_f32_16x16x32_bf16 v[88:91], a[156:159], a[52:55], v[88:91]
    ds_read_b128 a[144:147], v128 offset:45824
    v_mfma_f32_16x16x32_bf16 v[92:95], a[156:159], a[124:127], v[92:95]
    s_add_u32 m0, s67, 75776
    s_add_u32 s66, s66, 4096
    buffer_load_dwordx4 v1, s[32:35], s66 offen lds
    v_mfma_f32_16x16x32_bf16 v[96:99], a[160:163], a[52:55], v[96:99]
    ds_read_b128 a[148:151], v131 offset:41984
    v_mul_f32 v206, v150, v182
    v_mfma_f32_16x16x32_bf16 v[100:103], a[160:163], a[124:127], v[100:103]
    v_mul_f32 v207, v150, v183
    s_waitcnt vmcnt(10) lgkmcnt(5)
    v_mfma_f32_16x16x32_bf16 v[64:67], a[164:167], a[56:59], v[64:67]
    ds_read_b128 a[152:155], v128 offset:47616
    v_mul_f32 v208, v151, v180
    v_mfma_f32_16x16x32_bf16 v[68:71], a[164:167], a[128:131], v[68:71]
    s_add_u32 m0, s67, 79872
    s_add_u32 s66, s66, 4096
    buffer_load_dwordx4 v1, s[32:35], s66 offen lds
    v_mfma_f32_16x16x32_bf16 v[72:75], a[168:171], a[56:59], v[72:75]
    ds_read_b128 a[156:159], v128 offset:48640
    v_mul_f32 v209, v151, v181
    v_mfma_f32_16x16x32_bf16 v[76:79], a[168:171], a[128:131], v[76:79]
    v_mul_f32 v210, v151, v182
    v_mfma_f32_16x16x32_bf16 v[80:83], a[172:175], a[56:59], v[80:83]
    ds_read_b128 a[160:163], v128 offset:49664
    v_mul_f32 v211, v151, v183
    v_mfma_f32_16x16x32_bf16 v[84:87], a[172:175], a[128:131], v[84:87]
    s_add_u32 m0, s67, 83968
    s_add_u32 s66, s66, 4096
    buffer_load_dwordx4 v1, s[32:35], s66 offen lds
    v_mfma_f32_16x16x32_bf16 v[88:91], a[176:179], a[56:59], v[88:91]
    ds_read_b128 a[164:167], v128 offset:50688
    v_mul_f32 v212, v150, v184
    v_mfma_f32_16x16x32_bf16 v[92:95], a[176:179], a[128:131], v[92:95]
    v_mul_f32 v213, v150, v185
    v_mfma_f32_16x16x32_bf16 v[96:99], a[180:183], a[56:59], v[96:99]
    ds_read_b128 a[168:171], v131 offset:46848
    v_mul_f32 v214, v150, v186
    v_mfma_f32_16x16x32_bf16 v[100:103], a[180:183], a[128:131], v[100:103]
    s_add_u32 m0, s67, 88064
    s_add_u32 s66, s66, 4096
    buffer_load_dwordx4 v1, s[32:35], s66 offen lds
    s_waitcnt vmcnt(11) lgkmcnt(5)
    v_mfma_f32_16x16x32_bf16 v[64:67], a[184:187], a[60:63], v[64:67]
    ds_read_b128 a[172:175], v128 offset:52480
    v_mul_f32 v215, v150, v187
    v_mfma_f32_16x16x32_bf16 v[68:71], a[184:187], a[132:135], v[68:71]
    v_mul_f32 v216, v151, v184
    v_mfma_f32_16x16x32_bf16 v[72:75], a[188:191], a[60:63], v[72:75]
    ds_read_b128 a[176:179], v128 offset:53504
    v_mul_f32 v217, v151, v185
    v_mfma_f32_16x16x32_bf16 v[76:79], a[188:191], a[132:135], v[76:79]
    s_add_u32 m0, s67, 92160
    s_add_u32 s66, s66, 4096
    buffer_load_dwordx4 v1, s[32:35], s66 offen lds
    v_mfma_f32_16x16x32_bf16 v[80:83], a[192:195], a[60:63], v[80:83]
    ds_read_b128 a[180:183], v128 offset:54528
    v_mul_f32 v218, v151, v186
    v_mfma_f32_16x16x32_bf16 v[84:87], a[192:195], a[132:135], v[84:87]
    v_mul_f32 v219, v151, v187
    v_mfma_f32_16x16x32_bf16 v[88:91], a[144:147], a[60:63], v[88:91]
    ds_read_b128 a[184:187], v128 offset:55552
    v_mfma_f32_16x16x32_bf16 v[92:95], a[144:147], a[132:135], v[92:95]
    s_add_u32 m0, s67, 96256
    s_add_u32 s66, s66, 4096
    buffer_load_dwordx4 v1, s[32:35], s66 offen lds
    v_mfma_f32_16x16x32_bf16 v[96:99], a[148:151], a[60:63], v[96:99]
    ds_read_b128 a[188:191], v131 offset:51712
    v_mul_f32 v220, v150, v188
    v_mfma_f32_16x16x32_bf16 v[100:103], a[148:151], a[132:135], v[100:103]
    v_mul_f32 v221, v150, v189
    s_waitcnt vmcnt(11) lgkmcnt(5)
    v_mfma_f32_16x16x32_bf16 v[64:67], a[152:155], a[64:67], v[64:67]
    v_mul_f32 v222, v150, v190
    v_mfma_f32_16x16x32_bf16 v[68:71], a[152:155], a[136:139], v[68:71]
    v_mul_f32 v223, v150, v191
    v_mfma_f32_16x16x32_bf16 v[72:75], a[156:159], a[64:67], v[72:75]
    v_mul_f32 v224, v151, v188
    v_mfma_f32_16x16x32_bf16 v[76:79], a[156:159], a[136:139], v[76:79]
    v_mfma_f32_16x16x32_bf16 v[80:83], a[160:163], a[64:67], v[80:83]
    v_mul_f32 v225, v151, v189
    v_mfma_f32_16x16x32_bf16 v[84:87], a[160:163], a[136:139], v[84:87]
    v_mul_f32 v226, v151, v190
    v_mfma_f32_16x16x32_bf16 v[88:91], a[164:167], a[64:67], v[88:91]
    v_mfma_f32_16x16x32_bf16 v[92:95], a[164:167], a[136:139], v[92:95]
    v_mul_f32 v227, v151, v191
    v_mfma_f32_16x16x32_bf16 v[96:99], a[168:171], a[64:67], v[96:99]
    v_mul_f32 v228, v154, v192
    v_mfma_f32_16x16x32_bf16 v[100:103], a[168:171], a[136:139], v[100:103]
    v_mul_f32 v229, v154, v193
    s_waitcnt vmcnt(9) lgkmcnt(0)
    v_mfma_f32_16x16x32_bf16 v[64:67], a[172:175], a[68:71], v[64:67]
L_hop3:
    s_cbranch_execz L_hop7
    v_mfma_f32_16x16x32_bf16 v[68:71], a[172:175], a[140:143], v[68:71]
    v_mul_f32 v230, v154, v194
    v_mfma_f32_16x16x32_bf16 v[72:75], a[176:179], a[68:71], v[72:75]
    v_mul_f32 v231, v154, v195
    v_mfma_f32_16x16x32_bf16 v[76:79], a[176:179], a[140:143], v[76:79]
    v_mfma_f32_16x16x32_bf16 v[80:83], a[180:183], a[68:71], v[80:83]
    v_mul_f32 v232, v155, v192
    v_mfma_f32_16x16x32_bf16 v[84:87], a[180:183], a[140:143], v[84:87]
    v_mul_f32 v233, v155, v193
    v_mfma_f32_16x16x32_bf16 v[88:91], a[184:187], a[68:71], v[88:91]
    v_mfma_f32_16x16x32_bf16 v[92:95], a[184:187], a[140:143], v[92:95]
    v_mul_f32 v234, v155, v194
    v_mfma_f32_16x16x32_bf16 v[96:99], a[188:191], a[68:71], v[96:99]
    v_mul_f32 v235, v155, v195
    v_mfma_f32_16x16x32_bf16 v[100:103], a[188:191], a[140:143], v[100:103]
    s_add_u32 s45, s45, s3
    s_mul_i32 s57, s38, 5120
    s_sub_u32 s57, s53, s57
    v_mov_b32 v27, s44
    v_pk_fma_f32 v[64:65], v[64:65], v[148:149], v[196:197] op_sel:[0,0,0] op_sel_hi:[1,0,1]
    v_pk_fma_f32 v[66:67], v[66:67], v[148:149], v[198:199] op_sel:[0,0,0] op_sel_hi:[1,0,1]
    v_pk_fma_f32 v[68:69], v[68:69], v[148:149], v[200:201] op_sel:[0,1,0] op_sel_hi:[1,1,1]
    v_pk_fma_f32 v[70:71], v[70:71], v[148:149], v[202:203] op_sel:[0,1,0] op_sel_hi:[1,1,1]
    v_cvt_pk_bf16_f32 v236, v64, v65
    v_cvt_pk_bf16_f32 v238, v68, v69
    v_cvt_pk_bf16_f32 v237, v66, v67
    v_cvt_pk_bf16_f32 v239, v70, v71
    v_pk_fma_f32 v[72:73], v[72:73], v[148:149], v[204:205] op_sel:[0,0,0] op_sel_hi:[1,0,1]
    v_pk_fma_f32 v[74:75], v[74:75], v[148:149], v[206:207] op_sel:[0,0,0] op_sel_hi:[1,0,1]
    v_permlane16_swap_b32 v236, v238
    v_permlane16_swap_b32 v237, v239
    buffer_store_dwordx4 v[236:239], v3, s[32:35], s57 offen offset:0 sc1
    v_add3_u32 v27, v27, v236, v237
    v_add3_u32 v27, v27, v238, v239
    v_pk_fma_f32 v[76:77], v[76:77], v[148:149], v[208:209] op_sel:[0,1,0] op_sel_hi:[1,1,1]
    v_pk_fma_f32 v[78:79], v[78:79], v[148:149], v[210:211] op_sel:[0,1,0] op_sel_hi:[1,1,1]
    v_cvt_pk_bf16_f32 v240, v72, v73
    v_cvt_pk_bf16_f32 v242, v76, v77
    v_cvt_pk_bf16_f32 v241, v74, v75
    v_cvt_pk_bf16_f32 v243, v78, v79
    v_pk_fma_f32 v[80:81], v[80:81], v[148:149], v[212:213] op_sel:[0,0,0] op_sel_hi:[1,0,1]
    v_pk_fma_f32 v[82:83], v[82:83], v[148:149], v[214:215] op_sel:[0,0,0] op_sel_hi:[1,0,1]
    v_permlane16_swap_b32 v240, v242
    v_permlane16_swap_b32 v241, v243
    buffer_store_dwordx4 v[240:243], v3, s[32:35], s57 offen offset:1024 sc1
    v_add3_u32 v27, v27, v240, v241
    v_add3_u32 v27, v27, v242, v243
    v_pk_fma_f32 v[84:85], v[84:85], v[148:149], v[216:217] op_sel:[0,1,0] op_sel_hi:[1,1,1]
    v_pk_fma_f32 v[86:87], v[86:87], v[148:149], v[218:219] op_sel:[0,1,0] op_sel_hi:[1,1,1]
    v_cvt_pk_bf16_f32 v244, v80, v81
    v_cvt_pk_bf16_f32 v246, v84, v85
    v_cvt_pk_bf16_f32 v245, v82, v83
    v_cvt_pk_bf16_f32 v247, v86, v87
    v_pk_fma_f32 v[88:89], v[88:89], v[148:149], v[220:221] op_sel:[0,0,0] op_sel_hi:[1,0,1]
    v_pk_fma_f32 v[90:91], v[90:91], v[148:149], v[222:223] op_sel:[0,0,0] op_sel_hi:[1,0,1]
    v_permlane16_swap_b32 v244, v246
    v_permlane16_swap_b32 v245, v247
    buffer_store_dwordx4 v[244:247], v18, s[32:35], s57 offen offset:2048 sc1
    v_add3_u32 v27, v27, v244, v245
    v_add3_u32 v27, v27, v246, v247
    v_pk_fma_f32 v[92:93], v[92:93], v[148:149], v[224:225] op_sel:[0,1,0] op_sel_hi:[1,1,1]
    v_pk_fma_f32 v[94:95], v[94:95], v[148:149], v[226:227] op_sel:[0,1,0] op_sel_hi:[1,1,1]
    v_cvt_pk_bf16_f32 v248, v88, v89
    v_cvt_pk_bf16_f32 v250, v92, v93
    v_cvt_pk_bf16_f32 v249, v90, v91
    v_cvt_pk_bf16_f32 v251, v94, v95
    v_pk_fma_f32 v[96:97], v[96:97], v[152:153], v[228:229] op_sel:[0,0,0] op_sel_hi:[1,0,1]
    v_pk_fma_f32 v[98:99], v[98:99], v[152:153], v[230:231] op_sel:[0,0,0] op_sel_hi:[1,0,1]
    v_permlane16_swap_b32 v248, v250
    v_permlane16_swap_b32 v249, v251
    buffer_store_dwordx4 v[248:251], v18, s[32:35], s57 offen offset:3072 sc1
    v_add3_u32 v27, v27, v248, v249
    v_add3_u32 v27, v27, v250, v251
    v_pk_fma_f32 v[100:101], v[100:101], v[152:153], v[232:233] op_sel:[0,1,0] op_sel_hi:[1,1,1]
    v_pk_fma_f32 v[102:103], v[102:103], v[152:153], v[234:235] op_sel:[0,1,0] op_sel_hi:[1,1,1]
    v_cvt_pk_bf16_f32 v252, v96, v97
    v_cvt_pk_bf16_f32 v254, v100, v101
    v_cvt_pk_bf16_f32 v253, v98, v99
    v_cvt_pk_bf16_f32 v255, v102, v103
    v_permlane16_swap_b32 v252, v254
    s_nop 0
    v_permlane16_swap_b32 v253, v255
    v_mov_b32 v30, v254
    v_mov_b32 v31, v255
    v_add3_u32 v27, v27, v252, v253
    v_mov_b32 v254, s74
    v_and_b32 v255, 0xbfffbfff, v27
    buffer_store_dwordx4 v[252:255], v19, s[32:35], s57 offen sc1
    s_waitcnt vmcnt(9)
    s_waitcnt lgkmcnt(0)
    s_barrier
    ds_read_b128 a[144:147], v136 offset:0
    ds_read_b128 a[148:151], v136 offset:1024
    ds_read_b128 a[152:155], v136 offset:2048
    ds_read_b128 a[156:159], v136 offset:3072
    s_waitcnt lgkmcnt(2)
    v_mfma_f32_16x16x32_bf16 v[104:107], a[144:147], a[0:3], 0
    ds_read_b128 a[160:163], v136 offset:4096
    buffer_load_dword v42, v43, s[32:35], 0 offen sc1
    v_mfma_f32_16x16x32_bf16 v[108:111], a[144:147], a[72:75], 0
    v_and_b32 v140, 48, v0
    v_add_u32 v140, 160576, v140
    v_mfma_f32_16x16x32_bf16 v[112:115], a[148:151], a[0:3], 0
    ds_read_b128 a[164:167], v136 offset:5120
    ds_write_b128 v3, v[236:239] offset:40960
    v_mfma_f32_16x16x32_bf16 v[116:119], a[148:151], a[72:75], 0
    ds_read_b128 v[176:179], v140 offset:0
    s_waitcnt lgkmcnt(4)
    v_mfma_f32_16x16x32_bf16 v[104:107], a[152:155], a[4:7], v[104:107]
    ds_read_b128 a[168:171], v136 offset:6144
    ds_read_b128 v[180:183], v140 offset:64
    v_mfma_f32_16x16x32_bf16 v[108:111], a[152:155], a[76:79], v[108:111]
    v_mul_f32 v148, 0x3eae1a93, v148
    v_mul_f32 v149, 0x3eae1a93, v149
    v_mfma_f32_16x16x32_bf16 v[112:115], a[156:159], a[4:7], v[112:115]
    ds_read_b128 a[172:175], v136 offset:7168
    buffer_load_dword v42, v2, s[24:27], 0 offen sc1
    v_mfma_f32_16x16x32_bf16 v[116:119], a[156:159], a[76:79], v[116:119]
    v_mul_f32 v150, 0x3eae1a93, v150
    v_mul_f32 v151, 0x3eae1a93, v151
    s_waitcnt lgkmcnt(5)
    v_mfma_f32_16x16x32_bf16 v[104:107], a[160:163], a[8:11], v[104:107]
    ds_read_b128 a[176:179], v136 offset:8192
    v_mfma_f32_16x16x32_bf16 v[108:111], a[160:163], a[80:83], v[108:111]
    ds_write_b128 v3, v[240:243] offset:41984
    v_mfma_f32_16x16x32_bf16 v[112:115], a[164:167], a[8:11], v[112:115]
    ds_read_b128 a[180:183], v136 offset:9216
    v_mfma_f32_16x16x32_bf16 v[116:119], a[164:167], a[80:83], v[116:119]
    s_waitcnt lgkmcnt(3)
    v_mfma_f32_16x16x32_bf16 v[104:107], a[168:171], a[12:15], v[104:107]
    ds_read_b128 a[184:187], v136 offset:10240
    v_mfma_f32_16x16x32_bf16 v[108:111], a[168:171], a[84:87], v[108:111]
    s_bitcmp1_b32 s36, 0
    s_cselect_b32 s60, 20480, 0
    s_cselect_b32 s8, 0, -1.0
    s_cselect_b32 s9, -1.0, 0
    s_cselect_b32 s62, s38, 0
    v_mfma_f32_16x16x32_bf16 v[112:115], a[172:175], a[12:15], v[112:115]
    ds_read_b128 a[188:191], v136 offset:11264
    v_mfma_f32_16x16x32_bf16 v[116:119], a[172:175], a[84:87], v[116:119]
    s_waitcnt lgkmcnt(2)
    v_mfma_f32_16x16x32_bf16 v[104:107], a[176:179], a[16:19], v[104:107]
    ds_read_b128 a[192:195], v136 offset:12288
    v_mul_f32 v88, v150, v176
    v_mfma_f32_16x16x32_bf16 v[108:111], a[176:179], a[88:91], v[108:111]
    ds_write_b128 v18, v[244:247] offset:43008
    v_mfma_f32_16x16x32_bf16 v[112:115], a[180:183], a[16:19], v[112:115]
    ds_read_b128 a[144:147], v136 offset:13312
    v_mul_f32 v89, v150, v177
    v_mfma_f32_16x16x32_bf16 v[116:119], a[180:183], a[88:91], v[116:119]
    s_waitcnt lgkmcnt(3)
    v_mfma_f32_16x16x32_bf16 v[104:107], a[184:187], a[20:23], v[104:107]
    ds_read_b128 a[148:151], v136 offset:14336
    v_mul_f32 v90, v150, v178
    v_mfma_f32_16x16x32_bf16 v[108:111], a[184:187], a[92:95], v[108:111]
    s_sub_u32 s80, s53, 40960
    s_add_u32 s80, s80, s60
    s_add_u32 s81, s80, 4096
    v_mfma_f32_16x16x32_bf16 v[112:115], a[188:191], a[20:23], v[112:115]
    ds_read_b128 a[152:155], v136 offset:15360
    v_mul_f32 v91, v150, v179
    v_mfma_f32_16x16x32_bf16 v[116:119], a[188:191], a[92:95], v[116:119]
    s_sub_u32 s82, s53, 20480
    s_sub_u32 s82, s82, s60
    s_add_u32 s83, s82, 4096
    s_mul_i32 s62, s62, 5120
    s_cmp_lt_u32 s36, 1
    s_cselect_b32 s60, 268435456, 0
    s_cselect_b32 s84, 0, s44
    s_cselect_b32 s86, 0, s74
    v_add_u32 v208, s60, v1
    s_cmp_lt_u32 s36, 2
    s_cselect_b32 s60, 268435456, 0
    s_cselect_b32 s85, 0, s44
    s_cselect_b32 s87, 0, s74
    v_add_u32 v209, s60, v1
    s_waitcnt lgkmcnt(2)
    v_mfma_f32_16x16x32_bf16 v[104:107], a[192:195], a[24:27], v[104:107]
    ds_read_b128 a[156:159], v136 offset:16384
    ds_write_b128 v18, v[248:251] offset:44032
    v_mfma_f32_16x16x32_bf16 v[108:111], a[192:195], a[96:99], v[108:111]
    v_mul_f32 v92, v151, v176
    v_mfma_f32_16x16x32_bf16 v[112:115], a[144:147], a[24:27], v[112:115]
    ds_read_b128 a[160:163], v136 offset:17408
    v_mul_f32 v93, v151, v177
    v_mfma_f32_16x16x32_bf16 v[116:119], a[144:147], a[96:99], v[116:119]
    s_waitcnt lgkmcnt(3)
    v_mfma_f32_16x16x32_bf16 v[104:107], a[148:151], a[28:31], v[104:107]
    ds_read_b128 a[164:167], v136 offset:18432
    v_mul_f32 v94, v151, v178
    v_mfma_f32_16x16x32_bf16 v[108:111], a[148:151], a[100:103], v[108:111]
    s_mul_i32 s63, s38, 5120
    s_add_u32 s63, s63, 106240
    v_mfma_f32_16x16x32_bf16 v[112:115], a[152:155], a[28:31], v[112:115]
    ds_read_b128 a[168:171], v136 offset:19456
    v_add_u32 v32, s63, v1
    v_mfma_f32_16x16x32_bf16 v[116:119], a[152:155], a[100:103], v[116:119]
    v_mul_f32 v95, v151, v179
    s_waitcnt vmcnt(7)
    s_barrier
    s_waitcnt lgkmcnt(2)
    v_mfma_f32_16x16x32_bf16 v[104:107], a[156:159], a[32:35], v[104:107]
    ds_read_b128 a[172:175], v136 offset:20480
    ds_write_b128 v19, v[252:255] offset:40960
    v_mfma_f32_16x16x32_bf16 v[108:111], a[156:159], a[104:107], v[108:111]
    v_mul_f32 v96, v150, v180
    v_mfma_f32_16x16x32_bf16 v[112:115], a[160:163], a[32:35], v[112:115]
    ds_read_b128 a[176:179], v136 offset:21504
    v_mfma_f32_16x16x32_bf16 v[116:119], a[160:163], a[104:107], v[116:119]
    v_mul_f32 v97, v150, v181
    s_waitcnt lgkmcnt(3)
    v_mfma_f32_16x16x32_bf16 v[104:107], a[164:167], a[36:39], v[104:107]
    ds_read_b128 a[180:183], v136 offset:22528
    v_mfma_f32_16x16x32_bf16 v[108:111], a[164:167], a[108:111], v[108:111]
    v_mul_f32 v98, v150, v182
    v_mfma_f32_16x16x32_bf16 v[112:115], a[168:171], a[36:39], v[112:115]
    ds_read_b128 a[184:187], v136 offset:23552
    v_mfma_f32_16x16x32_bf16 v[116:119], a[168:171], a[108:111], v[116:119]
    v_mul_f32 v99, v150, v183
    s_mul_i32 s63, s38, 8192
    s_min_u32 s63, s63, 22528
    s_add_u32 s63, s63, 126720
    v_add_u32 v33, s63, v1
    v_mul_f32 v210, s8, -v35
    v_mul_f32 v211, s9, -v35
    s_waitcnt lgkmcnt(2)
    v_mfma_f32_16x16x32_bf16 v[104:107], a[172:175], a[40:43], v[104:107]
    ds_read_b128 a[188:191], v136 offset:24576
    s_mul_i32 s61, s38, 5120
    s_add_u32 m0, s61, 20480
    s_nop 0
    buffer_load_dwordx4 v209, s[32:35], s82 offen offset:0 sc1 lds
    v_mfma_f32_16x16x32_bf16 v[108:111], a[172:175], a[112:115], v[108:111]
    v_mul_f32 v100, v151, v180
    v_mfma_f32_16x16x32_bf16 v[112:115], a[176:179], a[40:43], v[112:115]
    ds_read_b128 a[192:195], v136 offset:25600
    v_mfma_f32_16x16x32_bf16 v[116:119], a[176:179], a[112:115], v[116:119]
    s_waitcnt lgkmcnt(2)
    v_mfma_f32_16x16x32_bf16 v[104:107], a[180:183], a[44:47], v[104:107]
    ds_read_b128 a[144:147], v136 offset:26624
    buffer_load_dwordx4 v209, s[32:35], s82 offen offset:1024 sc1 lds
    v_mul_f32 v101, v151, v181
    v_mfma_f32_16x16x32_bf16 v[108:111], a[180:183], a[116:119], v[108:111]
    v_mfma_f32_16x16x32_bf16 v[112:115], a[184:187], a[44:47], v[112:115]
    ds_read_b128 a[148:151], v136 offset:27648
    v_mul_f32 v102, v151, v182
    v_mfma_f32_16x16x32_bf16 v[116:119], a[184:187], a[116:119], v[116:119]
    s_waitcnt lgkmcnt(2)
    v_mfma_f32_16x16x32_bf16 v[104:107], a[188:191], a[48:51], v[104:107]
    ds_read_b128 a[152:155], v136 offset:28672
    buffer_load_dwordx4 v209, s[32:35], s82 offen offset:2048 sc1 lds
    v_mul_f32 v103, v151, v183
    v_mfma_f32_16x16x32_bf16 v[108:111], a[188:191], a[120:123], v[108:111]
    v_fma_f32 v232, v160, s9, v211
    v_fma_f32 v233, v161, s9, v211
    v_mfma_f32_16x16x32_bf16 v[112:115], a[192:195], a[48:51], v[112:115]
    ds_read_b128 a[156:159], v136 offset:29696
    v_add_u32 v38, 100352, v1
    v_mfma_f32_16x16x32_bf16 v[116:119], a[192:195], a[120:123], v[116:119]
    v_fma_f32 v234, v162, s9, v211
    s_waitcnt lgkmcnt(2)
    v_mfma_f32_16x16x32_bf16 v[104:107], a[144:147], a[52:55], v[104:107]
    ds_read_b128 a[160:163], v136 offset:30720
    buffer_load_dwordx4 v209, s[32:35], s82 offen offset:3072 sc1 lds
    v_add_u32 v39, 63488, v1
    v_mfma_f32_16x16x32_bf16 v[108:111], a[144:147], a[124:127], v[108:111]
    v_fma_f32 v235, v163, s9, v211
    v_fma_f32 v236, v164, s9, v211
    v_mfma_f32_16x16x32_bf16 v[112:115], a[148:151], a[52:55], v[112:115]
    ds_read_b128 a[164:167], v136 offset:31744
    v_mov_b32 v73, 0
    v_mfma_f32_16x16x32_bf16 v[116:119], a[148:151], a[124:127], v[116:119]
    v_fma_f32 v237, v165, s9, v211
    s_waitcnt lgkmcnt(2)
    v_mfma_f32_16x16x32_bf16 v[104:107], a[152:155], a[56:59], v[104:107]
    ds_read_b128 a[168:171], v136 offset:32768
    s_add_u32 m0, s61, 24576
    s_nop 0
    buffer_load_dwordx4 v209, s[32:35], s83 offen offset:0 sc1 lds
    v_mov_b32 v74, 0
    v_mfma_f32_16x16x32_bf16 v[108:111], a[152:155], a[128:131], v[108:111]
    v_fma_f32 v238, v166, s9, v211
    v_fma_f32 v239, v167, s9, v211
    v_mfma_f32_16x16x32_bf16 v[112:115], a[156:159], a[56:59], v[112:115]
    ds_read_b128 a[172:175], v136 offset:33792
    v_fma_f32 v240, v168, s9, v211
    v_mfma_f32_16x16x32_bf16 v[116:119], a[156:159], a[128:131], v[116:119]
    v_mov_b32 v75, 0
    s_waitcnt lgkmcnt(2)
    v_mfma_f32_16x16x32_bf16 v[104:107], a[160:163], a[60:63], v[104:107]
    ds_read_b128 a[176:179], v136 offset:34816
    v_fma_f32 v241, v169, s9, v211
    v_mfma_f32_16x16x32_bf16 v[108:111], a[160:163], a[132:135], v[108:111]
    v_mov_b32 v76, 0
    v_fma_f32 v242, v170, s9, v211
    v_mfma_f32_16x16x32_bf16 v[112:115], a[164:167], a[60:63], v[112:115]
    ds_read_b128 a[180:183], v136 offset:35840
    v_fma_f32 v243, v171, s9, v211
    v_mfma_f32_16x16x32_bf16 v[116:119], a[164:167], a[132:135], v[116:119]
    v_mov_b32 v78, 0
    s_waitcnt lgkmcnt(2)
    v_mfma_f32_16x16x32_bf16 v[104:107], a[168:171], a[64:67], v[104:107]
    v_fma_f32 v244, v172, s9, v211
    v_fma_f32 v245, v173, s9, v211
    v_mfma_f32_16x16x32_bf16 v[108:111], a[168:171], a[136:139], v[108:111]
    v_mov_b32 v79, 0
    v_fma_f32 v246, v174, s9, v211
    v_mfma_f32_16x16x32_bf16 v[112:115], a[172:175], a[64:67], v[112:115]
    v_fma_f32 v247, v175, s9, v211
    v_mfma_f32_16x16x32_bf16 v[116:119], a[172:175], a[136:139], v[116:119]
    v_cndmask_b32 v72, 0, v30, s[70:71]
    s_waitcnt lgkmcnt(0)
    v_mfma_f32_16x16x32_bf16 v[104:107], a[176:179], a[68:71], v[104:107]
    v_subrev_u32 v248, s62, v3
    v_subrev_u32 v249, s62, v19
    v_mfma_f32_16x16x32_bf16 v[108:111], a[176:179], a[140:143], v[108:111]
    v_cndmask_b32 v77, 0, v31, s[70:71]
    v_subrev_u32 v250, s62, v4
    v_mfma_f32_16x16x32_bf16 v[112:115], a[180:183], a[68:71], v[112:115]
    v_subrev_u32 v251, s62, v5
    v_mfma_f32_16x16x32_bf16 v[116:119], a[180:183], a[140:143], v[116:119]
    ds_read_b128 v[192:195], v3 offset:40960
    ds_read_b128 v[200:203], v19 offset:40960
    ds_read_b128 v[196:199], v3 offset:41984
    ds_read_b64_tr_b16 v[176:177], v4 offset:40960
    ds_read_b64_tr_b16 v[178:179], v4 offset:41088
    ds_read_b64_tr_b16 v[180:181], v4 offset:41216
    ds_read_b64_tr_b16 v[182:183], v4 offset:41344
    v_pk_fma_f32 v[104:105], v[104:105], v[148:149], v[88:89] op_sel:[0,0,0] op_sel_hi:[1,0,1]
    v_pk_fma_f32 v[106:107], v[106:107], v[148:149], v[90:91] op_sel:[0,0,0] op_sel_hi:[1,0,1]
    v_pk_fma_f32 v[108:109], v[108:109], v[148:149], v[92:93] op_sel:[0,1,0] op_sel_hi:[1,1,1]
    v_pk_fma_f32 v[110:111], v[110:111], v[148:149], v[94:95] op_sel:[0,1,0] op_sel_hi:[1,1,1]
    v_cvt_pk_bf16_f32 v64, v104, v105
    v_cvt_pk_bf16_f32 v66, v108, v109
    v_cvt_pk_bf16_f32 v65, v106, v107
    v_cvt_pk_bf16_f32 v67, v110, v111
    v_pk_fma_f32 v[112:113], v[112:113], v[148:149], v[96:97] op_sel:[0,0,0] op_sel_hi:[1,0,1]
    v_pk_fma_f32 v[114:115], v[114:115], v[148:149], v[98:99] op_sel:[0,0,0] op_sel_hi:[1,0,1]
    v_permlane16_swap_b32 v64, v66
    v_permlane16_swap_b32 v65, v67
    v_pk_fma_f32 v[116:117], v[116:117], v[148:149], v[100:101] op_sel:[0,1,0] op_sel_hi:[1,1,1]
    v_pk_fma_f32 v[118:119], v[118:119], v[148:149], v[102:103] op_sel:[0,1,0] op_sel_hi:[1,1,1]
    s_waitcnt lgkmcnt(6)
    v_mfma_f32_32x32x16_bf16 v[80:95], v[192:195], v[64:67], v[160:175]
    v_cvt_pk_bf16_f32 v68, v112, v113
    v_cvt_pk_bf16_f32 v70, v116, v117
    v_cvt_pk_bf16_f32 v69, v114, v115
    v_cvt_pk_bf16_f32 v71, v118, v119
    s_waitcnt lgkmcnt(5)
    v_mfma_f32_32x32x16_bf16 v[80:95], v[200:203], v[72:75], v[80:95]
    ds_read_b128 a[176:179], v32 offset:0
    ds_read_b128 a[180:183], v32 offset:1024
    ds_read_b128 a[184:187], v32 offset:2048
    ds_read_b128 a[188:191], v32 offset:3072
    ds_read_b128 a[192:195], v32 offset:4096
    ds_read_b128 a[144:147], v33 offset:0
    ds_read_b128 a[148:151], v33 offset:1024
    ds_read_b128 a[152:155], v33 offset:2048
    ds_read_b128 a[156:159], v33 offset:3072
    ds_read_b128 a[160:163], v33 offset:4096
    ds_read_b128 a[164:167], v33 offset:5120
    ds_read_b128 a[168:171], v33 offset:6144
    ds_read_b128 a[172:175], v33 offset:7168
    v_permlane16_swap_b32 v68, v70
    v_permlane16_swap_b32 v69, v71
L_rerun1:
    v_exp_f32 v80, v80
    v_exp_f32 v81, v81
    v_exp_f32 v82, v82
    v_exp_f32 v83, v83
    s_waitcnt lgkmcnt(15)
    v_mfma_f32_32x32x16_bf16 v[96:111], v[196:199], v[68:71], v[160:175]
    v_exp_f32 v84, v84
    v_cvt_pk_bf16_f32 v112, v80, v81
    v_exp_f32 v85, v85
    v_cvt_pk_bf16_f32 v113, v82, v83
    v_exp_f32 v86, v86
    v_exp_f32 v87, v87
    v_mfma_f32_32x32x16_bf16 v[96:111], v[200:203], v[76:79], v[96:111]
    v_exp_f32 v88, v88
    v_cvt_pk_bf16_f32 v114, v84, v85
    v_exp_f32 v89, v89
    v_cvt_pk_bf16_f32 v115, v86, v87
    v_exp_f32 v90, v90
    v_exp_f32 v91, v91
    v_exp_f32 v92, v92
    v_cvt_pk_bf16_f32 v116, v88, v89
    v_exp_f32 v93, v93
    v_cvt_pk_bf16_f32 v117, v90, v91
    v_exp_f32 v94, v94
    v_exp_f32 v95, v95
    s_waitcnt lgkmcnt(0)
    v_mfma_f32_32x32x16_bf16 v[128:143], v[176:179], v[112:115], 0
    ds_read_b64_tr_b16 v[184:185], v5 offset:40960
    ds_read_b64_tr_b16 v[186:187], v5 offset:41088
    ds_read_b64_tr_b16 v[188:189], v5 offset:41216
    s_waitcnt vmcnt(0)
    ds_read_b128 v[212:215], v3 offset:20480
    ds_read_b128 v[216:219], v3 offset:21504
    ds_read_b128 v[220:223], v18 offset:22528
    ds_read_b128 v[224:227], v18 offset:23552
    ds_read_b128 v[228:231], v19 offset:20480
    v_exp_f32 v96, v96
    v_cvt_pk_bf16_f32 v118, v92, v93
    v_exp_f32 v97, v97
    v_cvt_pk_bf16_f32 v119, v94, v95
    v_exp_f32 v98, v98
    v_exp_f32 v99, v99
    v_mfma_f32_32x32x16_bf16 v[128:143], v[180:183], v[116:119], v[128:143]
    ds_read_b64_tr_b16 v[190:191], v5 offset:41344
    v_exp_f32 v100, v100
    v_cvt_pk_bf16_f32 v120, v96, v97
    v_exp_f32 v101, v101
    v_cvt_pk_bf16_f32 v121, v98, v99
    v_exp_f32 v102, v102
    v_exp_f32 v103, v103
    s_cmp_lg_u32 s55, 0
    s_cbranch_scc1 rr_26
    s_waitcnt lgkmcnt(1)
chk_28:
    s_sub_u32 s43, s43, 1
    s_cselect_b64 s[68:69], 0, -1
    s_max_i32 s43, s43, 0
    v_add3_u32 v24, s85, v212, v213
    v_add3_u32 v24, v24, v214, v215
    v_add3_u32 v24, v24, v216, v217
    v_add3_u32 v24, v24, v218, v219
    v_add3_u32 v24, v24, v220, v221
    v_add3_u32 v24, v24, v222, v223
    v_add3_u32 v24, v24, v224, v225
    v_add3_u32 v24, v24, v226, v227
    v_add3_u32 v24, v24, v228, v229
    v_cmp_ne_u32 s[56:57], s87, v230
    v_and_b32 v24, 0xbfffbfff, v24
    v_cmp_ne_u32 vcc, v24, v231
    s_or_b64 vcc, vcc, s[56:57]
    s_and_b64 vcc, vcc, s[68:69]
    s_cbranch_scc0 ok_29
    s_nop 1
    s_mov_b32 s58, m0
    s_mul_i32 s61, s38, 5120
    s_add_u32 m0, s61, 20480
    s_nop 0
    buffer_load_dwordx4 v209, s[32:35], s82 offen offset:0 sc1 lds
    buffer_load_dwordx4 v209, s[32:35], s82 offen offset:1024 sc1 lds
    buffer_load_dwordx4 v209, s[32:35], s82 offen offset:2048 sc1 lds
    buffer_load_dwordx4 v209, s[32:35], s82 offen offset:3072 sc1 lds
    s_add_u32 m0, s61, 24576
    s_nop 0
    buffer_load_dwordx4 v209, s[32:35], s83 offen offset:0 sc1 lds
    s_waitcnt vmcnt(0)
    ds_read_b128 v[212:215], v3 offset:20480
    ds_read_b128 v[216:219], v3 offset:21504
    ds_read_b128 v[220:223], v18 offset:22528
    ds_read_b128 v[224:227], v18 offset:23552
    ds_read_b128 v[228:231], v19 offset:20480
    s_mov_b32 m0, s58
    s_waitcnt lgkmcnt(0)
    s_branch chk_28
ok_29:
    s_waitcnt lgkmcnt(0)
    s_barrier
rb_27:
    ds_read_b128 v[192:195], v3 offset:35840
    ds_read_b128 v[204:207], v19 offset:35840
    ds_read_b128 v[196:199], v3 offset:36864
    v_exp_f32 v104, v104
    v_cvt_pk_bf16_f32 v122, v100, v101
    v_exp_f32 v105, v105
    v_cvt_pk_bf16_f32 v123, v102, v103
    v_exp_f32 v106, v106
    v_exp_f32 v107, v107
    v_exp_f32 v108, v108
    v_cvt_pk_bf16_f32 v124, v104, v105
    v_exp_f32 v109, v109
    v_cvt_pk_bf16_f32 v125, v106, v107
    v_exp_f32 v110, v110
    v_exp_f32 v111, v111
    v_cvt_pk_bf16_f32 v126, v108, v109
    v_cvt_pk_bf16_f32 v127, v110, v111
    s_waitcnt lgkmcnt(2)
    v_mfma_f32_32x32x16_bf16 v[80:95], v[192:195], v[64:67], 0
    v_fma_f32 v160, v160, s8, v210
    v_fma_f32 v161, v161, s8, v210
    v_fma_f32 v162, v162, s8, v210
    v_fma_f32 v163, v163, s8, v210
    v_fma_f32 v164, v164, s8, v210
    v_fma_f32 v165, v165, s8, v210
    s_waitcnt lgkmcnt(1)
    v_mfma_f32_32x32x16_bf16 v[80:95], v[204:207], v[72:75], v[80:95]
    v_fma_f32 v166, v166, s8, v210
    v_fma_f32 v167, v167, s8, v210
    v_fma_f32 v168, v168, s8, v210
    v_fma_f32 v169, v169, s8, v210
    v_fma_f32 v170, v170, s8, v210
    v_fma_f32 v171, v171, s8, v210
    v_fma_f32 v172, v172, s8, v210
    v_fma_f32 v173, v173, s8, v210
    v_fma_f32 v174, v174, s8, v210
    v_fma_f32 v175, v175, s8, v210
    s_waitcnt lgkmcnt(0)
    v_mfma_f32_32x32x16_bf16 v[144:159], v[184:187], v[120:123], 0
    ds_read_b64_tr_b16 v[176:177], v4 offset:35840
    ds_read_b64_tr_b16 v[178:179], v4 offset:35968
    ds_read_b64_tr_b16 v[180:181], v4 offset:36096
    v_exp_f32 v80, v80
    v_exp_f32 v81, v81
    v_exp_f32 v82, v82
    v_exp_f32 v83, v83
    v_mfma_f32_32x32x16_bf16 v[96:111], v[196:199], v[68:71], 0
    ds_read_b64_tr_b16 v[182:183], v4 offset:36224
    ds_read_b128 v[192:195], v3 offset:30720
    ds_read_b128 v[200:203], v19 offset:30720
    s_mul_i32 s61, s38, 5120
    s_add_u32 m0, s61, 0
    s_nop 0
    buffer_load_dwordx4 v208, s[32:35], s80 offen offset:0 sc1 lds
    v_exp_f32 v84, v84
    v_cvt_pk_bf16_f32 v112, v80, v81
    v_exp_f32 v85, v85
    v_cvt_pk_bf16_f32 v113, v82, v83
    v_exp_f32 v86, v86
    v_exp_f32 v87, v87
    v_mfma_f32_32x32x16_bf16 v[96:111], v[204:207], v[76:79], v[96:111]
    buffer_load_dwordx4 v208, s[32:35], s80 offen offset:1024 sc1 lds
    v_exp_f32 v88, v88
    v_cvt_pk_bf16_f32 v114, v84, v85
    v_exp_f32 v89, v89
    v_cvt_pk_bf16_f32 v115, v86, v87
    v_exp_f32 v90, v90
    v_exp_f32 v91, v91
    v_mfma_f32_32x32x16_bf16 v[144:159], v[188:191], v[124:127], v[144:159]
    buffer_load_dwordx4 v208, s[32:35], s80 offen offset:2048 sc1 lds
    v_exp_f32 v92, v92
    v_cvt_pk_bf16_f32 v116, v88, v89
    v_exp_f32 v93, v93
    v_cvt_pk_bf16_f32 v117, v90, v91
    v_exp_f32 v94, v94
    v_exp_f32 v95, v95
    s_waitcnt lgkmcnt(0)
    v_mfma_f32_32x32x16_bf16 v[128:143], v[176:179], v[112:115], v[128:143]
    ds_read_b64_tr_b16 v[184:185], v5 offset:35840
    ds_read_b64_tr_b16 v[186:187], v5 offset:35968
    ds_read_b64_tr_b16 v[188:189], v5 offset:36096
    v_exp_f32 v96, v96
    v_cvt_pk_bf16_f32 v118, v92, v93
    v_exp_f32 v97, v97
    v_cvt_pk_bf16_f32 v119, v94, v95
    v_exp_f32 v98, v98
    v_exp_f32 v99, v99
    v_mfma_f32_32x32x16_bf16 v[80:95], v[192:195], v[64:67], 0
    ds_read_b64_tr_b16 v[190:191], v5 offset:36224
    ds_read_b128 v[196:199], v3 offset:31744
    buffer_load_dwordx4 v208, s[32:35], s80 offen offset:3072 sc1 lds
    v_exp_f32 v100, v100
    v_cvt_pk_bf16_f32 v120, v96, v97
    v_exp_f32 v101, v101
    v_cvt_pk_bf16_f32 v121, v98, v99
    v_exp_f32 v102, v102
    v_exp_f32 v103, v103
    v_mfma_f32_32x32x16_bf16 v[80:95], v[200:203], v[72:75], v[80:95]
    s_add_u32 m0, s61, 4096
    s_nop 0
    buffer_load_dwordx4 v208, s[32:35], s81 offen offset:0 sc1 lds
    v_exp_f32 v104, v104
    v_cvt_pk_bf16_f32 v122, v100, v101
    v_exp_f32 v105, v105
    v_cvt_pk_bf16_f32 v123, v102, v103
    v_exp_f32 v106, v106
    v_exp_f32 v107, v107
    v_mfma_f32_32x32x16_bf16 v[128:143], v[180:183], v[116:119], v[128:143]
    v_exp_f32 v108, v108
    v_cvt_pk_bf16_f32 v124, v104, v105
    v_exp_f32 v109, v109
    v_cvt_pk_bf16_f32 v125, v106, v107
    v_exp_f32 v110, v110
    v_exp_f32 v111, v111
    s_waitcnt lgkmcnt(0)
    v_mfma_f32_32x32x16_bf16 v[144:159], v[184:187], v[120:123], v[144:159]
    ds_read_b64_tr_b16 v[176:177], v4 offset:30720
    ds_read_b64_tr_b16 v[178:179], v4 offset:30848
    ds_read_b64_tr_b16 v[180:181], v4 offset:30976
    v_exp_f32 v80, v80
    v_cvt_pk_bf16_f32 v126, v108, v109
    v_exp_f32 v81, v81
    v_cvt_pk_bf16_f32 v127, v110, v111
    v_exp_f32 v82, v82
    v_exp_f32 v83, v83
    v_mfma_f32_32x32x16_bf16 v[96:111], v[196:199], v[68:71], 0
    ds_read_b64_tr_b16 v[182:183], v4 offset:31104
    ds_read_b128 v[192:195], v3 offset:25600
    ds_read_b128 v[204:207], v19 offset:25600
    v_exp_f32 v84, v84
    v_cvt_pk_bf16_f32 v112, v80, v81
    v_exp_f32 v85, v85
    v_cvt_pk_bf16_f32 v113, v82, v83
    v_exp_f32 v86, v86
    v_exp_f32 v87, v87
    v_mfma_f32_32x32x16_bf16 v[96:111], v[200:203], v[76:79], v[96:111]
    v_exp_f32 v88, v88
    v_cvt_pk_bf16_f32 v114, v84, v85
    v_exp_f32 v89, v89
    v_cvt_pk_bf16_f32 v115, v86, v87
    v_exp_f32 v90, v90
    v_exp_f32 v91, v91
    v_mfma_f32_32x32x16_bf16 v[144:159], v[188:191], v[124:127], v[144:159]
    v_exp_f32 v92, v92
    v_cvt_pk_bf16_f32 v116, v88, v89
    v_exp_f32 v93, v93
    v_cvt_pk_bf16_f32 v117, v90, v91
    v_exp_f32 v94, v94
    v_exp_f32 v95, v95
    s_waitcnt lgkmcnt(0)
    v_mfma_f32_32x32x16_bf16 v[128:143], v[176:179], v[112:115], v[128:143]
    ds_read_b64_tr_b16 v[184:185], v5 offset:30720
    ds_read_b64_tr_b16 v[186:187], v5 offset:30848
    ds_read_b64_tr_b16 v[188:189], v5 offset:30976
    v_exp_f32 v96, v96
    v_cvt_pk_bf16_f32 v118, v92, v93
    v_exp_f32 v97, v97
    v_cvt_pk_bf16_f32 v119, v94, v95
L_hop4:
    s_cbranch_execz L_hop8
    v_exp_f32 v98, v98
    v_exp_f32 v99, v99
    v_mfma_f32_32x32x16_bf16 v[80:95], v[192:195], v[64:67], 0
    ds_read_b64_tr_b16 v[190:191], v5 offset:31104
    ds_read_b128 v[196:199], v3 offset:26624
    v_exp_f32 v100, v100
    v_cvt_pk_bf16_f32 v120, v96, v97
    v_exp_f32 v101, v101
    v_cvt_pk_bf16_f32 v121, v98, v99
    v_exp_f32 v102, v102
    v_exp_f32 v103, v103
    v_mfma_f32_32x32x16_bf16 v[80:95], v[204:207], v[72:75], v[80:95]
    v_exp_f32 v104, v104
    v_cvt_pk_bf16_f32 v122, v100, v101
    v_exp_f32 v105, v105
    v_cvt_pk_bf16_f32 v123, v102, v103
    v_exp_f32 v106, v106
    v_exp_f32 v107, v107
    v_mfma_f32_32x32x16_bf16 v[128:143], v[180:183], v[116:119], v[128:143]
    v_exp_f32 v108, v108
    v_cvt_pk_bf16_f32 v124, v104, v105
    v_exp_f32 v109, v109
    v_cvt_pk_bf16_f32 v125, v106, v107
    v_exp_f32 v110, v110
    v_exp_f32 v111, v111
    s_waitcnt lgkmcnt(0)
    v_mfma_f32_32x32x16_bf16 v[144:159], v[184:187], v[120:123], v[144:159]
    ds_read_b64_tr_b16 v[176:177], v4 offset:25600
    ds_read_b64_tr_b16 v[178:179], v4 offset:25728
    ds_read_b64_tr_b16 v[180:181], v4 offset:25856
    v_exp_f32 v80, v80
    v_cvt_pk_bf16_f32 v126, v108, v109
    v_exp_f32 v81, v81
    v_cvt_pk_bf16_f32 v127, v110, v111
    v_exp_f32 v82, v82
    v_exp_f32 v83, v83
    v_mfma_f32_32x32x16_bf16 v[96:111], v[196:199], v[68:71], 0
    ds_read_b64_tr_b16 v[182:183], v4 offset:25984
    ds_read_b128 v[192:195], v3 offset:20480
    ds_read_b128 v[200:203], v19 offset:20480
    v_exp_f32 v84, v84
    v_cvt_pk_bf16_f32 v112, v80, v81
    v_exp_f32 v85, v85
    v_cvt_pk_bf16_f32 v113, v82, v83
    v_exp_f32 v86, v86
    v_exp_f32 v87, v87
    v_mfma_f32_32x32x16_bf16 v[96:111], v[204:207], v[76:79], v[96:111]
    v_exp_f32 v88, v88
    v_cvt_pk_bf16_f32 v114, v84, v85
    v_exp_f32 v89, v89
    v_cvt_pk_bf16_f32 v115, v86, v87
    v_exp_f32 v90, v90
    v_exp_f32 v91, v91
    v_mfma_f32_32x32x16_bf16 v[144:159], v[188:191], v[124:127], v[144:159]
    v_exp_f32 v92, v92
    v_cvt_pk_bf16_f32 v116, v88, v89
    v_exp_f32 v93, v93
    v_cvt_pk_bf16_f32 v117, v90, v91
    v_exp_f32 v94, v94
    v_exp_f32 v95, v95
    s_waitcnt lgkmcnt(0)
    v_mfma_f32_32x32x16_bf16 v[128:143], v[176:179], v[112:115], v[128:143]
    ds_read_b64_tr_b16 v[184:185], v5 offset:25600
    ds_read_b64_tr_b16 v[186:187], v5 offset:25728
    ds_read_b64_tr_b16 v[188:189], v5 offset:25856
    v_exp_f32 v96, v96
    v_cvt_pk_bf16_f32 v118, v92, v93
    v_exp_f32 v97, v97
    v_cvt_pk_bf16_f32 v119, v94, v95
    v_exp_f32 v98, v98
    v_exp_f32 v99, v99
    v_mfma_f32_32x32x16_bf16 v[80:95], v[192:195], v[64:67], v[232:247]
    ds_read_b64_tr_b16 v[190:191], v5 offset:25984
    ds_read_b128 v[196:199], v3 offset:21504
    v_exp_f32 v100, v100
    v_cvt_pk_bf16_f32 v120, v96, v97
    v_exp_f32 v101, v101
    v_cvt_pk_bf16_f32 v121, v98, v99
    v_exp_f32 v102, v102
    v_exp_f32 v103, v103
    v_mfma_f32_32x32x16_bf16 v[80:95], v[200:203], v[72:75], v[80:95]
    s_waitcnt vmcnt(0)
    ds_read_b128 v[212:215], v3 offset:0
    ds_read_b128 v[216:219], v3 offset:1024
    ds_read_b128 v[220:223], v18 offset:2048
    ds_read_b128 v[224:227], v18 offset:3072
    ds_read_b128 v[228:231], v19 offset:0
    v_exp_f32 v104, v104
    v_cvt_pk_bf16_f32 v122, v100, v101
    v_exp_f32 v105, v105
    v_cvt_pk_bf16_f32 v123, v102, v103
    v_exp_f32 v106, v106
    v_exp_f32 v107, v107
    v_mfma_f32_32x32x16_bf16 v[128:143], v[180:183], v[116:119], v[128:143]
    v_exp_f32 v108, v108
    v_cvt_pk_bf16_f32 v124, v104, v105
    v_exp_f32 v109, v109
    v_cvt_pk_bf16_f32 v125, v106, v107
    v_exp_f32 v110, v110
    v_exp_f32 v111, v111
    s_waitcnt lgkmcnt(0)
    s_cmp_lg_u32 s55, 0
    s_cbranch_scc1 rr_30
chk_32:
    s_sub_u32 s43, s43, 1
    s_cselect_b64 s[68:69], 0, -1
    s_max_i32 s43, s43, 0
    v_add3_u32 v24, s84, v212, v213
    v_add3_u32 v24, v24, v214, v215
    v_add3_u32 v24, v24, v216, v217
    v_add3_u32 v24, v24, v218, v219
    v_add3_u32 v24, v24, v220, v221
    v_add3_u32 v24, v24, v222, v223
    v_add3_u32 v24, v24, v224, v225
    v_add3_u32 v24, v24, v226, v227
    v_add3_u32 v24, v24, v228, v229
    v_cmp_ne_u32 s[56:57], s86, v230
    v_and_b32 v24, 0xbfffbfff, v24
    v_cmp_ne_u32 vcc, v24, v231
    s_or_b64 vcc, vcc, s[56:57]
    s_and_b64 vcc, vcc, s[68:69]
    s_cbranch_scc0 ok_33
    s_nop 1
    s_mov_b32 s58, m0
    s_mul_i32 s61, s38, 5120
    s_add_u32 m0, s61, 0
    s_nop 0
    buffer_load_dwordx4 v208, s[32:35], s80 offen offset:0 sc1 lds
    buffer_load_dwordx4 v208, s[32:35], s80 offen offset:1024 sc1 lds
    buffer_load_dwordx4 v208, s[32:35], s80 offen offset:2048 sc1 lds
    buffer_load_dwordx4 v208, s[32:35], s80 offen offset:3072 sc1 lds
    s_add_u32 m0, s61, 4096
    s_nop 0
    buffer_load_dwordx4 v208, s[32:35], s81 offen offset:0 sc1 lds
    s_waitcnt vmcnt(0)
    ds_read_b128 v[212:215], v3 offset:0
    ds_read_b128 v[216:219], v3 offset:1024
    ds_read_b128 v[220:223], v18 offset:2048
    ds_read_b128 v[224:227], v18 offset:3072
    ds_read_b128 v[228:231], v19 offset:0
    s_mov_b32 m0, s58
    s_waitcnt lgkmcnt(0)
    s_branch chk_32
ok_33:
    s_waitcnt lgkmcnt(0)
    s_barrier
rb_31:
    v_mfma_f32_32x32x16_bf16 v[144:159], v[184:187], v[120:123], v[144:159]
    ds_read_b64_tr_b16 v[176:177], v4 offset:20480
    ds_read_b64_tr_b16 v[178:179], v4 offset:20608
    ds_read_b64_tr_b16 v[180:181], v4 offset:20736
    v_exp_f32 v80, v80
    v_cvt_pk_bf16_f32 v126, v108, v109
    v_exp_f32 v81, v81
    v_cvt_pk_bf16_f32 v127, v110, v111
    v_exp_f32 v82, v82
    v_exp_f32 v83, v83
    v_mfma_f32_32x32x16_bf16 v[96:111], v[196:199], v[68:71], v[232:247]
    ds_read_b64_tr_b16 v[182:183], v4 offset:20864
    ds_read_b128 v[192:195], v248 offset:15360
    ds_read_b128 v[204:207], v249 offset:15360
    s_mul_i32 s67, s38, 14336
    s_add_u32 s66, s67, s89
    s_add_u32 m0, s67, 100352
    s_add_u32 s66, s66, 46802944
    buffer_load_dwordx4 v1, s[32:35], s66 offen lds
    v_exp_f32 v84, v84
    v_cvt_pk_bf16_f32 v112, v80, v81
    v_exp_f32 v85, v85
    v_cvt_pk_bf16_f32 v113, v82, v83
    v_exp_f32 v86, v86
    v_exp_f32 v87, v87
    v_mfma_f32_32x32x16_bf16 v[96:111], v[200:203], v[76:79], v[96:111]
    buffer_load_dwordx4 v1, s[32:35], s66 offen offset:1024 lds
    v_exp_f32 v88, v88
    v_cvt_pk_bf16_f32 v114, v84, v85
    v_exp_f32 v89, v89
    v_cvt_pk_bf16_f32 v115, v86, v87
    v_exp_f32 v90, v90
    v_exp_f32 v91, v91
    v_mfma_f32_32x32x16_bf16 v[144:159], v[188:191], v[124:127], v[144:159]
    buffer_load_dwordx4 v1, s[32:35], s66 offen offset:2048 lds
    v_exp_f32 v92, v92
    v_cvt_pk_bf16_f32 v116, v88, v89
    v_exp_f32 v93, v93
    v_cvt_pk_bf16_f32 v117, v90, v91
    v_exp_f32 v94, v94
    v_exp_f32 v95, v95
    s_waitcnt lgkmcnt(0)
    v_mfma_f32_32x32x16_bf16 v[128:143], v[176:179], v[112:115], v[128:143]
    ds_read_b64_tr_b16 v[184:185], v5 offset:20480
    ds_read_b64_tr_b16 v[186:187], v5 offset:20608
    ds_read_b64_tr_b16 v[188:189], v5 offset:20736
    v_exp_f32 v96, v96
    v_cvt_pk_bf16_f32 v118, v92, v93
    v_exp_f32 v97, v97
    v_cvt_pk_bf16_f32 v119, v94, v95
    v_exp_f32 v98, v98
    v_exp_f32 v99, v99
    v_mfma_f32_32x32x16_bf16 v[80:95], v[192:195], v[64:67], 0
    ds_read_b64_tr_b16 v[190:191], v5 offset:20864
    ds_read_b128 v[196:199], v248 offset:16384
    buffer_load_dwordx4 v1, s[32:35], s66 offen offset:3072 lds
    v_exp_f32 v100, v100
    v_cvt_pk_bf16_f32 v120, v96, v97
    v_exp_f32 v101, v101
    v_cvt_pk_bf16_f32 v121, v98, v99
    v_exp_f32 v102, v102
    v_exp_f32 v103, v103
    v_mfma_f32_32x32x16_bf16 v[80:95], v[204:207], v[72:75], v[80:95]
    s_add_u32 m0, s67, 104448
    s_add_u32 s66, s66, 4096
    buffer_load_dwordx4 v1, s[32:35], s66 offen lds
    v_exp_f32 v104, v104
    v_cvt_pk_bf16_f32 v122, v100, v101
    v_exp_f32 v105, v105
    v_cvt_pk_bf16_f32 v123, v102, v103
    v_exp_f32 v106, v106
    v_exp_f32 v107, v107
    v_mfma_f32_32x32x16_bf16 v[128:143], v[180:183], v[116:119], v[128:143]
    buffer_load_dwordx4 v1, s[32:35], s66 offen offset:1024 lds
    v_exp_f32 v108, v108
    v_cvt_pk_bf16_f32 v124, v104, v105
    v_exp_f32 v109, v109
    v_cvt_pk_bf16_f32 v125, v106, v107
    v_exp_f32 v110, v110
    v_exp_f32 v111, v111
    s_waitcnt lgkmcnt(0)
    v_mfma_f32_32x32x16_bf16 v[144:159], v[184:187], v[120:123], v[144:159]
    ds_read_b64_tr_b16 v[176:177], v250 offset:15360
    ds_read_b64_tr_b16 v[178:179], v250 offset:15488
    ds_read_b64_tr_b16 v[180:181], v250 offset:15616
    v_exp_f32 v80, v80
    v_cvt_pk_bf16_f32 v126, v108, v109
    v_exp_f32 v81, v81
    v_cvt_pk_bf16_f32 v127, v110, v111
    v_exp_f32 v82, v82
    v_exp_f32 v83, v83
    v_mfma_f32_32x32x16_bf16 v[96:111], v[196:199], v[68:71], 0
    ds_read_b64_tr_b16 v[182:183], v250 offset:15744
    ds_read_b128 v[192:195], v248 offset:10240
    ds_read_b128 v[200:203], v249 offset:10240
    buffer_load_dwordx4 v1, s[32:35], s66 offen offset:2048 lds
    v_exp_f32 v84, v84
    v_cvt_pk_bf16_f32 v112, v80, v81
    v_exp_f32 v85, v85
    v_cvt_pk_bf16_f32 v113, v82, v83
    v_exp_f32 v86, v86
    v_exp_f32 v87, v87
    v_mfma_f32_32x32x16_bf16 v[96:111], v[204:207], v[76:79], v[96:111]
    buffer_load_dwordx4 v1, s[32:35], s66 offen offset:3072 lds
    v_exp_f32 v88, v88
    v_cvt_pk_bf16_f32 v114, v84, v85
    v_exp_f32 v89, v89
    v_cvt_pk_bf16_f32 v115, v86, v87
    v_exp_f32 v90, v90
    v_exp_f32 v91, v91
    v_mfma_f32_32x32x16_bf16 v[144:159], v[188:191], v[124:127], v[144:159]
    s_add_u32 m0, s67, 108544
    s_add_u32 s66, s66, 4096
    buffer_load_dwordx4 v1, s[32:35], s66 offen lds
    v_exp_f32 v92, v92
    v_cvt_pk_bf16_f32 v116, v88, v89
    v_exp_f32 v93, v93
    v_cvt_pk_bf16_f32 v117, v90, v91
    v_exp_f32 v94, v94
    v_exp_f32 v95, v95
    s_waitcnt lgkmcnt(0)
    v_mfma_f32_32x32x16_bf16 v[128:143], v[176:179], v[112:115], v[128:143]
    ds_read_b64_tr_b16 v[184:185], v251 offset:15360
    ds_read_b64_tr_b16 v[186:187], v251 offset:15488
    ds_read_b64_tr_b16 v[188:189], v251 offset:15616
    v_exp_f32 v96, v96
    v_cvt_pk_bf16_f32 v118, v92, v93
    v_exp_f32 v97, v97
    v_cvt_pk_bf16_f32 v119, v94, v95
    v_exp_f32 v98, v98
    v_exp_f32 v99, v99
    v_mfma_f32_32x32x16_bf16 v[80:95], v[192:195], v[64:67], 0
    ds_read_b64_tr_b16 v[190:191], v251 offset:15744
    ds_read_b128 v[196:199], v248 offset:11264
    buffer_load_dwordx4 v1, s[32:35], s66 offen offset:1024 lds
    v_exp_f32 v100, v100
    v_cvt_pk_bf16_f32 v120, v96, v97
    v_exp_f32 v101, v101
    v_cvt_pk_bf16_f32 v121, v98, v99
    v_exp_f32 v102, v102
    v_exp_f32 v103, v103
    v_mfma_f32_32x32x16_bf16 v[80:95], v[200:203], v[72:75], v[80:95]
    buffer_load_dwordx4 v1, s[32:35], s66 offen offset:2048 lds
    v_exp_f32 v104, v104
    v_cvt_pk_bf16_f32 v122, v100, v101
    v_exp_f32 v105, v105
    v_cvt_pk_bf16_f32 v123, v102, v103
    v_exp_f32 v106, v106
    v_exp_f32 v107, v107
    v_mfma_f32_32x32x16_bf16 v[128:143], v[180:183], v[116:119], v[128:143]
    buffer_load_dwordx4 v1, s[32:35], s66 offen offset:3072 lds
    v_exp_f32 v108, v108
    v_cvt_pk_bf16_f32 v124, v104, v105
    v_exp_f32 v109, v109
    v_cvt_pk_bf16_f32 v125, v106, v107
    v_exp_f32 v110, v110
    v_exp_f32 v111, v111
    s_waitcnt lgkmcnt(0)
    v_mfma_f32_32x32x16_bf16 v[144:159], v[184:187], v[120:123], v[144:159]
    ds_read_b64_tr_b16 v[176:177], v250 offset:10240
    ds_read_b64_tr_b16 v[178:179], v250 offset:10368
    ds_read_b64_tr_b16 v[180:181], v250 offset:10496
    v_exp_f32 v80, v80
    v_cvt_pk_bf16_f32 v126, v108, v109
    v_exp_f32 v81, v81
    v_cvt_pk_bf16_f32 v127, v110, v111
    v_exp_f32 v82, v82
    v_exp_f32 v83, v83
    v_mfma_f32_32x32x16_bf16 v[96:111], v[196:199], v[68:71], 0
    ds_read_b64_tr_b16 v[182:183], v250 offset:10624
    ds_read_b128 v[192:195], v248 offset:5120
    ds_read_b128 v[204:207], v249 offset:5120
    s_add_u32 m0, s67, 112640
    s_add_u32 s66, s66, 4096
    buffer_load_dwordx4 v1, s[32:35], s66 offen lds
    v_exp_f32 v84, v84
    v_cvt_pk_bf16_f32 v112, v80, v81
    v_exp_f32 v85, v85
    v_cvt_pk_bf16_f32 v113, v82, v83
    v_exp_f32 v86, v86
    v_exp_f32 v87, v87
    v_mfma_f32_32x32x16_bf16 v[96:111], v[200:203], v[76:79], v[96:111]
    buffer_load_dwordx4 v1, s[32:35], s66 offen offset:1024 lds
    v_exp_f32 v88, v88
    v_cvt_pk_bf16_f32 v114, v84, v85
    v_exp_f32 v89, v89
    v_cvt_pk_bf16_f32 v115, v86, v87
    v_exp_f32 v90, v90
    v_exp_f32 v91, v91
    v_mfma_f32_32x32x16_bf16 v[144:159], v[188:191], v[124:127], v[144:159]
    s_mul_i32 s67, s38, 7168
    s_min_u32 s67, s67, 18432
    s_add_u32 s66, s67, s89
    s_add_u32 m0, s67, 63488
    s_add_u32 s66, s66, 46860288
    buffer_load_dwordx4 v1, s[32:35], s66 offen lds
    v_exp_f32 v92, v92
    v_cvt_pk_bf16_f32 v116, v88, v89
    v_exp_f32 v93, v93
    v_cvt_pk_bf16_f32 v117, v90, v91
    v_exp_f32 v94, v94
    v_exp_f32 v95, v95
    s_waitcnt lgkmcnt(0)
    v_mfma_f32_32x32x16_bf16 v[128:143], v[176:179], v[112:115], v[128:143]
    ds_read_b64_tr_b16 v[184:185], v251 offset:10240
    ds_read_b64_tr_b16 v[186:187], v251 offset:10368
    ds_read_b64_tr_b16 v[188:189], v251 offset:10496
    v_exp_f32 v96, v96
    v_cvt_pk_bf16_f32 v118, v92, v93
    v_exp_f32 v97, v97
    v_cvt_pk_bf16_f32 v119, v94, v95
    v_exp_f32 v98, v98
    v_exp_f32 v99, v99
    v_mfma_f32_32x32x16_bf16 v[80:95], v[192:195], v[64:67], 0
    ds_read_b64_tr_b16 v[190:191], v251 offset:10624
    ds_read_b128 v[196:199], v248 offset:6144
    buffer_load_dwordx4 v1, s[32:35], s66 offen offset:1024 lds
    v_exp_f32 v100, v100
    v_cvt_pk_bf16_f32 v120, v96, v97
    v_exp_f32 v101, v101
    v_cvt_pk_bf16_f32 v121, v98, v99
    v_exp_f32 v102, v102
    v_exp_f32 v103, v103
    v_mfma_f32_32x32x16_bf16 v[80:95], v[204:207], v[72:75], v[80:95]
    buffer_load_dwordx4 v1, s[32:35], s66 offen offset:2048 lds
    v_exp_f32 v104, v104
    v_cvt_pk_bf16_f32 v122, v100, v101
    v_exp_f32 v105, v105
    v_cvt_pk_bf16_f32 v123, v102, v103
    v_exp_f32 v106, v106
    v_exp_f32 v107, v107
    v_mfma_f32_32x32x16_bf16 v[128:143], v[180:183], v[116:119], v[128:143]
    buffer_load_dwordx4 v1, s[32:35], s66 offen offset:3072 lds
    v_exp_f32 v108, v108
    v_cvt_pk_bf16_f32 v124, v104, v105
    v_exp_f32 v109, v109
    v_cvt_pk_bf16_f32 v125, v106, v107
    v_exp_f32 v110, v110
    v_exp_f32 v111, v111
    s_waitcnt lgkmcnt(0)
    v_mfma_f32_32x32x16_bf16 v[144:159], v[184:187], v[120:123], v[144:159]
    ds_read_b64_tr_b16 v[176:177], v250 offset:5120
    ds_read_b64_tr_b16 v[178:179], v250 offset:5248
    ds_read_b64_tr_b16 v[180:181], v250 offset:5376
    v_exp_f32 v80, v80
    v_cvt_pk_bf16_f32 v126, v108, v109
    v_exp_f32 v81, v81
    v_cvt_pk_bf16_f32 v127, v110, v111
    v_exp_f32 v82, v82
    v_exp_f32 v83, v83
    v_mfma_f32_32x32x16_bf16 v[96:111], v[196:199], v[68:71], 0
    ds_read_b64_tr_b16 v[182:183], v250 offset:5504
    ds_read_b128 v[192:195], v248 offset:0
    ds_read_b128 v[200:203], v249 offset:0
    s_add_u32 m0, s67, 67584
    s_add_u32 s66, s66, 4096
    buffer_load_dwordx4 v1, s[32:35], s66 offen lds
    v_exp_f32 v84, v84
    v_cvt_pk_bf16_f32 v112, v80, v81
    v_exp_f32 v85, v85
    v_cvt_pk_bf16_f32 v113, v82, v83
    v_exp_f32 v86, v86
    v_exp_f32 v87, v87
    v_mfma_f32_32x32x16_bf16 v[96:111], v[204:207], v[76:79], v[96:111]
    buffer_load_dwordx4 v1, s[32:35], s66 offen offset:1024 lds
    v_exp_f32 v88, v88
    v_cvt_pk_bf16_f32 v114, v84, v85
    v_exp_f32 v89, v89
    v_cvt_pk_bf16_f32 v115, v86, v87
    v_exp_f32 v90, v90
    v_exp_f32 v91, v91
    v_mfma_f32_32x32x16_bf16 v[144:159], v[188:191], v[124:127], v[144:159]
    buffer_load_dwordx4 v1, s[32:35], s66 offen offset:2048 lds
    v_exp_f32 v92, v92
    v_cvt_pk_bf16_f32 v116, v88, v89
    v_exp_f32 v93, v93
    v_cvt_pk_bf16_f32 v117, v90, v91
    v_exp_f32 v94, v94
    v_exp_f32 v95, v95
    s_waitcnt lgkmcnt(0)
    v_mfma_f32_32x32x16_bf16 v[128:143], v[176:179], v[112:115], v[128:143]
    ds_read_b64_tr_b16 v[184:185], v251 offset:5120
    ds_read_b64_tr_b16 v[186:187], v251 offset:5248
    ds_read_b64_tr_b16 v[188:189], v251 offset:5376
    v_exp_f32 v96, v96
    v_cvt_pk_bf16_f32 v118, v92, v93
    v_exp_f32 v97, v97
    v_cvt_pk_bf16_f32 v119, v94, v95
    v_exp_f32 v98, v98
    v_exp_f32 v99, v99
    v_mfma_f32_32x32x16_bf16 v[80:95], v[192:195], v[64:67], v[160:175]
    ds_read_b64_tr_b16 v[190:191], v251 offset:5504
    ds_read_b128 v[196:199], v248 offset:1024
    buffer_load_dword v42, v43, s[32:35], 0 offen sc1
    v_exp_f32 v100, v100
    v_cvt_pk_bf16_f32 v120, v96, v97
    v_exp_f32 v101, v101
    v_cvt_pk_bf16_f32 v121, v98, v99
    v_exp_f32 v102, v102
    v_exp_f32 v103, v103
    v_mfma_f32_32x32x16_bf16 v[80:95], v[200:203], v[72:75], v[80:95]
    buffer_load_dword v42, v2, s[24:27], 0 offen sc1
    v_exp_f32 v104, v104
    v_cvt_pk_bf16_f32 v122, v100, v101
    v_exp_f32 v105, v105
    v_cvt_pk_bf16_f32 v123, v102, v103
    v_exp_f32 v106, v106
    v_exp_f32 v107, v107
    v_mfma_f32_32x32x16_bf16 v[128:143], v[180:183], v[116:119], v[128:143]
    v_exp_f32 v108, v108
    v_cvt_pk_bf16_f32 v124, v104, v105
    v_exp_f32 v109, v109
    v_cvt_pk_bf16_f32 v125, v106, v107
    v_exp_f32 v110, v110
    v_exp_f32 v111, v111
    s_waitcnt lgkmcnt(0)
    v_mfma_f32_32x32x16_bf16 v[144:159], v[184:187], v[120:123], v[144:159]
    ds_read_b64_tr_b16 v[176:177], v250 offset:0
    ds_read_b64_tr_b16 v[178:179], v250 offset:128
    ds_read_b64_tr_b16 v[180:181], v250 offset:256
    v_exp_f32 v80, v80
    v_cvt_pk_bf16_f32 v126, v108, v109
    v_exp_f32 v81, v81
    v_cvt_pk_bf16_f32 v127, v110, v111
    v_exp_f32 v82, v82
    v_exp_f32 v83, v83
    v_mfma_f32_32x32x16_bf16 v[96:111], v[196:199], v[68:71], v[160:175]
    ds_read_b64_tr_b16 v[182:183], v250 offset:384
    v_exp_f32 v84, v84
    v_cvt_pk_bf16_f32 v112, v80, v81
    v_exp_f32 v85, v85
    v_cvt_pk_bf16_f32 v113, v82, v83
    v_exp_f32 v86, v86
    v_exp_f32 v87, v87
    v_mfma_f32_32x32x16_bf16 v[96:111], v[200:203], v[76:79], v[96:111]
    v_exp_f32 v88, v88
    v_cvt_pk_bf16_f32 v114, v84, v85
    v_exp_f32 v89, v89
    v_cvt_pk_bf16_f32 v115, v86, v87
    v_exp_f32 v90, v90
    v_exp_f32 v91, v91
    v_mfma_f32_32x32x16_bf16 v[144:159], v[188:191], v[124:127], v[144:159]
    v_exp_f32 v92, v92
    v_cvt_pk_bf16_f32 v116, v88, v89
    v_exp_f32 v93, v93
    v_cvt_pk_bf16_f32 v117, v90, v91
    v_exp_f32 v94, v94
    v_exp_f32 v95, v95
    s_waitcnt lgkmcnt(0)
    v_mfma_f32_32x32x16_bf16 v[128:143], v[176:179], v[112:115], v[128:143]
    ds_read_b64_tr_b16 v[184:185], v251 offset:0
    ds_read_b64_tr_b16 v[186:187], v251 offset:128
    ds_read_b64_tr_b16 v[188:189], v251 offset:256
    v_exp_f32 v96, v96
    v_cvt_pk_bf16_f32 v118, v92, v93
    v_exp_f32 v97, v97
    v_cvt_pk_bf16_f32 v119, v94, v95
    v_exp_f32 v98, v98
    v_exp_f32 v99, v99
    ds_read_b64_tr_b16 v[190:191], v251 offset:384
    v_exp_f32 v100, v100
    v_cvt_pk_bf16_f32 v120, v96, v97
    v_exp_f32 v101, v101
    v_cvt_pk_bf16_f32 v121, v98, v99
    v_exp_f32 v102, v102
    v_exp_f32 v103, v103
    v_exp_f32 v104, v104
    v_cvt_pk_bf16_f32 v122, v100, v101
    v_exp_f32 v105, v105
    v_cvt_pk_bf16_f32 v123, v102, v103
    v_exp_f32 v106, v106
    v_exp_f32 v107, v107
    v_mfma_f32_32x32x16_bf16 v[128:143], v[180:183], v[116:119], v[128:143]
    v_exp_f32 v108, v108
    v_cvt_pk_bf16_f32 v124, v104, v105
    v_exp_f32 v109, v109
    v_cvt_pk_bf16_f32 v125, v106, v107
    v_exp_f32 v110, v110
    v_exp_f32 v111, v111
    s_waitcnt lgkmcnt(2)
    v_mfma_f32_32x32x16_bf16 v[144:159], v[184:187], v[120:123], v[144:159]
    v_cvt_pk_bf16_f32 v126, v108, v109
    v_cvt_pk_bf16_f32 v127, v110, v111
    s_waitcnt lgkmcnt(0)
    s_nop 0
    v_mfma_f32_32x32x16_bf16 v[144:159], v[188:191], v[124:127], v[144:159]
    v_rcp_f32 v142, v140
    v_mov_b32 v24, s44
    v_pk_mul_f32 v[128:129], v[128:129], v[142:143] op_sel_hi:[1,0]
    v_pk_mul_f32 v[130:131], v[130:131], v[142:143] op_sel_hi:[1,0]
    v_pk_mul_f32 v[132:133], v[132:133], v[142:143] op_sel_hi:[1,0]
    v_pk_mul_f32 v[134:135], v[134:135], v[142:143] op_sel_hi:[1,0]
    v_pk_mul_f32 v[136:137], v[136:137], v[142:143] op_sel_hi:[1,0]
    v_cvt_pk_bf16_f32 v28, v128, v129
    v_cvt_pk_bf16_f32 v29, v130, v131
    v_cvt_pk_bf16_f32 v30, v132, v133
    v_cvt_pk_bf16_f32 v31, v134, v135
    v_cvt_pk_bf16_f32 v36, v136, v137
    v_rcp_f32 v158, v156
    v_min_u32 v26, v140, v156
    v_max_u32 v25, v140, v156
    v_cmp_gt_u32 vcc, 0x12800000, v26
    v_pk_mul_f32 v[144:145], v[144:145], v[158:159] op_sel_hi:[1,0]
    v_pk_mul_f32 v[146:147], v[146:147], v[158:159] op_sel_hi:[1,0]
    s_mov_b64 s[56:57], vcc
    v_cmp_lt_u32 vcc, 0x6c800000, v25
    v_pk_mul_f32 v[148:149], v[148:149], v[158:159] op_sel_hi:[1,0]
    v_pk_mul_f32 v[150:151], v[150:151], v[158:159] op_sel_hi:[1,0]
    v_pk_mul_f32 v[154:155], v[154:155], v[158:159] op_sel_hi:[1,0]
    v_cvt_pk_bf16_f32 v32, v144, v145
    v_cvt_pk_bf16_f32 v33, v146, v147
    v_cvt_pk_bf16_f32 v34, v148, v149
    v_cvt_pk_bf16_f32 v35, v150, v151
    v_cvt_pk_bf16_f32 v37, v154, v155
    s_or_b64 vcc, vcc, s[56:57]
    s_cbranch_scc1 L_fallback1
L_attn_done1:
    s_cmp_eq_u32 s41, 0
    s_cbranch_scc1 slow_34
    buffer_store_dwordx4 v[28:31], v14, s[32:35], s47 offen
    buffer_store_dwordx4 v[32:35], v14, s[32:35], s47 offen offset:512
    buffer_store_dwordx2 v[36:37], v15, s[32:35], s47 offen
join_35:
    s_mov_b32 s55, 0
    s_waitcnt vmcnt(5)
    s_barrier
    ds_read_b128 a[0:3], v38 offset:0
    ds_read_b128 a[4:7], v38 offset:1024
    ds_read_b128 a[8:11], v38 offset:2048
    ds_read_b128 a[12:15], v38 offset:3072
    ds_read_b128 a[16:19], v39 offset:16384
    ds_read_b128 a[20:23], v38 offset:4096
    ds_read_b128 a[24:27], v38 offset:5120
    ds_read_b128 a[28:31], v38 offset:6144
    ds_read_b128 a[32:35], v38 offset:7168
    ds_read_b128 a[36:39], v38 offset:8192
    ds_read_b128 a[40:43], v38 offset:9216
    ds_read_b128 a[44:47], v38 offset:10240
    ds_read_b128 a[48:51], v38 offset:11264
    ds_read_b128 a[52:55], v39 offset:17408
    ds_read_b128 a[56:59], v38 offset:12288
    s_cmp_eq_u32 s41, 0
    s_cbranch_scc1 slow_36
    s_waitcnt vmcnt(0)
    buffer_store_dword v24, v23, s[32:35], s50 offen
join_37:
L_mark1:
    ds_read_b128 a[60:63], v38 offset:13312
    s_mul_i32 s63, s38, 5120
    s_add_u32 s63, s63, 36864
    ds_read_b128 a[64:67], v38 offset:14336
    v_add_u32 v40, s63, v1
    ds_write_b128 v40, a[228:231] offset:0
    ds_read_b128 a[68:71], v38 offset:15360
    ds_write_b128 v40, a[232:235] offset:1024
    ds_read_b128 a[72:75], v38 offset:16384
    ds_write_b128 v40, a[236:239] offset:2048
    ds_write_b128 v40, a[240:243] offset:3072
    ds_read_b128 a[76:79], v38 offset:17408
    ds_write_b128 v40, a[244:247] offset:4096
    s_add_u32 s57, s48, 4096
    s_add_u32 s58, s48, 8192
    s_add_u32 s59, s48, 12288
    s_add_u32 s60, s48, 16384
poll_38:
    buffer_load_dword v24, v17, s[32:35], 0 offen sc1
    s_sub_u32 s43, s43, 1
    s_cselect_b64 s[68:69], 0, -1
    s_max_i32 s43, s43, 0
    s_waitcnt vmcnt(0)
    v_cmp_ne_u32 vcc, s44, v24
    s_and_b64 vcc, vcc, s[68:69]
    s_cbranch_scc1 poll_38
    buffer_load_dwordx4 v[184:187], v1, s[32:35], s48 offen offset:0 sc1
    ds_read_b128 a[80:83], v38 offset:18432
    ds_read_b128 a[84:87], v38 offset:19456
    ds_read_b128 a[88:91], v39 offset:18432
    buffer_load_dwordx4 v[188:191], v1, s[32:35], s48 offen offset:1024 sc1
    ds_read_b128 a[92:95], v38 offset:20480
    ds_read_b128 a[96:99], v38 offset:21504
    ds_read_b128 a[100:103], v38 offset:22528
    buffer_load_dwordx4 v[192:195], v1, s[32:35], s48 offen offset:2048 sc1
    ds_read_b128 a[104:107], v38 offset:23552
    ds_read_b128 a[108:111], v38 offset:24576
    ds_read_b128 a[112:115], v38 offset:25600
    buffer_load_dwordx4 v[196:199], v1, s[32:35], s48 offen offset:3072 sc1
    ds_read_b128 a[116:119], v38 offset:26624
    ds_read_b128 a[120:123], v38 offset:27648
    ds_read_b128 a[124:127], v39 offset:19456
    buffer_load_dwordx4 v[200:203], v1, s[32:35], s57 offen offset:0 sc1
    ds_read_b128 a[128:131], v38 offset:28672
    ds_read_b128 a[132:135], v38 offset:29696
    ds_read_b128 a[136:139], v38 offset:30720
    buffer_load_dwordx4 v[204:207], v1, s[32:35], s57 offen offset:1024 sc1
    ds_read_b128 a[140:143], v38 offset:31744
    ds_read_b128 v[68:71], v38 offset:32768
    ds_read_b128 v[72:75], v38 offset:33792
    buffer_load_dwordx4 v[208:211], v1, s[32:35], s57 offen offset:2048 sc1
    ds_read_b128 v[76:79], v38 offset:34816
    ds_read_b128 v[80:83], v38 offset:35840
    s_waitcnt vmcnt(6) lgkmcnt(15)
    v_mfma_f32_16x16x32_bf16 v[44:47], a[0:3], v[184:187], v[44:47]
    buffer_load_dwordx4 v[212:215], v1, s[32:35], s57 offen offset:3072 sc1
    ds_read_b128 v[84:87], v39 offset:20480
    v_mfma_f32_16x16x32_bf16 v[48:51], a[4:7], v[184:187], v[48:51]
    ds_read_b128 v[88:91], v38 offset:36864
    v_mfma_f32_16x16x32_bf16 v[52:55], a[8:11], v[184:187], v[52:55]
L_hop5:
    s_cbranch_execz L_hop9
    v_mfma_f32_16x16x32_bf16 v[56:59], a[12:15], v[184:187], v[56:59]
    ds_read_b128 v[92:95], v38 offset:37888
    v_mfma_f32_16x16x32_bf16 v[60:63], a[16:19], v[184:187], v[60:63]
    buffer_load_dwordx4 v[216:219], v1, s[32:35], s58 offen offset:0 sc1
    ds_read_b128 v[96:99], v38 offset:38912
    s_waitcnt vmcnt(7)
    v_mfma_f32_16x16x32_bf16 v[44:47], a[20:23], v[188:191], v[44:47]
    v_mfma_f32_16x16x32_bf16 v[48:51], a[24:27], v[188:191], v[48:51]
    ds_read_b128 v[100:103], v38 offset:39936
    v_mfma_f32_16x16x32_bf16 v[52:55], a[28:31], v[188:191], v[52:55]
    ds_read_b128 v[104:107], v38 offset:40960
    v_mfma_f32_16x16x32_bf16 v[56:59], a[32:35], v[188:191], v[56:59]
    buffer_load_dwordx4 v[220:223], v1, s[32:35], s58 offen offset:1024 sc1
    v_mfma_f32_16x16x32_bf16 v[64:67], a[16:19], v[188:191], 0
    ds_read_b128 v[108:111], v38 offset:41984
    s_waitcnt vmcnt(7)
    v_mfma_f32_16x16x32_bf16 v[44:47], a[36:39], v[192:195], v[44:47]
    ds_read_b128 v[112:115], v38 offset:43008
    v_mfma_f32_16x16x32_bf16 v[48:51], a[40:43], v[192:195], v[48:51]
    v_mfma_f32_16x16x32_bf16 v[52:55], a[44:47], v[192:195], v[52:55]
    buffer_load_dwordx4 v[224:227], v1, s[32:35], s58 offen offset:2048 sc1
    ds_read_b128 v[116:119], v38 offset:44032
    v_mfma_f32_16x16x32_bf16 v[56:59], a[48:51], v[192:195], v[56:59]
    ds_read_b128 v[120:123], v39 offset:21504
    v_mfma_f32_16x16x32_bf16 v[60:63], a[52:55], v[192:195], v[60:63]
    s_waitcnt vmcnt(7)
    v_mfma_f32_16x16x32_bf16 v[44:47], a[56:59], v[196:199], v[44:47]
    ds_read_b128 v[124:127], v38 offset:45056
    v_mfma_f32_16x16x32_bf16 v[48:51], a[60:63], v[196:199], v[48:51]
    buffer_load_dwordx4 v[228:231], v1, s[32:35], s58 offen offset:3072 sc1
    ds_read_b128 v[128:131], v38 offset:46080
    v_mfma_f32_16x16x32_bf16 v[52:55], a[64:67], v[196:199], v[52:55]
    v_mfma_f32_16x16x32_bf16 v[56:59], a[68:71], v[196:199], v[56:59]
    ds_read_b128 v[132:135], v38 offset:47104
    v_mfma_f32_16x16x32_bf16 v[64:67], a[52:55], v[196:199], v[64:67]
    ds_read_b128 v[136:139], v38 offset:48128
    s_waitcnt vmcnt(7)
    v_mfma_f32_16x16x32_bf16 v[44:47], a[72:75], v[200:203], v[44:47]
    buffer_load_dwordx4 v[232:235], v1, s[32:35], s59 offen offset:0 sc1
    v_mfma_f32_16x16x32_bf16 v[48:51], a[76:79], v[200:203], v[48:51]
    ds_read_b128 v[140:143], v38 offset:49152
    v_mfma_f32_16x16x32_bf16 v[52:55], a[80:83], v[200:203], v[52:55]
    ds_read_b128 v[144:147], v38 offset:50176
    v_mfma_f32_16x16x32_bf16 v[56:59], a[84:87], v[200:203], v[56:59]
    v_mfma_f32_16x16x32_bf16 v[60:63], a[88:91], v[200:203], v[60:63]
    buffer_load_dwordx4 v[236:239], v1, s[32:35], s59 offen offset:1024 sc1
    ds_read_b128 v[148:151], v38 offset:51200
    s_waitcnt vmcnt(8) lgkmcnt(15)
    v_mfma_f32_16x16x32_bf16 v[44:47], a[92:95], v[204:207], v[44:47]
    ds_read_b128 v[152:155], v38 offset:52224
    v_mfma_f32_16x16x32_bf16 v[48:51], a[96:99], v[204:207], v[48:51]
    v_mfma_f32_16x16x32_bf16 v[52:55], a[100:103], v[204:207], v[52:55]
    ds_read_b128 v[156:159], v39 offset:22528
    v_mfma_f32_16x16x32_bf16 v[56:59], a[104:107], v[204:207], v[56:59]
    buffer_load_dwordx4 v[240:243], v1, s[32:35], s59 offen offset:2048 sc1
    ds_read_b128 v[160:163], v38 offset:53248
    v_mfma_f32_16x16x32_bf16 v[64:67], a[88:91], v[204:207], v[64:67]
    s_waitcnt vmcnt(8)
    v_mfma_f32_16x16x32_bf16 v[44:47], a[108:111], v[208:211], v[44:47]
    ds_read_b128 v[164:167], v38 offset:54272
    v_mfma_f32_16x16x32_bf16 v[48:51], a[112:115], v[208:211], v[48:51]
    ds_read_b128 v[168:171], v38 offset:55296
    v_mfma_f32_16x16x32_bf16 v[52:55], a[116:119], v[208:211], v[52:55]
    buffer_load_dwordx4 v[244:247], v1, s[32:35], s59 offen offset:3072 sc1
    v_mfma_f32_16x16x32_bf16 v[56:59], a[120:123], v[208:211], v[56:59]
    ds_read_b128 v[172:175], v38 offset:56320
    v_mfma_f32_16x16x32_bf16 v[60:63], a[124:127], v[208:211], v[60:63]
    ds_read_b128 v[176:179], v39 offset:0
    s_waitcnt vmcnt(8)
    v_mfma_f32_16x16x32_bf16 v[44:47], a[128:131], v[212:215], v[44:47]
    v_mfma_f32_16x16x32_bf16 v[48:51], a[132:135], v[212:215], v[48:51]
    buffer_load_dwordx4 v[248:251], v1, s[32:35], s60 offen offset:0 sc1
    ds_read_b128 v[180:183], v39 offset:1024
    v_mfma_f32_16x16x32_bf16 v[52:55], a[136:139], v[212:215], v[52:55]
    ds_read_b128 a[0:3], v39 offset:2048
    v_mfma_f32_16x16x32_bf16 v[56:59], a[140:143], v[212:215], v[56:59]
    v_mfma_f32_16x16x32_bf16 v[64:67], a[124:127], v[212:215], v[64:67]
    ds_read_b128 a[4:7], v39 offset:3072
    s_waitcnt vmcnt(8)
    v_mfma_f32_16x16x32_bf16 v[44:47], v[68:71], v[216:219], v[44:47]
    buffer_load_dwordx4 v[252:255], v1, s[32:35], s60 offen offset:1024 sc1
    ds_read_b128 a[8:11], v39 offset:23552
    v_mfma_f32_16x16x32_bf16 v[48:51], v[72:75], v[216:219], v[48:51]
    s_add_u32 s47, s47, s3
    v_mfma_f32_16x16x32_bf16 v[52:55], v[76:79], v[216:219], v[52:55]
    ds_read_b128 a[12:15], v39 offset:4096
    s_add_u32 s44, s44, 1
    v_mfma_f32_16x16x32_bf16 v[56:59], v[80:83], v[216:219], v[56:59]
    ds_read_b128 a[16:19], v39 offset:5120
    v_mfma_f32_16x16x32_bf16 v[60:63], v[84:87], v[216:219], v[60:63]
    s_mul_i32 s67, s38, 9216
    s_add_u32 s66, s67, s75
    s_add_u32 m0, s67, 0
    s_add_u32 s66, s66, 25239552
    buffer_load_dwordx4 v1, s[32:35], s66 offen lds
    s_waitcnt vmcnt(9) lgkmcnt(15)
    v_mfma_f32_16x16x32_bf16 v[44:47], v[88:91], v[220:223], v[44:47]
    ds_read_b128 a[20:23], v39 offset:6144
    v_mfma_f32_16x16x32_bf16 v[48:51], v[92:95], v[220:223], v[48:51]
    ds_read_b128 a[24:27], v39 offset:7168
    buffer_load_dwordx4 v1, s[32:35], s66 offen offset:1024 lds
    v_mfma_f32_16x16x32_bf16 v[52:55], v[96:99], v[220:223], v[52:55]
    s_cmp_eq_u32 s41, 0
    s_cselect_b32 s61, s46, s54
    v_mfma_f32_16x16x32_bf16 v[56:59], v[100:103], v[220:223], v[56:59]
    ds_read_b128 a[28:31], v39 offset:8192
    v_mfma_f32_16x16x32_bf16 v[64:67], v[84:87], v[220:223], v[64:67]
    ds_read_b128 a[32:35], v39 offset:9216
    buffer_load_dwordx4 v1, s[32:35], s66 offen offset:2048 lds
    s_waitcnt vmcnt(10)
    v_mfma_f32_16x16x32_bf16 v[44:47], v[104:107], v[224:227], v[44:47]
    s_lshl_b32 s56, s39, 11
    s_add_u32 s56, s56, s61
    v_mfma_f32_16x16x32_bf16 v[48:51], v[108:111], v[224:227], v[48:51]
    ds_read_b128 a[36:39], v39 offset:10240
    s_mov_b32 s82, 0x22222222
    v_mfma_f32_16x16x32_bf16 v[52:55], v[112:115], v[224:227], v[52:55]
    ds_read_b128 a[40:43], v39 offset:11264
    buffer_load_dwordx4 v1, s[32:35], s66 offen offset:3072 lds
    v_mfma_f32_16x16x32_bf16 v[56:59], v[116:119], v[224:227], v[56:59]
    s_mov_b32 s83, 0x22222222
    v_mfma_f32_16x16x32_bf16 v[60:63], v[120:123], v[224:227], v[60:63]
    ds_read_b128 a[44:47], v39 offset:24576
    s_waitcnt vmcnt(10)
    v_mfma_f32_16x16x32_bf16 v[44:47], v[124:127], v[228:231], v[44:47]
    ds_read_b128 a[48:51], v39 offset:12288
    s_add_u32 m0, s67, 4096
    s_add_u32 s66, s66, 4096
    buffer_load_dwordx4 v1, s[32:35], s66 offen lds
    v_mfma_f32_16x16x32_bf16 v[48:51], v[128:131], v[228:231], v[48:51]
    s_mov_b32 s84, 0x44444444
    s_mov_b32 s85, 0x44444444
    v_mfma_f32_16x16x32_bf16 v[52:55], v[132:135], v[228:231], v[52:55]
    ds_read_b128 a[52:55], v39 offset:13312
    v_mfma_f32_16x16x32_bf16 v[56:59], v[136:139], v[228:231], v[56:59]
    ds_read_b128 a[56:59], v39 offset:14336
    buffer_load_dwordx4 v1, s[32:35], s66 offen offset:1024 lds
    v_mfma_f32_16x16x32_bf16 v[64:67], v[120:123], v[228:231], v[64:67]
    s_mov_b32 s86, 0x88888888
    s_waitcnt vmcnt(11) lgkmcnt(15)
    v_mfma_f32_16x16x32_bf16 v[44:47], v[140:143], v[232:235], v[44:47]
    ds_read_b128 a[60:63], v39 offset:15360
    v_mfma_f32_16x16x32_bf16 v[48:51], v[144:147], v[232:235], v[48:51]
    buffer_load_dwordx4 v1, s[32:35], s66 offen offset:2048 lds
    s_mov_b32 s87, 0x88888888
    v_mfma_f32_16x16x32_bf16 v[52:55], v[148:151], v[232:235], v[52:55]
    v_mfma_f32_16x16x32_bf16 v[56:59], v[152:155], v[232:235], v[56:59]
    s_mul_i32 s63, s38, 8192
    s_min_u32 s63, s63, 22528
    s_add_u32 s63, s63, 63488
    v_mfma_f32_16x16x32_bf16 v[60:63], v[156:159], v[232:235], v[60:63]
    buffer_load_dwordx4 v1, s[32:35], s66 offen offset:3072 lds
    s_waitcnt vmcnt(12)
    v_mfma_f32_16x16x32_bf16 v[44:47], v[160:163], v[236:239], v[44:47]
    v_add_u32 v40, s63, v1
    v_mfma_f32_16x16x32_bf16 v[48:51], v[164:167], v[236:239], v[48:51]
    v_mfma_f32_16x16x32_bf16 v[52:55], v[168:171], v[236:239], v[52:55]
    s_add_u32 m0, s67, 8192
    s_add_u32 s66, s66, 4096
    buffer_load_dwordx4 v1, s[32:35], s66 offen lds
    v_mfma_f32_16x16x32_bf16 v[56:59], v[172:175], v[236:239], v[56:59]
    v_mfma_f32_16x16x32_bf16 v[64:67], v[156:159], v[236:239], v[64:67]
    s_waitcnt vmcnt(9)
    s_waitcnt lgkmcnt(0)
    s_cmp_eq_u32 s41, 0
    s_cbranch_scc1 slow_39
    v_mfma_f32_16x16x32_bf16 v[60:63], a[8:11], v[240:243], v[60:63]
    v_mfma_f32_16x16x32_bf16 v[64:67], a[8:11], v[244:247], v[64:67]
    v_mfma_f32_16x16x32_bf16 v[60:63], a[44:47], v[248:251], v[60:63]
    v_mfma_f32_16x16x32_bf16 v[64:67], a[44:47], v[252:255], v[64:67]
    v_mov_b32 v194, 0
    v_mov_b32 v195, 0
    v_mfma_f32_16x16x32_bf16 v[44:47], v[176:179], v[240:243], v[44:47]
    v_mov_b32 v196, s74
    v_mov_b32 v197, s74
    v_mfma_f32_16x16x32_bf16 v[44:47], a[12:15], v[244:247], v[44:47]
    v_mov_b32 v198, s74
    v_mov_b32 v199, s74
    v_mfma_f32_16x16x32_bf16 v[44:47], a[28:31], v[248:251], v[44:47]
    v_permlane32_swap_b32 v64, v68
    v_permlane32_swap_b32 v65, v69
    v_mfma_f32_16x16x32_bf16 v[44:47], a[48:51], v[252:255], v[44:47]
    v_permlane32_swap_b32 v66, v70
    v_permlane32_swap_b32 v67, v71
    v_mfma_f32_16x16x32_bf16 v[48:51], v[180:183], v[240:243], v[48:51]
    v_add_f32 v60, v60, v68
    v_mfma_f32_16x16x32_bf16 v[48:51], a[16:19], v[244:247], v[48:51]
    v_add_f32 v61, v61, v69
    v_add_f32 v62, v62, v70
    v_mfma_f32_16x16x32_bf16 v[48:51], a[32:35], v[248:251], v[48:51]
    v_add_f32 v63, v63, v71
    v_cvt_pk_bf16_f32 v192, v60, v61
    v_mfma_f32_16x16x32_bf16 v[48:51], a[52:55], v[252:255], v[48:51]
    v_cvt_pk_bf16_f32 v193, v62, v63
    v_mfma_f32_16x16x32_bf16 v[52:55], a[0:3], v[240:243], v[52:55]
    v_cndmask_b32 v192, 0, v192, s[70:71]
    v_cndmask_b32 v193, 0, v193, s[70:71]
    v_mfma_f32_16x16x32_bf16 v[52:55], a[20:23], v[244:247], v[52:55]
    buffer_store_dwordx2 v[192:193], v12, s[4:7], s61 offen
    v_cvt_pk_bf16_f32 v184, v44, v45
    v_mfma_f32_16x16x32_bf16 v[52:55], a[36:39], v[248:251], v[52:55]
    v_cvt_pk_bf16_f32 v185, v46, v47
    v_mfma_f32_16x16x32_bf16 v[52:55], a[56:59], v[252:255], v[52:55]
    v_cvt_pk_bf16_f32 v186, v48, v49
    v_mfma_f32_16x16x32_bf16 v[56:59], a[4:7], v[240:243], v[56:59]
    v_cvt_pk_bf16_f32 v187, v50, v51
    v_mfma_f32_16x16x32_bf16 v[56:59], a[24:27], v[244:247], v[56:59]
    buffer_store_dwordx4 v[184:187], v1, s[4:7], s56 offen offset:0
    v_mfma_f32_16x16x32_bf16 v[56:59], a[40:43], v[248:251], v[56:59]
    s_nop 1
    v_mfma_f32_16x16x32_bf16 v[56:59], a[60:63], v[252:255], v[56:59]
    v_cvt_pk_bf16_f32 v188, v52, v53
    v_mfma_f32_16x16x32_bf16 v[204:207], v[192:195], v[192:195], 0
    v_cvt_pk_bf16_f32 v189, v54, v55
    v_mfma_f32_16x16x32_bf16 v[200:203], v[196:199], v[192:195], 0
    s_nop 1
    v_mfma_f32_16x16x32_bf16 v[204:207], v[184:187], v[184:187], v[204:207]
    s_nop 1
    v_mfma_f32_16x16x32_bf16 v[200:203], v[196:199], v[184:187], v[200:203]
    v_cvt_pk_bf16_f32 v190, v56, v57
    v_cvt_pk_bf16_f32 v191, v58, v59
    s_nop 1
    v_mfma_f32_16x16x32_bf16 v[204:207], v[188:191], v[188:191], v[204:207]
    buffer_store_dwordx4 v[188:191], v1, s[4:7], s56 offen offset:1024
    v_mfma_f32_16x16x32_bf16 v[200:203], v[196:199], v[188:191], v[200:203]
    v_mov_b32 v26, s44
    s_nop 4
    v_cndmask_b32 v204, v204, v205, s[82:83]
    v_cndmask_b32 v204, v204, v206, s[84:85]
    v_cndmask_b32 v201, v204, v207, s[86:87]
    buffer_store_dwordx2 v[200:201], v13, s[32:35], s46 offen
    s_barrier
    ds_write_b128 v40, a[196:199] offset:0
    ds_write_b128 v40, a[200:203] offset:1024
    ds_write_b128 v40, a[204:207] offset:2048
    s_waitcnt vmcnt(0)
    buffer_store_dword v26, v23, s[32:35], s49 offen
join_40:
    s_add_u32 s46, s46, s3
    s_add_u32 s48, s48, s3
    ds_write_b128 v40, a[208:211] offset:3072
    ds_write_b128 v40, a[212:215] offset:4096
    ds_write_b128 v40, a[216:219] offset:5120
    ds_write_b128 v40, a[220:223] offset:6144
    ds_write_b128 v40, a[224:227] offset:7168
    v_add_u32 v128, 63488, v1
    v_add_u32 v136, 98304, v1
    v_and_b32 v130, 15, v0
    v_min_u32 v130, 11, v130
    v_lshrrev_b32 v131, 4, v0
    v_mul_u32_u24 v131, 192, v131
    v_lshl_add_u32 v130, v130, 4, v131
    v_add_u32 v131, 63488, v130
    s_cmp_eq_u32 s41, 0
    s_cselect_b32 s94, s45, s94
    s_cselect_b32 s56, 1024, 0
    s_add_u32 s56, s56, 18432
    v_add_u32 v138, s56, v1
    s_add_u32 s57, s94, 4096
    s_add_u32 s58, s94, 8192
    s_add_u32 s59, s94, 12288
    s_add_u32 s60, s94, 16384
    s_add_u32 s86, s45, 18432
    s_add_u32 s87, s45, 37888
poll_41:
    buffer_load_dword v24, v16, s[32:35], 0 offen sc1
    s_sub_u32 s43, s43, 1
    s_cselect_b64 s[68:69], 0, -1
    s_max_i32 s43, s43, 0
    s_waitcnt vmcnt(0)
    v_cmp_ne_u32 vcc, s44, v24
    s_and_b64 vcc, vcc, s[68:69]
    s_cbranch_scc1 poll_41
    buffer_load_dwordx4 a[0:3], v1, s[4:7], s94 offen offset:0 sc1
    buffer_load_dwordx4 a[72:75], v138, s[4:7], s94 offen offset:0 sc1
    s_waitcnt lgkmcnt(0)
    s_barrier
    buffer_load_dwordx4 a[4:7], v1, s[4:7], s94 offen offset:1024 sc1
    ds_read_b128 a[196:199], v1 offset:768
    ds_read_b128 a[200:203], v1 offset:1792
    ds_read_b128 a[204:207], v1 offset:2816
    buffer_load_dwordx4 a[76:79], v138, s[4:7], s94 offen offset:1024 sc1
    ds_read_b128 a[208:211], v1 offset:3840
    ds_read_b128 a[212:215], v130 offset:0
    buffer_load_dwordx4 a[8:11], v1, s[4:7], s94 offen offset:2048 sc1
    ds_read_b128 a[216:219], v1 offset:5632
    ds_read_b128 a[220:223], v1 offset:6656
    ds_read_b128 a[224:227], v1 offset:7680
    buffer_load_dwordx4 a[80:83], v138, s[4:7], s94 offen offset:2048 sc1
    ds_read_b128 a[228:231], v1 offset:8704
    ds_read_b128 a[232:235], v130 offset:4864
    s_waitcnt vmcnt(4) lgkmcnt(5)
    v_mfma_f32_16x16x32_bf16 v[64:67], a[0:3], a[196:199], 0
    ds_read_b128 a[236:239], v1 offset:10496
    buffer_load_dwordx4 a[12:15], v1, s[4:7], s94 offen offset:3072 sc1
    v_mfma_f32_16x16x32_bf16 v[68:71], a[72:75], a[196:199], 0
    v_and_b32 v24, 15, v0
    v_mfma_f32_16x16x32_bf16 v[72:75], a[0:3], a[200:203], 0
    ds_read_b128 a[240:243], v1 offset:11520
    v_mfma_f32_16x16x32_bf16 v[76:79], a[72:75], a[200:203], 0
    buffer_load_dwordx4 a[84:87], v138, s[4:7], s94 offen offset:3072 sc1
    v_lshlrev_b32 v24, 2, v24
    v_mfma_f32_16x16x32_bf16 v[80:83], a[0:3], a[204:207], 0
    ds_read_b128 a[244:247], v1 offset:12544
    v_mfma_f32_16x16x32_bf16 v[84:87], a[72:75], a[204:207], 0
    v_mfma_f32_16x16x32_bf16 v[88:91], a[0:3], a[208:211], 0
    ds_read_b128 a[196:199], v1 offset:13568
    v_add_u32 v24, 159744, v24
    v_mfma_f32_16x16x32_bf16 v[92:95], a[72:75], a[208:211], 0
    buffer_load_dwordx4 a[16:19], v1, s[4:7], s57 offen offset:0 sc1
    v_mfma_f32_16x16x32_bf16 v[96:99], a[0:3], a[212:215], 0
    ds_read_b128 a[200:203], v130 offset:9728
    v_mfma_f32_16x16x32_bf16 v[100:103], a[72:75], a[212:215], 0
    ds_read_b32 v176, v24 offset:0
    s_waitcnt vmcnt(5) lgkmcnt(6)
    v_mfma_f32_16x16x32_bf16 v[64:67], a[4:7], a[216:219], v[64:67]
    ds_read_b128 a[204:207], v1 offset:15360
    v_mfma_f32_16x16x32_bf16 v[68:71], a[76:79], a[216:219], v[68:71]
    buffer_load_dwordx4 a[88:91], v138, s[4:7], s57 offen offset:0 sc1
    v_mfma_f32_16x16x32_bf16 v[72:75], a[4:7], a[220:223], v[72:75]
    ds_read_b128 a[208:211], v1 offset:16384
    v_mfma_f32_16x16x32_bf16 v[76:79], a[76:79], a[220:223], v[76:79]
    ds_read_b32 v177, v24 offset:64
    v_mfma_f32_16x16x32_bf16 v[80:83], a[4:7], a[224:227], v[80:83]
    ds_read_b128 a[212:215], v1 offset:17408
    v_mfma_f32_16x16x32_bf16 v[84:87], a[76:79], a[224:227], v[84:87]
    buffer_load_dwordx4 a[20:23], v1, s[4:7], s57 offen offset:1024 sc1
    v_mfma_f32_16x16x32_bf16 v[88:91], a[4:7], a[228:231], v[88:91]
    ds_read_b128 a[216:219], v1 offset:18432
    ds_read_b32 v178, v24 offset:128
    v_mfma_f32_16x16x32_bf16 v[92:95], a[76:79], a[228:231], v[92:95]
    v_mfma_f32_16x16x32_bf16 v[96:99], a[4:7], a[232:235], v[96:99]
    ds_read_b128 a[220:223], v130 offset:14592
    v_mfma_f32_16x16x32_bf16 v[100:103], a[76:79], a[232:235], v[100:103]
    buffer_load_dwordx4 a[92:95], v138, s[4:7], s57 offen offset:1024 sc1
    s_waitcnt vmcnt(6) lgkmcnt(8)
    v_mfma_f32_16x16x32_bf16 v[64:67], a[8:11], a[236:239], v[64:67]
    ds_read_b128 a[224:227], v1 offset:20224
    ds_read_b32 v179, v24 offset:192
    v_mfma_f32_16x16x32_bf16 v[68:71], a[80:83], a[236:239], v[68:71]
    v_mfma_f32_16x16x32_bf16 v[72:75], a[8:11], a[240:243], v[72:75]
    ds_read_b128 a[228:231], v1 offset:21248
    ds_read_b32 v180, v24 offset:256
    v_mfma_f32_16x16x32_bf16 v[76:79], a[80:83], a[240:243], v[76:79]
    buffer_load_dwordx4 a[24:27], v1, s[4:7], s57 offen offset:2048 sc1
    v_mfma_f32_16x16x32_bf16 v[80:83], a[8:11], a[244:247], v[80:83]
    ds_read_b128 a[232:235], v1 offset:22272
    v_mfma_f32_16x16x32_bf16 v[84:87], a[80:83], a[244:247], v[84:87]
    v_mfma_f32_16x16x32_bf16 v[88:91], a[8:11], a[196:199], v[88:91]
    ds_read_b128 a[236:239], v1 offset:23296
    v_mfma_f32_16x16x32_bf16 v[92:95], a[80:83], a[196:199], v[92:95]
    buffer_load_dwordx4 a[96:99], v138, s[4:7], s57 offen offset:2048 sc1
    v_mfma_f32_16x16x32_bf16 v[96:99], a[8:11], a[200:203], v[96:99]
    ds_read_b128 a[240:243], v130 offset:19456
    v_mfma_f32_16x16x32_bf16 v[100:103], a[80:83], a[200:203], v[100:103]
    s_waitcnt vmcnt(6) lgkmcnt(7)
    v_mfma_f32_16x16x32_bf16 v[64:67], a[12:15], a[204:207], v[64:67]
    ds_read_b128 a[244:247], v1 offset:25088
    v_mfma_f32_16x16x32_bf16 v[68:71], a[84:87], a[204:207], v[68:71]
    buffer_load_dwordx4 a[28:31], v1, s[4:7], s57 offen offset:3072 sc1
    v_mfma_f32_16x16x32_bf16 v[72:75], a[12:15], a[208:211], v[72:75]
    ds_read_b128 a[196:199], v1 offset:26112
    v_mfma_f32_16x16x32_bf16 v[76:79], a[84:87], a[208:211], v[76:79]
    s_lshl_b32 s61, s38, 12
    s_add_u32 s61, s61, 135168
    v_mfma_f32_16x16x32_bf16 v[80:83], a[12:15], a[212:215], v[80:83]
    ds_read_b128 a[200:203], v1 offset:27136
    v_add_u32 v129, s61, v1
    v_mfma_f32_16x16x32_bf16 v[84:87], a[84:87], a[212:215], v[84:87]
    buffer_load_dwordx4 a[100:103], v138, s[4:7], s57 offen offset:3072 sc1
    v_mfma_f32_16x16x32_bf16 v[88:91], a[12:15], a[216:219], v[88:91]
    ds_read_b128 a[204:207], v1 offset:28160
    v_mfma_f32_16x16x32_bf16 v[92:95], a[84:87], a[216:219], v[92:95]
    s_lshl_b32 s61, s38, 8
    s_add_u32 s61, s61, 160768
    v_mfma_f32_16x16x32_bf16 v[96:99], a[12:15], a[220:223], v[96:99]
    ds_read_b128 a[208:211], v130 offset:24320
    v_and_b32 v134, 3, v0
    v_mfma_f32_16x16x32_bf16 v[100:103], a[84:87], a[220:223], v[100:103]
    buffer_load_dwordx4 a[32:35], v1, s[4:7], s58 offen offset:0 sc1
    s_waitcnt vmcnt(7) lgkmcnt(5)
    v_mfma_f32_16x16x32_bf16 v[64:67], a[16:19], a[224:227], v[64:67]
    ds_read_b128 a[212:215], v1 offset:29952
    v_lshrrev_b32 v135, 4, v0
    v_mfma_f32_16x16x32_bf16 v[68:71], a[88:91], a[224:227], v[68:71]
    v_mfma_f32_16x16x32_bf16 v[72:75], a[16:19], a[228:231], v[72:75]
    ds_read_b128 a[216:219], v1 offset:30976
    buffer_load_dwordx4 a[104:107], v138, s[4:7], s58 offen offset:0 sc1
    v_mfma_f32_16x16x32_bf16 v[76:79], a[88:91], a[228:231], v[76:79]
    v_lshlrev_b32 v132, 6, v134
    v_mfma_f32_16x16x32_bf16 v[80:83], a[16:19], a[232:235], v[80:83]
    ds_read_b128 a[220:223], v1 offset:32000
    v_mfma_f32_16x16x32_bf16 v[84:87], a[88:91], a[232:235], v[84:87]
    v_lshl_add_u32 v132, v135, 3, v132
    v_mfma_f32_16x16x32_bf16 v[88:91], a[16:19], a[236:239], v[88:91]
    ds_read_b128 a[224:227], v1 offset:33024
    buffer_load_dwordx4 v[140:143], v1, s[32:35], s86 offen sc1
    v_mfma_f32_16x16x32_bf16 v[92:95], a[88:91], a[236:239], v[92:95]
    v_mfma_f32_16x16x32_bf16 v[96:99], a[16:19], a[240:243], v[96:99]
    ds_read_b128 a[228:231], v130 offset:29184
    v_add_u32 v132, s61, v132
    v_mfma_f32_16x16x32_bf16 v[100:103], a[88:91], a[240:243], v[100:103]
    s_waitcnt vmcnt(7) lgkmcnt(5)
    v_mfma_f32_16x16x32_bf16 v[64:67], a[20:23], a[244:247], v[64:67]
    ds_read_b128 a[232:235], v1 offset:34816
    buffer_load_dwordx4 v[144:147], v1, s[32:35], s87 offen sc1
    v_mfma_f32_16x16x32_bf16 v[68:71], a[92:95], a[244:247], v[68:71]
    v_mfma_f32_16x16x32_bf16 v[72:75], a[20:23], a[196:199], v[72:75]
    ds_read_b128 a[236:239], v1 offset:35840
    v_and_b32 v135, 1, v135
    v_mfma_f32_16x16x32_bf16 v[76:79], a[92:95], a[196:199], v[76:79]
    v_mfma_f32_16x16x32_bf16 v[80:83], a[20:23], a[200:203], v[80:83]
    ds_read_b128 a[240:243], v1 offset:36864
    buffer_load_dwordx4 a[36:39], v1, s[4:7], s58 offen offset:1024 sc1
    v_mfma_f32_16x16x32_bf16 v[84:87], a[92:95], a[200:203], v[84:87]
    v_lshlrev_b32 v135, 5, v135
    v_mfma_f32_16x16x32_bf16 v[88:91], a[20:23], a[204:207], v[88:91]
    ds_read_b128 a[244:247], v1 offset:37888
    v_mfma_f32_16x16x32_bf16 v[92:95], a[92:95], a[204:207], v[92:95]
    v_mfma_f32_16x16x32_bf16 v[96:99], a[20:23], a[208:211], v[96:99]
    ds_read_b128 a[196:199], v130 offset:34048
    buffer_load_dwordx4 a[108:111], v138, s[4:7], s58 offen offset:1024 sc1
    v_mfma_f32_16x16x32_bf16 v[100:103], a[92:95], a[208:211], v[100:103]
    v_lshl_add_u32 v134, v134, 3, v135
    s_waitcnt vmcnt(8) lgkmcnt(5)
    v_mfma_f32_16x16x32_bf16 v[64:67], a[24:27], a[212:215], v[64:67]
    ds_read_b128 a[200:203], v1 offset:39680
    v_mfma_f32_16x16x32_bf16 v[68:71], a[96:99], a[212:215], v[68:71]
    v_bfe_u32 v135, v0, 2, 2
    v_mfma_f32_16x16x32_bf16 v[72:75], a[24:27], a[216:219], v[72:75]
    ds_read_b128 a[204:207], v1 offset:40704
    buffer_load_dwordx4 a[40:43], v1, s[4:7], s58 offen offset:2048 sc1
    v_mfma_f32_16x16x32_bf16 v[76:79], a[96:99], a[216:219], v[76:79]
    v_mfma_f32_16x16x32_bf16 v[80:83], a[24:27], a[220:223], v[80:83]
    ds_read_b128 a[208:211], v1 offset:41728
    v_mfma_f32_16x16x32_bf16 v[84:87], a[96:99], a[220:223], v[84:87]
    v_lshl_add_u32 v134, v135, 6, v134
    v_mfma_f32_16x16x32_bf16 v[88:91], a[24:27], a[224:227], v[88:91]
    ds_read_b128 a[212:215], v1 offset:42752
    buffer_load_dwordx4 a[112:115], v138, s[4:7], s58 offen offset:2048 sc1
    v_mfma_f32_16x16x32_bf16 v[92:95], a[96:99], a[224:227], v[92:95]
    v_mfma_f32_16x16x32_bf16 v[96:99], a[24:27], a[228:231], v[96:99]
    ds_read_b128 a[216:219], v130 offset:38912
    v_add_u32 v133, s61, v134
    v_mfma_f32_16x16x32_bf16 v[100:103], a[96:99], a[228:231], v[100:103]
    s_waitcnt vmcnt(8) lgkmcnt(5)
    v_mfma_f32_16x16x32_bf16 v[64:67], a[28:31], a[232:235], v[64:67]
    ds_read_b128 a[220:223], v1 offset:44544
    buffer_load_dwordx4 a[44:47], v1, s[4:7], s58 offen offset:3072 sc1
    v_mfma_f32_16x16x32_bf16 v[68:71], a[100:103], a[232:235], v[68:71]
    v_lshl_add_u32 v134, v0, 3, s92
    v_mfma_f32_16x16x32_bf16 v[72:75], a[28:31], a[236:239], v[72:75]
    ds_read_b128 a[224:227], v1 offset:45568
    v_mfma_f32_16x16x32_bf16 v[76:79], a[100:103], a[236:239], v[76:79]
    v_mfma_f32_16x16x32_bf16 v[80:83], a[28:31], a[240:243], v[80:83]
    ds_read_b128 a[228:231], v1 offset:46592
    buffer_load_dwordx4 a[116:119], v138, s[4:7], s58 offen offset:3072 sc1
    v_mfma_f32_16x16x32_bf16 v[84:87], a[100:103], a[240:243], v[84:87]
    v_mfma_f32_16x16x32_bf16 v[88:91], a[28:31], a[244:247], v[88:91]
    ds_read_b128 a[232:235], v1 offset:47616
    v_mfma_f32_16x16x32_bf16 v[92:95], a[100:103], a[244:247], v[92:95]
    v_mfma_f32_16x16x32_bf16 v[96:99], a[28:31], a[196:199], v[96:99]
    ds_read_b128 a[236:239], v130 offset:43776
    buffer_load_dwordx4 a[48:51], v1, s[4:7], s59 offen offset:0 sc1
    v_mfma_f32_16x16x32_bf16 v[100:103], a[100:103], a[196:199], v[100:103]
    s_waitcnt vmcnt(9) lgkmcnt(5)
    v_mfma_f32_16x16x32_bf16 v[64:67], a[32:35], a[200:203], v[64:67]
    ds_read_b128 a[240:243], v1 offset:49408
    v_mfma_f32_16x16x32_bf16 v[68:71], a[104:107], a[200:203], v[68:71]
    v_mfma_f32_16x16x32_bf16 v[72:75], a[32:35], a[204:207], v[72:75]
    ds_read_b128 a[244:247], v1 offset:50432
    buffer_load_dwordx4 a[120:123], v138, s[4:7], s59 offen offset:0 sc1
    v_mfma_f32_16x16x32_bf16 v[76:79], a[104:107], a[204:207], v[76:79]
    s_waitcnt vmcnt(9)
    v_add_f32 v140, v140, v142
    v_add_f32 v141, v141, v143
    v_mfma_f32_16x16x32_bf16 v[80:83], a[32:35], a[208:211], v[80:83]
    ds_read_b128 a[196:199], v1 offset:51456
    s_waitcnt vmcnt(8)
    v_add_f32 v144, v144, v146
    v_mfma_f32_16x16x32_bf16 v[84:87], a[104:107], a[208:211], v[84:87]
    buffer_load_dwordx4 a[52:55], v1, s[4:7], s59 offen offset:1024 sc1
    v_add_f32 v145, v145, v147
    v_mfma_f32_16x16x32_bf16 v[88:91], a[32:35], a[212:215], v[88:91]
    ds_read_b128 a[200:203], v1 offset:52480
    v_permlane32_swap_b32 v140, v141
    v_mfma_f32_16x16x32_bf16 v[92:95], a[104:107], a[212:215], v[92:95]
    v_permlane32_swap_b32 v144, v145
    v_mfma_f32_16x16x32_bf16 v[96:99], a[32:35], a[216:219], v[96:99]
    ds_read_b128 a[204:207], v130 offset:48640
    v_add_f32 v140, v140, v141
    v_mfma_f32_16x16x32_bf16 v[100:103], a[104:107], a[216:219], v[100:103]
    buffer_load_dwordx4 a[124:127], v138, s[4:7], s59 offen offset:1024 sc1
    s_waitcnt vmcnt(8) lgkmcnt(5)
    v_mfma_f32_16x16x32_bf16 v[64:67], a[36:39], a[220:223], v[64:67]
    ds_read_b128 a[208:211], v1 offset:54272
    v_add_f32 v144, v144, v145
    v_mfma_f32_16x16x32_bf16 v[68:71], a[108:111], a[220:223], v[68:71]
    s_nop 0
    v_permlane16_swap_b32 v140, v144
    v_add_f32 v140, v140, v144
    v_mfma_f32_16x16x32_bf16 v[72:75], a[36:39], a[224:227], v[72:75]
    ds_read_b128 a[212:215], v1 offset:55296
    v_mul_f32 v140, 0x3ae38e39, v140
    v_mfma_f32_16x16x32_bf16 v[76:79], a[108:111], a[224:227], v[76:79]
    buffer_load_dwordx4 a[56:59], v1, s[4:7], s59 offen offset:2048 sc1
    v_mfma_f32_16x16x32_bf16 v[80:83], a[36:39], a[228:231], v[80:83]
    ds_read_b128 a[216:219], v1 offset:56320
    v_mov_b32 v144, v140
    v_mfma_f32_16x16x32_bf16 v[84:87], a[108:111], a[228:231], v[84:87]
    s_nop 0
    v_permlane32_swap_b32 v140, v144
    v_mfma_f32_16x16x32_bf16 v[88:91], a[36:39], a[232:235], v[88:91]
    ds_read_b128 a[220:223], v128 offset:0
    v_fma_f32 v144, -v140, v140, v144
    v_mfma_f32_16x16x32_bf16 v[92:95], a[108:111], a[232:235], v[92:95]
    buffer_load_dwordx4 a[128:131], v138, s[4:7], s59 offen offset:2048 sc1
    v_max_f32 v144, 0, v144
    v_mfma_f32_16x16x32_bf16 v[96:99], a[36:39], a[236:239], v[96:99]
    ds_read_b128 a[224:227], v130 offset:53504
    v_add_f32 v144, 0x3727c5ac, v144
    v_mfma_f32_16x16x32_bf16 v[100:103], a[108:111], a[236:239], v[100:103]
    s_waitcnt vmcnt(8) lgkmcnt(5)
    v_mfma_f32_16x16x32_bf16 v[64:67], a[40:43], a[240:243], v[64:67]
    ds_read_b128 a[228:231], v128 offset:1792
    v_mfma_f32_16x16x32_bf16 v[68:71], a[112:115], a[240:243], v[68:71]
    buffer_load_dwordx4 a[60:63], v1, s[4:7], s59 offen offset:3072 sc1
    v_mfma_f32_16x16x32_bf16 v[72:75], a[40:43], a[244:247], v[72:75]
    ds_read_b128 a[232:235], v128 offset:2816
    v_mfma_f32_16x16x32_bf16 v[76:79], a[112:115], a[244:247], v[76:79]
    v_rsq_f32 v148, v144
    v_mfma_f32_16x16x32_bf16 v[80:83], a[40:43], a[196:199], v[80:83]
    ds_read_b128 a[236:239], v128 offset:3840
    v_mul_f32 v150, -v140, v148
    v_mfma_f32_16x16x32_bf16 v[84:87], a[112:115], a[196:199], v[84:87]
    buffer_load_dwordx4 a[132:135], v138, s[4:7], s59 offen offset:3072 sc1
    v_cndmask_b32 v140, v150, v148, s[70:71]
    v_mfma_f32_16x16x32_bf16 v[88:91], a[40:43], a[200:203], v[88:91]
    ds_read_b128 a[240:243], v128 offset:4864
    v_mfma_f32_16x16x32_bf16 v[92:95], a[112:115], a[200:203], v[92:95]
    s_lshl_b32 s56, s38, 8
    s_add_u32 s56, s56, 160768
    v_mfma_f32_16x16x32_bf16 v[96:99], a[40:43], a[204:207], v[96:99]
    ds_read_b128 a[244:247], v131 offset:1024
    v_lshl_add_u32 v141, v0, 2, s56
    v_mfma_f32_16x16x32_bf16 v[100:103], a[112:115], a[204:207], v[100:103]
    buffer_load_dwordx4 a[64:67], v1, s[4:7], s60 offen offset:0 sc1
    s_waitcnt vmcnt(9) lgkmcnt(5)
    v_mfma_f32_16x16x32_bf16 v[64:67], a[44:47], a[208:211], v[64:67]
    ds_read_b128 a[196:199], v128 offset:6656
    v_and_b32 v142, 48, v0
    v_mfma_f32_16x16x32_bf16 v[68:71], a[116:119], a[208:211], v[68:71]
    v_add_u32 v142, s56, v142
    v_mfma_f32_16x16x32_bf16 v[72:75], a[44:47], a[212:215], v[72:75]
    ds_read_b128 a[200:203], v128 offset:7680
    ds_write_b32 v141, v140
    v_mfma_f32_16x16x32_bf16 v[76:79], a[116:119], a[212:215], v[76:79]
    buffer_load_dwordx4 a[136:139], v138, s[4:7], s60 offen offset:0 sc1
    ds_read_b128 v[152:155], v142
    v_mfma_f32_16x16x32_bf16 v[80:83], a[44:47], a[216:219], v[80:83]
    ds_read_b128 a[204:207], v128 offset:8704
    ds_read_b128 v[156:159], v142 offset:64
    v_mfma_f32_16x16x32_bf16 v[84:87], a[116:119], a[216:219], v[84:87]
    ds_read_b128 v[160:163], v142 offset:128
    ds_read_b128 v[164:167], v142 offset:192
    v_mfma_f32_16x16x32_bf16 v[88:91], a[44:47], a[220:223], v[88:91]
    ds_read_b128 a[208:211], v128 offset:9728
    v_mov_b32 v149, v148
    v_mov_b32 v151, v150
L_hop6:
    s_cbranch_execz L_hop10
    s_nop 0
    v_permlane16_swap_b32 v148, v149
    v_permlane16_swap_b32 v150, v151
    v_mfma_f32_16x16x32_bf16 v[92:95], a[116:119], a[220:223], v[92:95]
    buffer_load_dwordx4 a[68:71], v1, s[4:7], s60 offen offset:1024 sc1
    v_mfma_f32_16x16x32_bf16 v[96:99], a[44:47], a[224:227], v[96:99]
    ds_read_b128 a[212:215], v131 offset:5888
    v_mfma_f32_16x16x32_bf16 v[100:103], a[116:119], a[224:227], v[100:103]
    s_waitcnt vmcnt(9) lgkmcnt(10)
    v_mfma_f32_16x16x32_bf16 v[64:67], a[48:51], a[228:231], v[64:67]
    ds_read_b128 a[216:219], v128 offset:11520
    v_mfma_f32_16x16x32_bf16 v[68:71], a[120:123], a[228:231], v[68:71]
    buffer_load_dwordx4 a[140:143], v138, s[4:7], s60 offen offset:1024 sc1
    v_mfma_f32_16x16x32_bf16 v[72:75], a[48:51], a[232:235], v[72:75]
    ds_read_b128 a[220:223], v128 offset:12544
    v_mfma_f32_16x16x32_bf16 v[76:79], a[120:123], a[232:235], v[76:79]
    v_mfma_f32_16x16x32_bf16 v[80:83], a[48:51], a[236:239], v[80:83]
    ds_read_b128 a[224:227], v128 offset:13568
    v_mfma_f32_16x16x32_bf16 v[84:87], a[120:123], a[236:239], v[84:87]
    s_mul_i32 s67, s38, 9216
    s_add_u32 s66, s67, s75
    s_add_u32 m0, s67, 98304
    s_add_u32 s66, s66, 25331712
    buffer_load_dwordx4 v1, s[32:35], s66 offen lds
    v_mfma_f32_16x16x32_bf16 v[88:91], a[48:51], a[240:243], v[88:91]
    ds_read_b128 a[228:231], v128 offset:14592
    v_mfma_f32_16x16x32_bf16 v[92:95], a[120:123], a[240:243], v[92:95]
    v_mfma_f32_16x16x32_bf16 v[96:99], a[48:51], a[244:247], v[96:99]
    ds_read_b128 a[232:235], v131 offset:10752
    v_mfma_f32_16x16x32_bf16 v[100:103], a[120:123], a[244:247], v[100:103]
    buffer_load_dwordx4 v1, s[32:35], s66 offen offset:1024 lds
    s_waitcnt vmcnt(10) lgkmcnt(5)
    v_mfma_f32_16x16x32_bf16 v[64:67], a[52:55], a[196:199], v[64:67]
    ds_read_b128 a[236:239], v128 offset:16384
    v_mfma_f32_16x16x32_bf16 v[68:71], a[124:127], a[196:199], v[68:71]
    v_mfma_f32_16x16x32_bf16 v[72:75], a[52:55], a[200:203], v[72:75]
    ds_read_b128 a[240:243], v128 offset:17408
    v_mul_f32 v168, 0x3fb8aa3b, v152
    v_mfma_f32_16x16x32_bf16 v[76:79], a[124:127], a[200:203], v[76:79]
    buffer_load_dwordx4 v1, s[32:35], s66 offen offset:2048 lds
    v_mul_f32 v169, 0x3fb8aa3b, v153
    v_mfma_f32_16x16x32_bf16 v[80:83], a[52:55], a[204:207], v[80:83]
    ds_read_b128 a[244:247], v128 offset:18432
    v_mul_f32 v170, 0x3fb8aa3b, v154
    v_mfma_f32_16x16x32_bf16 v[84:87], a[124:127], a[204:207], v[84:87]
    v_mul_f32 v171, 0x3fb8aa3b, v155
    v_mul_f32 v172, 0x3fb8aa3b, v156
    v_mfma_f32_16x16x32_bf16 v[88:91], a[52:55], a[208:211], v[88:91]
    ds_read_b128 a[196:199], v128 offset:19456
    v_mul_f32 v173, 0x3fb8aa3b, v157
    v_mfma_f32_16x16x32_bf16 v[92:95], a[124:127], a[208:211], v[92:95]
    buffer_load_dwordx4 v1, s[32:35], s66 offen offset:3072 lds
    v_mul_f32 v174, 0x3fb8aa3b, v158
    v_mfma_f32_16x16x32_bf16 v[96:99], a[52:55], a[212:215], v[96:99]
    ds_read_b128 a[200:203], v131 offset:15616
    v_mul_f32 v175, 0x3fb8aa3b, v159
    v_mfma_f32_16x16x32_bf16 v[100:103], a[124:127], a[212:215], v[100:103]
    v_mov_b32 v181, s74
    s_waitcnt vmcnt(10) lgkmcnt(5)
    v_mfma_f32_16x16x32_bf16 v[64:67], a[56:59], a[216:219], v[64:67]
    ds_read_b128 a[204:207], v128 offset:21248
    v_mul_f32 v184, v160, v180
    v_mfma_f32_16x16x32_bf16 v[68:71], a[128:131], a[216:219], v[68:71]
    s_add_u32 m0, s67, 102400
    s_add_u32 s66, s66, 4096
    buffer_load_dwordx4 v1, s[32:35], s66 offen lds
    v_mfma_f32_16x16x32_bf16 v[72:75], a[56:59], a[220:223], v[72:75]
    ds_read_b128 a[208:211], v128 offset:22272
    v_mul_f32 v185, v161, v180
    v_mfma_f32_16x16x32_bf16 v[76:79], a[128:131], a[220:223], v[76:79]
    v_mul_f32 v186, v162, v180
    v_mul_f32 v187, v163, v180
    v_mfma_f32_16x16x32_bf16 v[80:83], a[56:59], a[224:227], v[80:83]
    ds_read_b128 a[212:215], v128 offset:23296
    v_mul_f32 v188, v164, v180
    v_mfma_f32_16x16x32_bf16 v[84:87], a[128:131], a[224:227], v[84:87]
    buffer_load_dwordx4 v1, s[32:35], s66 offen offset:1024 lds
    v_mul_f32 v189, v165, v180
    v_mfma_f32_16x16x32_bf16 v[88:91], a[56:59], a[228:231], v[88:91]
    ds_read_b128 a[216:219], v128 offset:24320
    v_mul_f32 v190, v166, v180
    v_mfma_f32_16x16x32_bf16 v[92:95], a[128:131], a[228:231], v[92:95]
    v_mul_f32 v191, v167, v180
    v_mul_f32 v176, 0x3fb8aa3b, v176
    v_mfma_f32_16x16x32_bf16 v[96:99], a[56:59], a[232:235], v[96:99]
    ds_read_b128 a[220:223], v131 offset:20480
    v_mul_f32 v177, 0x3fb8aa3b, v177
    v_mfma_f32_16x16x32_bf16 v[100:103], a[128:131], a[232:235], v[100:103]
    buffer_load_dwordx4 v1, s[32:35], s66 offen offset:2048 lds
    s_waitcnt vmcnt(11) lgkmcnt(5)
    v_mfma_f32_16x16x32_bf16 v[64:67], a[60:63], a[236:239], v[64:67]
    ds_read_b128 a[224:227], v128 offset:26112
    v_mul_f32 v180, 0x3fb8aa3b, v180
    v_mfma_f32_16x16x32_bf16 v[68:71], a[132:135], a[236:239], v[68:71]
    v_mul_f32 v196, v160, v176
    v_mul_f32 v197, v161, v176
    v_mfma_f32_16x16x32_bf16 v[72:75], a[60:63], a[240:243], v[72:75]
    ds_read_b128 a[228:231], v128 offset:27136
    v_mul_f32 v198, v162, v176
    v_mfma_f32_16x16x32_bf16 v[76:79], a[132:135], a[240:243], v[76:79]
    buffer_load_dwordx4 v1, s[32:35], s66 offen offset:3072 lds
    v_mul_f32 v199, v163, v176
    v_mfma_f32_16x16x32_bf16 v[80:83], a[60:63], a[244:247], v[80:83]
    ds_read_b128 a[232:235], v128 offset:28160
    v_mul_f32 v200, v164, v176
    v_mfma_f32_16x16x32_bf16 v[84:87], a[132:135], a[244:247], v[84:87]
    v_mul_f32 v201, v165, v176
    v_mul_f32 v202, v166, v176
    v_mfma_f32_16x16x32_bf16 v[88:91], a[60:63], a[196:199], v[88:91]
    ds_read_b128 a[236:239], v128 offset:29184
    v_mul_f32 v203, v167, v176
    v_mfma_f32_16x16x32_bf16 v[92:95], a[132:135], a[196:199], v[92:95]
    s_add_u32 m0, s67, 106496
    s_add_u32 s66, s66, 4096
    buffer_load_dwordx4 v1, s[32:35], s66 offen lds
    v_mfma_f32_16x16x32_bf16 v[96:99], a[60:63], a[200:203], v[96:99]
    ds_read_b128 a[240:243], v131 offset:25344
    v_mul_f32 v204, v160, v177
    v_mfma_f32_16x16x32_bf16 v[100:103], a[132:135], a[200:203], v[100:103]
    v_mul_f32 v205, v161, v177
    s_waitcnt vmcnt(11) lgkmcnt(5)
    v_mfma_f32_16x16x32_bf16 v[64:67], a[64:67], a[204:207], v[64:67]
    v_mul_f32 v206, v162, v177
    v_mul_f32 v207, v163, v177
    v_mfma_f32_16x16x32_bf16 v[68:71], a[136:139], a[204:207], v[68:71]
    v_mul_f32 v208, v164, v177
    v_mul_f32 v209, v165, v177
    v_mfma_f32_16x16x32_bf16 v[72:75], a[64:67], a[208:211], v[72:75]
    v_mul_f32 v210, v166, v177
    v_mul_f32 v211, v167, v177
    v_mfma_f32_16x16x32_bf16 v[76:79], a[136:139], a[208:211], v[76:79]
    v_mul_f32 v212, v160, v178
    v_mul_f32 v213, v161, v178
    v_mfma_f32_16x16x32_bf16 v[80:83], a[64:67], a[212:215], v[80:83]
    v_mul_f32 v214, v162, v178
    v_mul_f32 v215, v163, v178
    v_mfma_f32_16x16x32_bf16 v[84:87], a[136:139], a[212:215], v[84:87]
    v_mul_f32 v216, v164, v178
    v_mul_f32 v217, v165, v178
    v_mfma_f32_16x16x32_bf16 v[88:91], a[64:67], a[216:219], v[88:91]
    v_mul_f32 v218, v166, v178
    v_mul_f32 v219, v167, v178
    v_mfma_f32_16x16x32_bf16 v[92:95], a[136:139], a[216:219], v[92:95]
    v_mul_f32 v220, v160, v179
    v_mfma_f32_16x16x32_bf16 v[96:99], a[64:67], a[220:223], v[96:99]
    v_mul_f32 v221, v161, v179
    v_mul_f32 v222, v162, v179
    v_mfma_f32_16x16x32_bf16 v[100:103], a[136:139], a[220:223], v[100:103]
    v_mul_f32 v223, v163, v179
    s_waitcnt vmcnt(9) lgkmcnt(0)
    v_mfma_f32_16x16x32_bf16 v[64:67], a[68:71], a[224:227], v[64:67]
    v_mul_f32 v224, v164, v179
    v_mfma_f32_16x16x32_bf16 v[68:71], a[140:143], a[224:227], v[68:71]
    v_mul_f32 v225, v165, v179
    v_mfma_f32_16x16x32_bf16 v[72:75], a[68:71], a[228:231], v[72:75]
    v_mul_f32 v226, v166, v179
    v_mul_f32 v227, v167, v179
    v_mfma_f32_16x16x32_bf16 v[76:79], a[140:143], a[228:231], v[76:79]
    v_mul_f32 v228, v160, v180
    v_mfma_f32_16x16x32_bf16 v[80:83], a[68:71], a[232:235], v[80:83]
    v_mul_f32 v229, v161, v180
    v_mfma_f32_16x16x32_bf16 v[84:87], a[140:143], a[232:235], v[84:87]
    v_mul_f32 v230, v162, v180
    v_mfma_f32_16x16x32_bf16 v[88:91], a[68:71], a[236:239], v[88:91]
    v_mul_f32 v231, v163, v180
    v_mul_f32 v232, v164, v180
    v_mfma_f32_16x16x32_bf16 v[92:95], a[140:143], a[236:239], v[92:95]
    v_mul_f32 v233, v165, v180
    v_mfma_f32_16x16x32_bf16 v[96:99], a[68:71], a[240:243], v[96:99]
    v_mul_f32 v234, v166, v180
    v_mfma_f32_16x16x32_bf16 v[100:103], a[140:143], a[240:243], v[100:103]
    v_mul_f32 v235, v167, v180
    s_add_u32 s45, s45, s3
    v_pk_fma_f32 v[64:65], v[64:65], v[168:169], v[196:197]
    v_pk_fma_f32 v[66:67], v[66:67], v[170:171], v[198:199]
    v_pk_fma_f32 v[68:69], v[68:69], v[172:173], v[200:201]
    v_pk_fma_f32 v[70:71], v[70:71], v[174:175], v[202:203]
    v_pk_fma_f32 v[72:73], v[72:73], v[168:169], v[204:205]
    v_pk_fma_f32 v[74:75], v[74:75], v[170:171], v[206:207]
    v_pk_fma_f32 v[76:77], v[76:77], v[172:173], v[208:209]
    v_pk_fma_f32 v[78:79], v[78:79], v[174:175], v[210:211]
    v_pk_fma_f32 v[80:81], v[80:81], v[152:153], v[212:213]
    v_pk_fma_f32 v[82:83], v[82:83], v[154:155], v[214:215]
    v_pk_fma_f32 v[84:85], v[84:85], v[156:157], v[216:217]
    v_pk_fma_f32 v[86:87], v[86:87], v[158:159], v[218:219]
    v_pk_fma_f32 v[88:89], v[88:89], v[152:153], v[220:221]
    v_pk_fma_f32 v[90:91], v[90:91], v[154:155], v[222:223]
    v_pk_fma_f32 v[92:93], v[92:93], v[156:157], v[224:225]
    v_pk_fma_f32 v[94:95], v[94:95], v[158:159], v[226:227]
    v_pk_fma_f32 v[184:185], v[96:97], v[152:153], v[184:185]
    v_pk_fma_f32 v[186:187], v[98:99], v[154:155], v[186:187]
    v_pk_fma_f32 v[188:189], v[100:101], v[156:157], v[188:189]
    v_pk_fma_f32 v[190:191], v[102:103], v[158:159], v[190:191]
    v_pk_fma_f32 v[96:97], v[96:97], v[168:169], v[228:229]
    v_pk_fma_f32 v[98:99], v[98:99], v[170:171], v[230:231]
    v_pk_fma_f32 v[100:101], v[100:101], v[172:173], v[232:233]
    v_pk_fma_f32 v[102:103], v[102:103], v[174:175], v[234:235]
    v_cvt_pk_bf16_f32 v36, v184, v185
    v_cvt_pk_bf16_f32 v37, v186, v187
    v_cvt_pk_bf16_f32 v38, v188, v189
    v_cvt_pk_bf16_f32 v39, v190, v191
    v_cndmask_b32 v36, v36, v181, s[72:73]
    v_cndmask_b32 v37, v37, v181, s[72:73]
    v_cndmask_b32 v38, v38, v181, s[72:73]
    v_cndmask_b32 v39, v39, v181, s[72:73]
    v_cvt_pk_bf16_f32 v244, v80, v81
    v_cvt_pk_bf16_f32 v245, v82, v83
    v_cvt_pk_bf16_f32 v246, v84, v85
    v_cvt_pk_bf16_f32 v247, v86, v87
    v_cvt_pk_bf16_f32 v248, v88, v89
    v_cvt_pk_bf16_f32 v249, v90, v91
    v_cvt_pk_bf16_f32 v250, v92, v93
    v_cvt_pk_bf16_f32 v251, v94, v95
    v_exp_f32 v26, v96 clamp
    v_exp_f32 v27, v97 clamp
    v_max_f32 v96, 0x35c1a2a0, v96
    v_max_f32 v97, 0x35c1a2a0, v97
    v_pk_fma_f32 v[96:97], v[96:97], s[90:91], v[26:27] op_sel:[0,0,0] op_sel_hi:[1,0,1]
    v_cvt_pk_bf16_f32 v252, v96, v97
    v_exp_f32 v26, v98 clamp
    v_exp_f32 v27, v99 clamp
    v_max_f32 v98, 0x35c1a2a0, v98
    v_max_f32 v99, 0x35c1a2a0, v99
    v_pk_fma_f32 v[98:99], v[98:99], s[90:91], v[26:27] op_sel:[0,0,0] op_sel_hi:[1,0,1]
    v_cvt_pk_bf16_f32 v253, v98, v99
    v_exp_f32 v26, v100 clamp
    v_exp_f32 v27, v101 clamp
    v_max_f32 v100, 0x35c1a2a0, v100
    v_max_f32 v101, 0x35c1a2a0, v101
    v_pk_fma_f32 v[100:101], v[100:101], s[90:91], v[26:27] op_sel:[0,0,0] op_sel_hi:[1,0,1]
    v_cvt_pk_bf16_f32 v254, v100, v101
    v_exp_f32 v26, v102 clamp
    v_exp_f32 v27, v103 clamp
    v_max_f32 v102, 0x35c1a2a0, v102
    v_max_f32 v103, 0x35c1a2a0, v103
    v_pk_fma_f32 v[102:103], v[102:103], s[90:91], v[26:27] op_sel:[0,0,0] op_sel_hi:[1,0,1]
    v_cvt_pk_bf16_f32 v255, v102, v103
    s_nop 1
    v_mfma_f32_16x16x32_bf16 v[220:223], v[252:255], v[244:247], 0
    v_mfma_f32_16x16x32_bf16 v[224:227], v[252:255], v[248:251], 0
    v_mfma_f32_16x16x32_bf16 v[228:231], v[252:255], v[36:39], 0
    v_exp_f32 v26, v64 clamp
    v_exp_f32 v27, v65 clamp
    v_max_f32 v64, 0x35c1a2a0, v64
    v_max_f32 v65, 0x35c1a2a0, v65
    v_pk_fma_f32 v[64:65], v[64:65], s[90:91], v[26:27] op_sel:[0,0,0] op_sel_hi:[1,0,1]
    v_cvt_pk_bf16_f32 v236, v64, v65
    v_exp_f32 v26, v66 clamp
    v_exp_f32 v27, v67 clamp
    v_max_f32 v66, 0x35c1a2a0, v66
    v_max_f32 v67, 0x35c1a2a0, v67
    v_pk_fma_f32 v[66:67], v[66:67], s[90:91], v[26:27] op_sel:[0,0,0] op_sel_hi:[1,0,1]
    v_cvt_pk_bf16_f32 v237, v66, v67
    v_exp_f32 v26, v68 clamp
    v_exp_f32 v27, v69 clamp
    v_max_f32 v68, 0x35c1a2a0, v68
    v_max_f32 v69, 0x35c1a2a0, v69
    v_pk_fma_f32 v[68:69], v[68:69], s[90:91], v[26:27] op_sel:[0,0,0] op_sel_hi:[1,0,1]
    v_cvt_pk_bf16_f32 v238, v68, v69
    v_exp_f32 v26, v70 clamp
    v_exp_f32 v27, v71 clamp
    v_max_f32 v70, 0x35c1a2a0, v70
    v_max_f32 v71, 0x35c1a2a0, v71
    v_pk_fma_f32 v[70:71], v[70:71], s[90:91], v[26:27] op_sel:[0,0,0] op_sel_hi:[1,0,1]
    v_cvt_pk_bf16_f32 v239, v70, v71
    s_nop 1
    v_mfma_f32_16x16x32_bf16 v[204:207], v[236:239], v[244:247], 0
    v_mfma_f32_16x16x32_bf16 v[212:215], v[236:239], v[36:39], 0
    s_mov_b64 exec, 0xffff
    ds_write_b128 v129, v[220:223] offset:3072
    ds_write_b128 v129, v[224:227] offset:3328
    s_mov_b64 exec, 0x1f00
    ds_write_b128 v129, v[228:231] offset:3584
    s_mov_b64 exec, -1
    v_exp_f32 v26, v72 clamp
    v_exp_f32 v27, v73 clamp
    v_max_f32 v72, 0x35c1a2a0, v72
    v_max_f32 v73, 0x35c1a2a0, v73
    v_pk_fma_f32 v[72:73], v[72:73], s[90:91], v[26:27] op_sel:[0,0,0] op_sel_hi:[1,0,1]
    v_cvt_pk_bf16_f32 v240, v72, v73
    v_exp_f32 v26, v74 clamp
    v_exp_f32 v27, v75 clamp
    v_max_f32 v74, 0x35c1a2a0, v74
    v_max_f32 v75, 0x35c1a2a0, v75
    v_pk_fma_f32 v[74:75], v[74:75], s[90:91], v[26:27] op_sel:[0,0,0] op_sel_hi:[1,0,1]
    v_cvt_pk_bf16_f32 v241, v74, v75
    v_exp_f32 v26, v76 clamp
    v_exp_f32 v27, v77 clamp
    v_max_f32 v76, 0x35c1a2a0, v76
    v_max_f32 v77, 0x35c1a2a0, v77
    v_pk_fma_f32 v[76:77], v[76:77], s[90:91], v[26:27] op_sel:[0,0,0] op_sel_hi:[1,0,1]
    v_cvt_pk_bf16_f32 v242, v76, v77
    v_exp_f32 v26, v78 clamp
    v_exp_f32 v27, v79 clamp
    v_max_f32 v78, 0x35c1a2a0, v78
    v_max_f32 v79, 0x35c1a2a0, v79
    v_pk_fma_f32 v[78:79], v[78:79], s[90:91], v[26:27] op_sel:[0,0,0] op_sel_hi:[1,0,1]
    v_cvt_pk_bf16_f32 v243, v78, v79
    s_nop 1
    v_mfma_f32_16x16x32_bf16 v[208:211], v[240:243], v[248:251], 0
    v_mfma_f32_16x16x32_bf16 v[216:219], v[240:243], v[36:39], 0
    ds_write_b128 v129, v[204:207]
    s_mov_b32 exec_lo, 0x1f001f00
    s_mov_b32 exec_hi, 0x1f001f00
    ds_write_b128 v129, v[212:215] offset:2048
    s_mov_b64 exec, -1
    s_nop 1
    ds_write_b128 v129, v[208:211] offset:1024
    s_mov_b32 exec_lo, 0x1f001f00
    s_mov_b32 exec_hi, 0x1f001f00
    ds_write_b128 v129, v[216:219] offset:1920
    s_mov_b64 exec, -1
    s_waitcnt lgkmcnt(0)
    s_barrier
    ds_read_b128 v[196:199], v11 offset:0
    ds_read_b128 v[200:203], v11 offset:4096
    ds_read_b128 v[204:207], v11 offset:8192
    ds_read_b128 v[208:211], v11 offset:12288
    s_mov_b32 exec_lo, 0x00f000f0
    s_mov_b32 exec_hi, 0x00f000f0
    ds_write_b64 v132, v[252:253]
    ds_write_b64 v132, v[254:255] offset:32
    s_mov_b64 exec, -1
    ds_read_b64_tr_b16 v[30:31], v133
    s_waitcnt lgkmcnt(5)
    v_pk_add_f32 v[196:197], v[196:197], v[200:201]
    v_pk_add_f32 v[198:199], v[198:199], v[202:203]
    s_waitcnt lgkmcnt(3)
    v_pk_add_f32 v[204:205], v[204:205], v[208:209]
    v_pk_add_f32 v[206:207], v[206:207], v[210:211]
    v_pk_add_f32 v[196:197], v[196:197], v[204:205]
    v_pk_add_f32 v[198:199], v[198:199], v[206:207]
    v_cvt_pk_bf16_f32 v200, v196, v197
    v_cvt_pk_bf16_f32 v201, v198, v199
    buffer_store_dwordx2 v[200:201], v134, s[32:35], s51 offen sc1
    s_waitcnt vmcnt(1)
    s_barrier
    ds_read_b128 a[196:199], v136 offset:0
    ds_read_b128 a[200:203], v136 offset:1024
    ds_read_b128 a[204:207], v136 offset:2048
    ds_read_b128 a[208:211], v136 offset:3072
    s_waitcnt lgkmcnt(2)
    v_mfma_f32_16x16x32_bf16 v[104:107], a[196:199], a[0:3], 0
    ds_read_b128 a[212:215], v136 offset:4096
    buffer_load_dword v42, v43, s[32:35], 0 offen sc1
    v_mfma_f32_16x16x32_bf16 v[108:111], a[196:199], a[72:75], 0
    v_and_b32 v140, 48, v0
    v_add_u32 v140, 160064, v140
    v_mfma_f32_16x16x32_bf16 v[112:115], a[200:203], a[0:3], 0
    ds_read_b128 a[216:219], v136 offset:5120
    ds_read_b128 v[176:179], v140 offset:0
    v_mfma_f32_16x16x32_bf16 v[116:119], a[200:203], a[72:75], 0
    buffer_load_dword v42, v2, s[24:27], 0 offen sc1
    s_waitcnt lgkmcnt(3)
    v_mfma_f32_16x16x32_bf16 v[104:107], a[204:207], a[4:7], v[104:107]
    ds_read_b128 a[220:223], v136 offset:6144
    ds_read_b128 v[180:183], v140 offset:64
    v_mfma_f32_16x16x32_bf16 v[108:111], a[204:207], a[76:79], v[108:111]
    v_mul_f32 v148, 0x3fb8aa3b, v148
    v_mul_f32 v149, 0x3fb8aa3b, v149
    v_mfma_f32_16x16x32_bf16 v[112:115], a[208:211], a[4:7], v[112:115]
    ds_read_b128 a[224:227], v136 offset:7168
    v_mul_f32 v150, 0x3fb8aa3b, v150
    v_mfma_f32_16x16x32_bf16 v[116:119], a[208:211], a[76:79], v[116:119]
    s_mul_i32 s67, s38, 14336
    s_add_u32 s66, s67, s89
    s_add_u32 m0, s67, 0
    s_add_u32 s66, s66, 46137344
    buffer_load_dwordx4 v1, s[32:35], s66 offen lds
    v_mul_f32 v151, 0x3fb8aa3b, v151
    s_waitcnt lgkmcnt(4)
    v_mfma_f32_16x16x32_bf16 v[104:107], a[212:215], a[8:11], v[104:107]
    ds_read_b128 a[228:231], v136 offset:8192
    v_mfma_f32_16x16x32_bf16 v[108:111], a[212:215], a[80:83], v[108:111]
    v_mfma_f32_16x16x32_bf16 v[112:115], a[216:219], a[8:11], v[112:115]
    ds_read_b128 a[232:235], v136 offset:9216
    v_mfma_f32_16x16x32_bf16 v[116:119], a[216:219], a[80:83], v[116:119]
    buffer_load_dwordx4 v1, s[32:35], s66 offen offset:1024 lds
    s_waitcnt lgkmcnt(2)
    v_mfma_f32_16x16x32_bf16 v[104:107], a[220:223], a[12:15], v[104:107]
    ds_read_b128 a[236:239], v136 offset:10240
    v_mfma_f32_16x16x32_bf16 v[108:111], a[220:223], a[84:87], v[108:111]
    v_mfma_f32_16x16x32_bf16 v[112:115], a[224:227], a[12:15], v[112:115]
    ds_read_b128 a[240:243], v136 offset:11264
    buffer_load_dwordx4 v1, s[32:35], s66 offen offset:2048 lds
    v_mfma_f32_16x16x32_bf16 v[116:119], a[224:227], a[84:87], v[116:119]
    s_waitcnt lgkmcnt(2)
    v_mfma_f32_16x16x32_bf16 v[104:107], a[228:231], a[16:19], v[104:107]
    ds_read_b128 a[244:247], v136 offset:12288
    v_mul_f32 v152, v150, v176
    v_mfma_f32_16x16x32_bf16 v[108:111], a[228:231], a[88:91], v[108:111]
    v_mul_f32 v153, v150, v177
    v_mfma_f32_16x16x32_bf16 v[112:115], a[232:235], a[16:19], v[112:115]
    ds_read_b128 a[196:199], v136 offset:13312
    buffer_load_dwordx4 v1, s[32:35], s66 offen offset:3072 lds
    v_mfma_f32_16x16x32_bf16 v[116:119], a[232:235], a[88:91], v[116:119]
    v_mul_f32 v154, v150, v178
    s_waitcnt lgkmcnt(2)
    v_mfma_f32_16x16x32_bf16 v[104:107], a[236:239], a[20:23], v[104:107]
    ds_read_b128 a[200:203], v136 offset:14336
    v_mfma_f32_16x16x32_bf16 v[108:111], a[236:239], a[92:95], v[108:111]
    v_mul_f32 v155, v150, v179
    v_mfma_f32_16x16x32_bf16 v[112:115], a[240:243], a[20:23], v[112:115]
    ds_read_b128 a[204:207], v136 offset:15360
    s_add_u32 m0, s67, 4096
    s_add_u32 s66, s66, 4096
    buffer_load_dwordx4 v1, s[32:35], s66 offen lds
    v_mfma_f32_16x16x32_bf16 v[116:119], a[240:243], a[92:95], v[116:119]
    v_mul_f32 v156, v151, v176
    s_waitcnt lgkmcnt(2)
    v_mfma_f32_16x16x32_bf16 v[104:107], a[244:247], a[24:27], v[104:107]
    ds_read_b128 a[208:211], v136 offset:16384
    v_mfma_f32_16x16x32_bf16 v[108:111], a[244:247], a[96:99], v[108:111]
    v_mul_f32 v157, v151, v177
    v_mfma_f32_16x16x32_bf16 v[112:115], a[196:199], a[24:27], v[112:115]
    ds_read_b128 a[212:215], v136 offset:17408
    buffer_load_dwordx4 v1, s[32:35], s66 offen offset:1024 lds
    v_mfma_f32_16x16x32_bf16 v[116:119], a[196:199], a[96:99], v[116:119]
    v_mul_f32 v158, v151, v178
    s_waitcnt lgkmcnt(2)
    v_mfma_f32_16x16x32_bf16 v[104:107], a[200:203], a[28:31], v[104:107]
    ds_read_b128 a[216:219], v136 offset:18432
    v_mfma_f32_16x16x32_bf16 v[108:111], a[200:203], a[100:103], v[108:111]
    buffer_load_dwordx4 v1, s[32:35], s66 offen offset:2048 lds
    v_mul_f32 v159, v151, v179
    v_mfma_f32_16x16x32_bf16 v[112:115], a[204:207], a[28:31], v[112:115]
    ds_read_b128 a[220:223], v136 offset:19456
    v_mul_f32 v160, v150, v180
    v_mfma_f32_16x16x32_bf16 v[116:119], a[204:207], a[100:103], v[116:119]
    s_waitcnt lgkmcnt(2)
    v_mfma_f32_16x16x32_bf16 v[104:107], a[208:211], a[32:35], v[104:107]
    ds_read_b128 a[224:227], v136 offset:20480
    v_mul_f32 v161, v150, v181
    v_mfma_f32_16x16x32_bf16 v[108:111], a[208:211], a[104:107], v[108:111]
    buffer_load_dwordx4 v1, s[32:35], s66 offen offset:3072 lds
    v_mfma_f32_16x16x32_bf16 v[112:115], a[212:215], a[32:35], v[112:115]
    ds_read_b128 a[228:231], v136 offset:21504
    v_mul_f32 v162, v150, v182
    v_mfma_f32_16x16x32_bf16 v[116:119], a[212:215], a[104:107], v[116:119]
    s_waitcnt lgkmcnt(2)
    v_mfma_f32_16x16x32_bf16 v[104:107], a[216:219], a[36:39], v[104:107]
    ds_read_b128 a[232:235], v136 offset:22528
    v_mul_f32 v163, v150, v183
    v_mfma_f32_16x16x32_bf16 v[108:111], a[216:219], a[108:111], v[108:111]
    s_add_u32 m0, s67, 8192
    s_add_u32 s66, s66, 4096
    buffer_load_dwordx4 v1, s[32:35], s66 offen lds
    v_mfma_f32_16x16x32_bf16 v[112:115], a[220:223], a[36:39], v[112:115]
    ds_read_b128 a[236:239], v136 offset:23552
    v_mul_f32 v164, v151, v180
    v_mfma_f32_16x16x32_bf16 v[116:119], a[220:223], a[108:111], v[116:119]
    s_waitcnt lgkmcnt(2)
    v_mfma_f32_16x16x32_bf16 v[104:107], a[224:227], a[40:43], v[104:107]
    ds_read_b128 a[240:243], v136 offset:24576
    v_mul_f32 v165, v151, v181
    v_mfma_f32_16x16x32_bf16 v[108:111], a[224:227], a[112:115], v[108:111]
    buffer_load_dwordx4 v1, s[32:35], s66 offen offset:1024 lds
    v_mfma_f32_16x16x32_bf16 v[112:115], a[228:231], a[40:43], v[112:115]
    ds_read_b128 a[244:247], v136 offset:25600
    v_mul_f32 v166, v151, v182
    v_mfma_f32_16x16x32_bf16 v[116:119], a[228:231], a[112:115], v[116:119]
    s_waitcnt lgkmcnt(2)
    v_mfma_f32_16x16x32_bf16 v[104:107], a[232:235], a[44:47], v[104:107]
    ds_read_b128 a[196:199], v136 offset:26624
    buffer_load_dwordx4 v1, s[32:35], s66 offen offset:2048 lds
    v_mfma_f32_16x16x32_bf16 v[108:111], a[232:235], a[116:119], v[108:111]
    v_mul_f32 v167, v151, v183
    v_add_u32 v38, 0, v1
    v_mfma_f32_16x16x32_bf16 v[112:115], a[236:239], a[44:47], v[112:115]
    ds_read_b128 a[200:203], v136 offset:27648
    v_mfma_f32_16x16x32_bf16 v[116:119], a[236:239], a[116:119], v[116:119]
    v_add_u32 v39, 63488, v1
    s_waitcnt lgkmcnt(2)
    v_mfma_f32_16x16x32_bf16 v[104:107], a[240:243], a[48:51], v[104:107]
    ds_read_b128 a[204:207], v136 offset:28672
    buffer_load_dwordx4 v1, s[32:35], s66 offen offset:3072 lds
    v_mfma_f32_16x16x32_bf16 v[108:111], a[240:243], a[120:123], v[108:111]
    v_mov_b32 v193, 0
    v_mfma_f32_16x16x32_bf16 v[112:115], a[244:247], a[48:51], v[112:115]
    ds_read_b128 a[208:211], v136 offset:29696
    v_mfma_f32_16x16x32_bf16 v[116:119], a[244:247], a[120:123], v[116:119]
    v_mov_b32 v194, 0
    s_waitcnt lgkmcnt(2)
    v_mfma_f32_16x16x32_bf16 v[104:107], a[196:199], a[52:55], v[104:107]
    ds_read_b128 a[212:215], v136 offset:30720
    s_add_u32 m0, s67, 12288
    s_add_u32 s66, s66, 4096
    buffer_load_dwordx4 v1, s[32:35], s66 offen lds
    v_mfma_f32_16x16x32_bf16 v[108:111], a[196:199], a[124:127], v[108:111]
    v_mov_b32 v195, 0
    v_mfma_f32_16x16x32_bf16 v[112:115], a[200:203], a[52:55], v[112:115]
    ds_read_b128 a[216:219], v136 offset:31744
    v_mfma_f32_16x16x32_bf16 v[116:119], a[200:203], a[124:127], v[116:119]
    v_mov_b32 v196, 0
    s_waitcnt lgkmcnt(2)
    v_mfma_f32_16x16x32_bf16 v[104:107], a[204:207], a[56:59], v[104:107]
    ds_read_b128 a[220:223], v136 offset:32768
    buffer_load_dwordx4 v[224:227], v21, s[32:35], s52 offen offset:0 sc1
    v_mfma_f32_16x16x32_bf16 v[108:111], a[204:207], a[128:131], v[108:111]
    v_mov_b32 v198, 0
    v_mfma_f32_16x16x32_bf16 v[112:115], a[208:211], a[56:59], v[112:115]
    ds_read_b128 a[224:227], v136 offset:33792
    buffer_load_dwordx4 v[228:231], v21, s[32:35], s52 offen offset:256 sc1
    v_mfma_f32_16x16x32_bf16 v[116:119], a[208:211], a[128:131], v[116:119]
    v_mov_b32 v199, 0
    s_waitcnt lgkmcnt(2)
    v_mfma_f32_16x16x32_bf16 v[104:107], a[212:215], a[60:63], v[104:107]
    ds_read_b128 a[228:231], v136 offset:34816
    s_add_u32 s56, s52, 7168
    buffer_load_dwordx4 v[232:235], v21, s[32:35], s56 offen offset:0 sc1
    v_mfma_f32_16x16x32_bf16 v[108:111], a[212:215], a[132:135], v[108:111]
    v_cndmask_b32 v192, 0, v30, s[70:71]
    v_mfma_f32_16x16x32_bf16 v[112:115], a[216:219], a[60:63], v[112:115]
    ds_read_b128 a[232:235], v136 offset:35840
    buffer_load_dwordx4 v[236:239], v21, s[32:35], s56 offen offset:256 sc1
    v_mfma_f32_16x16x32_bf16 v[116:119], a[216:219], a[132:135], v[116:119]
    v_cndmask_b32 v197, 0, v31, s[70:71]
    s_waitcnt lgkmcnt(2)
    v_mfma_f32_16x16x32_bf16 v[104:107], a[220:223], a[64:67], v[104:107]
    s_add_u32 s56, s52, 14336
    buffer_load_dwordx4 v[240:243], v21, s[32:35], s56 offen offset:0 sc1
    v_mfma_f32_16x16x32_bf16 v[108:111], a[220:223], a[136:139], v[108:111]
    v_mov_b32 v206, 0
    v_mfma_f32_16x16x32_bf16 v[112:115], a[224:227], a[64:67], v[112:115]
    buffer_load_dwordx4 v[244:247], v21, s[32:35], s56 offen offset:256 sc1
    v_mov_b32 v207, 0
    v_mfma_f32_16x16x32_bf16 v[116:119], a[224:227], a[136:139], v[116:119]
    s_waitcnt lgkmcnt(0)
    v_mfma_f32_16x16x32_bf16 v[104:107], a[228:231], a[68:71], v[104:107]
    s_add_u32 s56, s52, 21504
    buffer_load_dwordx4 v[248:251], v21, s[32:35], s56 offen offset:0 sc1
    v_mfma_f32_16x16x32_bf16 v[108:111], a[228:231], a[140:143], v[108:111]
    v_mov_b32 v214, 0
    v_mfma_f32_16x16x32_bf16 v[112:115], a[232:235], a[68:71], v[112:115]
    buffer_load_dwordx4 v[252:255], v21, s[32:35], s56 offen offset:256 sc1
    v_mov_b32 v215, 0
    v_mfma_f32_16x16x32_bf16 v[116:119], a[232:235], a[140:143], v[116:119]
    v_pk_fma_f32 v[104:105], v[104:105], v[148:149], v[152:153] op_sel:[0,0,0] op_sel_hi:[1,0,1]
    buffer_load_dwordx4 v1, s[32:35], s66 offen offset:1024 lds
    v_pk_fma_f32 v[106:107], v[106:107], v[148:149], v[154:155] op_sel:[0,0,0] op_sel_hi:[1,0,1]
    v_pk_fma_f32 v[108:109], v[108:109], v[148:149], v[156:157] op_sel:[0,1,0] op_sel_hi:[1,1,1]
    v_pk_fma_f32 v[110:111], v[110:111], v[148:149], v[158:159] op_sel:[0,1,0] op_sel_hi:[1,1,1]
    v_exp_f32 v26, v104 clamp
    v_exp_f32 v27, v105 clamp
    v_max_f32 v104, 0x35c1a2a0, v104
    v_max_f32 v105, 0x35c1a2a0, v105
    v_pk_fma_f32 v[104:105], v[104:105], s[90:91], v[26:27] op_sel:[0,0,0] op_sel_hi:[1,0,1]
    v_exp_f32 v26, v106 clamp
    v_exp_f32 v27, v107 clamp
    v_max_f32 v106, 0x35c1a2a0, v106
    v_max_f32 v107, 0x35c1a2a0, v107
    v_pk_fma_f32 v[106:107], v[106:107], s[90:91], v[26:27] op_sel:[0,0,0] op_sel_hi:[1,0,1]
    v_exp_f32 v26, v108 clamp
    v_exp_f32 v27, v109 clamp
    s_mul_i32 s67, s38, 7168
    s_min_u32 s67, s67, 18432
    s_add_u32 s66, s67, s89
    s_add_u32 m0, s67, 63488
    s_add_u32 s66, s66, 46194688
    buffer_load_dwordx4 v1, s[32:35], s66 offen lds
    v_max_f32 v108, 0x35c1a2a0, v108
    v_max_f32 v109, 0x35c1a2a0, v109
    v_pk_fma_f32 v[108:109], v[108:109], s[90:91], v[26:27] op_sel:[0,0,0] op_sel_hi:[1,0,1]
    v_exp_f32 v26, v110 clamp
    v_exp_f32 v27, v111 clamp
    v_max_f32 v110, 0x35c1a2a0, v110
    v_max_f32 v111, 0x35c1a2a0, v111
    v_pk_fma_f32 v[110:111], v[110:111], s[90:91], v[26:27] op_sel:[0,0,0] op_sel_hi:[1,0,1]
    v_cvt_pk_bf16_f32 v184, v104, v105
    v_cvt_pk_bf16_f32 v186, v108, v109
    v_cvt_pk_bf16_f32 v185, v106, v107
    v_cvt_pk_bf16_f32 v187, v110, v111
    v_pk_fma_f32 v[112:113], v[112:113], v[148:149], v[160:161] op_sel:[0,0,0] op_sel_hi:[1,0,1]
L_hop7:
    s_cbranch_execz L_hopback
    v_pk_fma_f32 v[114:115], v[114:115], v[148:149], v[162:163] op_sel:[0,0,0] op_sel_hi:[1,0,1]
    v_pk_fma_f32 v[116:117], v[116:117], v[148:149], v[164:165] op_sel:[0,1,0] op_sel_hi:[1,1,1]
    buffer_load_dwordx4 v1, s[32:35], s66 offen offset:1024 lds
    v_pk_fma_f32 v[118:119], v[118:119], v[148:149], v[166:167] op_sel:[0,1,0] op_sel_hi:[1,1,1]
    v_exp_f32 v26, v112 clamp
    v_exp_f32 v27, v113 clamp
    v_max_f32 v112, 0x35c1a2a0, v112
    v_max_f32 v113, 0x35c1a2a0, v113
    v_pk_fma_f32 v[112:113], v[112:113], s[90:91], v[26:27] op_sel:[0,0,0] op_sel_hi:[1,0,1]
    v_exp_f32 v26, v114 clamp
    v_exp_f32 v27, v115 clamp
    v_max_f32 v114, 0x35c1a2a0, v114
    v_max_f32 v115, 0x35c1a2a0, v115
    v_pk_fma_f32 v[114:115], v[114:115], s[90:91], v[26:27] op_sel:[0,0,0] op_sel_hi:[1,0,1]
    v_exp_f32 v26, v116 clamp
    v_exp_f32 v27, v117 clamp
    v_max_f32 v116, 0x35c1a2a0, v116
    v_max_f32 v117, 0x35c1a2a0, v117
    buffer_load_dwordx4 v1, s[32:35], s66 offen offset:2048 lds
    v_pk_fma_f32 v[116:117], v[116:117], s[90:91], v[26:27] op_sel:[0,0,0] op_sel_hi:[1,0,1]
    v_exp_f32 v26, v118 clamp
    v_exp_f32 v27, v119 clamp
    v_max_f32 v118, 0x35c1a2a0, v118
    v_max_f32 v119, 0x35c1a2a0, v119
    v_pk_fma_f32 v[118:119], v[118:119], s[90:91], v[26:27] op_sel:[0,0,0] op_sel_hi:[1,0,1]
    v_cvt_pk_bf16_f32 v188, v112, v113
    v_cvt_pk_bf16_f32 v190, v116, v117
    v_cvt_pk_bf16_f32 v189, v114, v115
    v_cvt_pk_bf16_f32 v191, v118, v119
    v_permlane16_swap_b32 v184, v186
    v_permlane16_swap_b32 v185, v187
    v_permlane16_swap_b32 v188, v190
    v_permlane16_swap_b32 v189, v191
    s_mul_i32 s63, s38, 5120
    s_add_u32 s63, s63, 137216
    v_add_u32 v40, s63, v1
    ds_write_b128 v40, a[176:179] offset:0
    ds_write_b128 v40, a[180:183] offset:1024
    ds_write_b128 v40, a[184:187] offset:2048
    ds_write_b128 v40, a[188:191] offset:3072
    ds_write_b128 v40, a[192:195] offset:4096
    s_waitcnt vmcnt(11)
    v_mfma_f32_16x16x32_bf16 v[28:31], a[248:251], v[224:227], 0
    s_waitcnt vmcnt(10)
    v_mfma_f32_16x16x32_bf16 v[28:31], a[252:255], v[228:231], v[28:31]
    buffer_load_dwordx4 v1, s[32:35], s66 offen offset:3072 lds
    s_waitcnt vmcnt(10)
    v_mfma_f32_16x16x32_bf16 v[28:31], a[248:251], v[232:235], v[28:31]
    s_add_u32 m0, s67, 67584
    s_add_u32 s66, s66, 4096
    buffer_load_dwordx4 v1, s[32:35], s66 offen lds
    s_waitcnt vmcnt(10)
    v_mfma_f32_16x16x32_bf16 v[28:31], a[252:255], v[236:239], v[28:31]
    buffer_load_dwordx4 v1, s[32:35], s66 offen offset:1024 lds
    s_waitcnt vmcnt(10)
    v_mfma_f32_16x16x32_bf16 v[28:31], a[248:251], v[240:243], v[28:31]
    s_waitcnt vmcnt(9)
    v_mfma_f32_16x16x32_bf16 v[28:31], a[252:255], v[244:247], v[28:31]
    buffer_load_dwordx4 v1, s[32:35], s66 offen offset:2048 lds
    s_waitcnt vmcnt(9)
    v_mfma_f32_16x16x32_bf16 v[28:31], a[248:251], v[248:251], v[28:31]
    buffer_load_dword v42, v43, s[32:35], 0 offen sc1
    s_waitcnt vmcnt(9)
    v_mfma_f32_16x16x32_bf16 v[28:31], a[252:255], v[252:255], v[28:31]
    buffer_load_dword v42, v2, s[24:27], 0 offen sc1
chk_42:
    s_sub_u32 s43, s43, 1
    s_cselect_b64 s[68:69], 0, -1
    s_max_i32 s43, s43, 0
    s_nop 3
    v_cmp_u_f32 vcc, v28, v28
    v_cvt_pk_bf16_f32 v32, v28, v29
    v_cvt_pk_bf16_f32 v33, v30, v31
    s_and_b64 vcc, vcc, s[68:69]
    s_cbranch_scc0 ok_44
    s_nop 0
    buffer_load_dwordx4 v[224:227], v21, s[32:35], s52 offen offset:0 sc1
    buffer_load_dwordx4 v[228:231], v21, s[32:35], s52 offen offset:256 sc1
    s_add_u32 s56, s52, 7168
    buffer_load_dwordx4 v[232:235], v21, s[32:35], s56 offen offset:0 sc1
    buffer_load_dwordx4 v[236:239], v21, s[32:35], s56 offen offset:256 sc1
    s_add_u32 s56, s52, 14336
    buffer_load_dwordx4 v[240:243], v21, s[32:35], s56 offen offset:0 sc1
    buffer_load_dwordx4 v[244:247], v21, s[32:35], s56 offen offset:256 sc1
    s_add_u32 s56, s52, 21504
    buffer_load_dwordx4 v[248:251], v21, s[32:35], s56 offen offset:0 sc1
    buffer_load_dwordx4 v[252:255], v21, s[32:35], s56 offen offset:256 sc1
    s_waitcnt vmcnt(0)
    v_mfma_f32_16x16x32_bf16 v[28:31], a[248:251], v[224:227], 0
    v_mfma_f32_16x16x32_bf16 v[28:31], a[252:255], v[228:231], v[28:31]
    v_mfma_f32_16x16x32_bf16 v[28:31], a[248:251], v[232:235], v[28:31]
    v_mfma_f32_16x16x32_bf16 v[28:31], a[252:255], v[236:239], v[28:31]
    v_mfma_f32_16x16x32_bf16 v[28:31], a[248:251], v[240:243], v[28:31]
    v_mfma_f32_16x16x32_bf16 v[28:31], a[252:255], v[244:247], v[28:31]
    v_mfma_f32_16x16x32_bf16 v[28:31], a[248:251], v[248:251], v[28:31]
    v_mfma_f32_16x16x32_bf16 v[28:31], a[252:255], v[252:255], v[28:31]
    s_nop 7
    s_branch chk_42
ok_44:
    ds_write_b64 v10, v[32:33]
    s_add_u32 s52, s52, 28672
    s_add_u32 s51, s51, 28672
    s_waitcnt lgkmcnt(0)
    s_barrier
    ds_read2_b64 v[200:203], v6 offset1:16
    ds_read_b64 v[204:205], v8
    ds_read2_b64 v[208:211], v7 offset1:16
    ds_read_b64 v[212:213], v9
    s_waitcnt lgkmcnt(3)
    v_mfma_f32_32x32x16_bf16 v[224:239], v[200:203], v[184:187], 0
    s_waitcnt lgkmcnt(2)
    v_mfma_f32_32x32x16_bf16 v[224:239], v[204:207], v[192:195], v[224:239]
    s_waitcnt lgkmcnt(1)
    v_mfma_f32_32x32x16_bf16 v[240:255], v[208:211], v[188:191], 0
    s_waitcnt lgkmcnt(0)
    v_mfma_f32_32x32x16_bf16 v[240:255], v[212:215], v[196:199], v[240:255]
    s_nop 7
    v_add_f32 v236, 0x358637bd, v236
    v_rcp_f32 v238, v236
    v_mov_b32 v24, s44
    v_pk_mul_f32 v[224:225], v[224:225], v[238:239] op_sel_hi:[1,0]
    v_pk_mul_f32 v[226:227], v[226:227], v[238:239] op_sel_hi:[1,0]
    v_pk_mul_f32 v[228:229], v[228:229], v[238:239] op_sel_hi:[1,0]
    v_pk_mul_f32 v[230:231], v[230:231], v[238:239] op_sel_hi:[1,0]
    v_pk_mul_f32 v[232:233], v[232:233], v[238:239] op_sel_hi:[1,0]
    v_cvt_pk_bf16_f32 v28, v224, v225
    v_cvt_pk_bf16_f32 v29, v226, v227
    v_cvt_pk_bf16_f32 v30, v228, v229
    v_cvt_pk_bf16_f32 v31, v230, v231
    v_cvt_pk_bf16_f32 v36, v232, v233
    v_add_f32 v252, 0x358637bd, v252
    v_rcp_f32 v254, v252
    v_mov_b32 v24, s44
    v_pk_mul_f32 v[240:241], v[240:241], v[254:255] op_sel_hi:[1,0]
    v_pk_mul_f32 v[242:243], v[242:243], v[254:255] op_sel_hi:[1,0]
    v_pk_mul_f32 v[244:245], v[244:245], v[254:255] op_sel_hi:[1,0]
    v_pk_mul_f32 v[246:247], v[246:247], v[254:255] op_sel_hi:[1,0]
    v_pk_mul_f32 v[250:251], v[250:251], v[254:255] op_sel_hi:[1,0]
    v_cvt_pk_bf16_f32 v32, v240, v241
    v_cvt_pk_bf16_f32 v33, v242, v243
    v_cvt_pk_bf16_f32 v34, v244, v245
    v_cvt_pk_bf16_f32 v35, v246, v247
    v_cvt_pk_bf16_f32 v37, v250, v251
    s_cmp_eq_u32 s41, 0
    s_cbranch_scc1 slow_45
    buffer_store_dwordx4 v[28:31], v14, s[32:35], s47 offen
    buffer_store_dwordx4 v[32:35], v14, s[32:35], s47 offen offset:512
    buffer_store_dwordx2 v[36:37], v15, s[32:35], s47 offen
join_46:
    s_waitcnt vmcnt(5)
    s_barrier
    ds_read_b128 a[0:3], v38 offset:0
    ds_read_b128 a[4:7], v38 offset:1024
    ds_read_b128 a[8:11], v38 offset:2048
    ds_read_b128 a[12:15], v38 offset:3072
    ds_read_b128 a[16:19], v39 offset:16384
    ds_read_b128 a[20:23], v38 offset:4096
    ds_read_b128 a[24:27], v38 offset:5120
    ds_read_b128 a[28:31], v38 offset:6144
    ds_read_b128 a[32:35], v38 offset:7168
    ds_read_b128 a[36:39], v38 offset:8192
    ds_read_b128 a[40:43], v38 offset:9216
    ds_read_b128 a[44:47], v38 offset:10240
    ds_read_b128 a[48:51], v38 offset:11264
    ds_read_b128 a[52:55], v39 offset:17408
    ds_read_b128 a[56:59], v38 offset:12288
    ds_read_b128 a[60:63], v38 offset:13312
    ds_read_b128 a[64:67], v38 offset:14336
    ds_read_b128 a[68:71], v38 offset:15360
    ds_read_b128 a[72:75], v38 offset:16384
    ds_read_b128 a[76:79], v38 offset:17408
    s_cmp_eq_u32 s41, 0
    s_cbranch_scc1 slow_47
    s_waitcnt vmcnt(0)
    buffer_store_dword v24, v23, s[32:35], s50 offen
join_48:
L_mark2:
    ds_read_b128 a[80:83], v38 offset:18432
    s_mul_i32 s67, s38, 9216
    s_add_u32 s66, s67, s75
    s_add_u32 m0, s67, 100352
    s_add_u32 s66, s66, 25370624
    buffer_load_dwordx4 v1, s[32:35], s66 offen lds
    ds_read_b128 a[84:87], v38 offset:19456
    ds_read_b128 a[88:91], v39 offset:18432
    ds_read_b128 a[92:95], v38 offset:20480
    ds_read_b128 a[96:99], v38 offset:21504
    ds_read_b128 a[100:103], v38 offset:22528
    buffer_load_dwordx4 v1, s[32:35], s66 offen offset:1024 lds
    ds_read_b128 a[104:107], v38 offset:23552
    ds_read_b128 a[108:111], v38 offset:24576
    ds_read_b128 a[112:115], v38 offset:25600
    ds_read_b128 a[116:119], v38 offset:26624
    ds_read_b128 a[120:123], v38 offset:27648
    buffer_load_dwordx4 v1, s[32:35], s66 offen offset:2048 lds
    ds_read_b128 a[124:127], v39 offset:19456
    ds_read_b128 a[128:131], v38 offset:28672
    ds_read_b128 a[132:135], v38 offset:29696
    ds_read_b128 a[136:139], v38 offset:30720
    ds_read_b128 a[140:143], v38 offset:31744
    buffer_load_dwordx4 v1, s[32:35], s66 offen offset:3072 lds
    ds_read_b128 a[196:199], v38 offset:32768
    ds_read_b128 a[200:203], v38 offset:33792
    ds_read_b128 a[204:207], v38 offset:34816
    ds_read_b128 a[208:211], v38 offset:35840
    s_add_u32 s57, s48, 4096
    s_add_u32 s58, s48, 8192
    s_add_u32 s59, s48, 12288
    s_add_u32 s60, s48, 16384
poll_49:
    buffer_load_dword v24, v17, s[32:35], 0 offen sc1
    s_sub_u32 s43, s43, 1
    s_cselect_b64 s[68:69], 0, -1
    s_max_i32 s43, s43, 0
    s_waitcnt vmcnt(0)
    v_cmp_ne_u32 vcc, s44, v24
    s_and_b64 vcc, vcc, s[68:69]
    s_cbranch_scc1 poll_49
    buffer_load_dwordx4 v[184:187], v1, s[32:35], s48 offen offset:0 sc1
    ds_read_b128 a[212:215], v39 offset:20480
    ds_read_b128 a[216:219], v38 offset:36864
    ds_read_b128 a[220:223], v38 offset:37888
    buffer_load_dwordx4 v[188:191], v1, s[32:35], s48 offen offset:1024 sc1
    ds_read_b128 a[224:227], v38 offset:38912
    ds_read_b128 a[228:231], v38 offset:39936
    ds_read_b128 a[232:235], v38 offset:40960
    buffer_load_dwordx4 v[192:195], v1, s[32:35], s48 offen offset:2048 sc1
    ds_read_b128 a[236:239], v38 offset:41984
    ds_read_b128 a[240:243], v38 offset:43008
    ds_read_b128 a[244:247], v38 offset:44032
    buffer_load_dwordx4 v[196:199], v1, s[32:35], s48 offen offset:3072 sc1
    ds_read_b128 v[68:71], v39 offset:21504
    ds_read_b128 v[72:75], v38 offset:45056
    ds_read_b128 v[76:79], v38 offset:46080
    buffer_load_dwordx4 v[200:203], v1, s[32:35], s57 offen offset:0 sc1
    ds_read_b128 v[80:83], v38 offset:47104
    ds_read_b128 v[84:87], v38 offset:48128
    ds_read_b128 v[88:91], v38 offset:49152
    buffer_load_dwordx4 v[204:207], v1, s[32:35], s57 offen offset:1024 sc1
    ds_read_b128 v[92:95], v38 offset:50176
    ds_read_b128 v[96:99], v38 offset:51200
    ds_read_b128 v[100:103], v38 offset:52224
    buffer_load_dwordx4 v[208:211], v1, s[32:35], s57 offen offset:2048 sc1
    ds_read_b128 v[104:107], v39 offset:22528
    ds_read_b128 v[108:111], v38 offset:53248
    s_waitcnt vmcnt(6) lgkmcnt(15)
    v_mfma_f32_16x16x32_bf16 v[44:47], a[0:3], v[184:187], v[44:47]
    buffer_load_dwordx4 v[212:215], v1, s[32:35], s57 offen offset:3072 sc1
    ds_read_b128 v[112:115], v38 offset:54272
    v_mfma_f32_16x16x32_bf16 v[48:51], a[4:7], v[184:187], v[48:51]
    v_mfma_f32_16x16x32_bf16 v[52:55], a[8:11], v[184:187], v[52:55]
    ds_read_b128 v[116:119], v38 offset:55296
    v_mfma_f32_16x16x32_bf16 v[56:59], a[12:15], v[184:187], v[56:59]
    v_mfma_f32_16x16x32_bf16 v[60:63], a[16:19], v[184:187], v[60:63]
    buffer_load_dwordx4 v[216:219], v1, s[32:35], s58 offen offset:0 sc1
    s_waitcnt vmcnt(7)
    v_mfma_f32_16x16x32_bf16 v[44:47], a[20:23], v[188:191], v[44:47]
    ds_read_b128 v[120:123], v38 offset:56320
    v_mfma_f32_16x16x32_bf16 v[48:51], a[24:27], v[188:191], v[48:51]
    v_mfma_f32_16x16x32_bf16 v[52:55], a[28:31], v[188:191], v[52:55]
    v_mfma_f32_16x16x32_bf16 v[56:59], a[32:35], v[188:191], v[56:59]
    buffer_load_dwordx4 v[220:223], v1, s[32:35], s58 offen offset:1024 sc1
    ds_read_b128 v[124:127], v39 offset:0
    v_mfma_f32_16x16x32_bf16 v[64:67], a[16:19], v[188:191], 0
    s_waitcnt vmcnt(7)
    v_mfma_f32_16x16x32_bf16 v[44:47], a[36:39], v[192:195], v[44:47]
    v_mfma_f32_16x16x32_bf16 v[48:51], a[40:43], v[192:195], v[48:51]
    ds_read_b128 v[128:131], v39 offset:1024
    v_mfma_f32_16x16x32_bf16 v[52:55], a[44:47], v[192:195], v[52:55]
    buffer_load_dwordx4 v[224:227], v1, s[32:35], s58 offen offset:2048 sc1
    v_mfma_f32_16x16x32_bf16 v[56:59], a[48:51], v[192:195], v[56:59]
    v_mfma_f32_16x16x32_bf16 v[60:63], a[52:55], v[192:195], v[60:63]
    ds_read_b128 v[132:135], v39 offset:2048
    s_waitcnt vmcnt(7)
    v_mfma_f32_16x16x32_bf16 v[44:47], a[56:59], v[196:199], v[44:47]
    v_mfma_f32_16x16x32_bf16 v[48:51], a[60:63], v[196:199], v[48:51]
    buffer_load_dwordx4 v[228:231], v1, s[32:35], s58 offen offset:3072 sc1
    v_mfma_f32_16x16x32_bf16 v[52:55], a[64:67], v[196:199], v[52:55]
    ds_read_b128 v[136:139], v39 offset:3072
    v_mfma_f32_16x16x32_bf16 v[56:59], a[68:71], v[196:199], v[56:59]
    v_mfma_f32_16x16x32_bf16 v[64:67], a[52:55], v[196:199], v[64:67]
    s_waitcnt vmcnt(7)
    v_mfma_f32_16x16x32_bf16 v[44:47], a[72:75], v[200:203], v[44:47]
    buffer_load_dwordx4 v[232:235], v1, s[32:35], s59 offen offset:0 sc1
    ds_read_b128 v[140:143], v39 offset:23552
    v_mfma_f32_16x16x32_bf16 v[48:51], a[76:79], v[200:203], v[48:51]
    v_mfma_f32_16x16x32_bf16 v[52:55], a[80:83], v[200:203], v[52:55]
    v_mfma_f32_16x16x32_bf16 v[56:59], a[84:87], v[200:203], v[56:59]
    ds_read_b128 v[144:147], v39 offset:4096
    v_mfma_f32_16x16x32_bf16 v[60:63], a[88:91], v[200:203], v[60:63]
    buffer_load_dwordx4 v[236:239], v1, s[32:35], s59 offen offset:1024 sc1
    s_waitcnt vmcnt(8)
    v_mfma_f32_16x16x32_bf16 v[44:47], a[92:95], v[204:207], v[44:47]
    v_mfma_f32_16x16x32_bf16 v[48:51], a[96:99], v[204:207], v[48:51]
    ds_read_b128 v[148:151], v39 offset:5120
    v_mfma_f32_16x16x32_bf16 v[52:55], a[100:103], v[204:207], v[52:55]
    v_mfma_f32_16x16x32_bf16 v[56:59], a[104:107], v[204:207], v[56:59]
    buffer_load_dwordx4 v[240:243], v1, s[32:35], s59 offen offset:2048 sc1
    v_mfma_f32_16x16x32_bf16 v[64:67], a[88:91], v[204:207], v[64:67]
    ds_read_b128 v[152:155], v39 offset:6144
    s_waitcnt vmcnt(8)
    v_mfma_f32_16x16x32_bf16 v[44:47], a[108:111], v[208:211], v[44:47]
    v_mfma_f32_16x16x32_bf16 v[48:51], a[112:115], v[208:211], v[48:51]
    v_mfma_f32_16x16x32_bf16 v[52:55], a[116:119], v[208:211], v[52:55]
    buffer_load_dwordx4 v[244:247], v1, s[32:35], s59 offen offset:3072 sc1
    ds_read_b128 v[156:159], v39 offset:7168
    v_mfma_f32_16x16x32_bf16 v[56:59], a[120:123], v[208:211], v[56:59]
    v_mfma_f32_16x16x32_bf16 v[60:63], a[124:127], v[208:211], v[60:63]
    s_waitcnt vmcnt(8)
    v_mfma_f32_16x16x32_bf16 v[44:47], a[128:131], v[212:215], v[44:47]
    ds_read_b128 v[160:163], v39 offset:8192
    v_mfma_f32_16x16x32_bf16 v[48:51], a[132:135], v[212:215], v[48:51]
    buffer_load_dwordx4 v[248:251], v1, s[32:35], s60 offen offset:0 sc1
    v_mfma_f32_16x16x32_bf16 v[52:55], a[136:139], v[212:215], v[52:55]
    v_mfma_f32_16x16x32_bf16 v[56:59], a[140:143], v[212:215], v[56:59]
    ds_read_b128 v[164:167], v39 offset:9216
    v_mfma_f32_16x16x32_bf16 v[64:67], a[124:127], v[212:215], v[64:67]
    s_waitcnt vmcnt(8)
    v_mfma_f32_16x16x32_bf16 v[44:47], a[196:199], v[216:219], v[44:47]
    buffer_load_dwordx4 v[252:255], v1, s[32:35], s60 offen offset:1024 sc1
    s_add_u32 s47, s47, s3
    v_mfma_f32_16x16x32_bf16 v[48:51], a[200:203], v[216:219], v[48:51]
    ds_read_b128 v[168:171], v39 offset:10240
    v_mfma_f32_16x16x32_bf16 v[52:55], a[204:207], v[216:219], v[52:55]
    s_add_u32 s44, s44, 1
    v_mfma_f32_16x16x32_bf16 v[56:59], a[208:211], v[216:219], v[56:59]
    v_mfma_f32_16x16x32_bf16 v[60:63], a[212:215], v[216:219], v[60:63]
    ds_read_b128 v[172:175], v39 offset:11264
    s_mul_i32 s67, s38, 9216
    s_add_u32 s66, s67, s75
    s_add_u32 m0, s67, 104448
    s_add_u32 s66, s66, 25374720
    buffer_load_dwordx4 v1, s[32:35], s66 offen lds
    s_waitcnt vmcnt(9)
    v_mfma_f32_16x16x32_bf16 v[44:47], a[216:219], v[220:223], v[44:47]
    s_cmp_eq_u32 s41, 0
    s_cselect_b32 s61, s46, s54
    v_mfma_f32_16x16x32_bf16 v[48:51], a[220:223], v[220:223], v[48:51]
    v_mfma_f32_16x16x32_bf16 v[52:55], a[224:227], v[220:223], v[52:55]
    ds_read_b128 v[176:179], v39 offset:24576
    v_mfma_f32_16x16x32_bf16 v[56:59], a[228:231], v[220:223], v[56:59]
    s_lshl_b32 s56, s39, 11
    s_add_u32 s56, s56, s61
    v_mfma_f32_16x16x32_bf16 v[64:67], a[212:215], v[220:223], v[64:67]
    buffer_load_dwordx4 v1, s[32:35], s66 offen offset:1024 lds
    s_waitcnt vmcnt(9) lgkmcnt(15)
    v_mfma_f32_16x16x32_bf16 v[44:47], a[232:235], v[224:227], v[44:47]
    ds_read_b128 v[180:183], v39 offset:12288
    s_mov_b32 s82, 0x22222222
    v_mfma_f32_16x16x32_bf16 v[48:51], a[236:239], v[224:227], v[48:51]
    s_mov_b32 s83, 0x22222222
    v_mfma_f32_16x16x32_bf16 v[52:55], a[240:243], v[224:227], v[52:55]
    v_mfma_f32_16x16x32_bf16 v[56:59], a[244:247], v[224:227], v[56:59]
    ds_read_b128 a[0:3], v39 offset:13312
    v_mfma_f32_16x16x32_bf16 v[60:63], v[68:71], v[224:227], v[60:63]
    buffer_load_dwordx4 v1, s[32:35], s66 offen offset:2048 lds
    s_waitcnt vmcnt(9)
    v_mfma_f32_16x16x32_bf16 v[44:47], v[72:75], v[228:231], v[44:47]
    s_mov_b32 s84, 0x44444444
    v_mfma_f32_16x16x32_bf16 v[48:51], v[76:79], v[228:231], v[48:51]
    ds_read_b128 a[4:7], v39 offset:14336
    s_mov_b32 s85, 0x44444444
    v_mfma_f32_16x16x32_bf16 v[52:55], v[80:83], v[228:231], v[52:55]
    v_mfma_f32_16x16x32_bf16 v[56:59], v[84:87], v[228:231], v[56:59]
    s_mov_b32 s86, 0x88888888
    v_mfma_f32_16x16x32_bf16 v[64:67], v[68:71], v[228:231], v[64:67]
    ds_read_b128 a[8:11], v39 offset:15360
    buffer_load_dwordx4 v1, s[32:35], s66 offen offset:3072 lds
    s_waitcnt vmcnt(9)
    v_mfma_f32_16x16x32_bf16 v[44:47], v[88:91], v[232:235], v[44:47]
    v_mfma_f32_16x16x32_bf16 v[48:51], v[92:95], v[232:235], v[48:51]
    s_mov_b32 s87, 0x88888888
    v_mfma_f32_16x16x32_bf16 v[52:55], v[96:99], v[232:235], v[52:55]
    v_mfma_f32_16x16x32_bf16 v[56:59], v[100:103], v[232:235], v[56:59]
    s_mul_i32 s63, s38, 8192
    s_min_u32 s63, s63, 22528
    s_add_u32 s63, s63, 0
    v_mfma_f32_16x16x32_bf16 v[60:63], v[104:107], v[232:235], v[60:63]
    s_add_u32 m0, s67, 108544
    s_add_u32 s66, s66, 4096
    buffer_load_dwordx4 v1, s[32:35], s66 offen lds
    s_waitcnt vmcnt(9) lgkmcnt(15)
    v_mfma_f32_16x16x32_bf16 v[44:47], v[108:111], v[236:239], v[44:47]
    v_add_u32 v40, s63, v1
    v_mfma_f32_16x16x32_bf16 v[48:51], v[112:115], v[236:239], v[48:51]
    v_mfma_f32_16x16x32_bf16 v[52:55], v[116:119], v[236:239], v[52:55]
    v_mfma_f32_16x16x32_bf16 v[56:59], v[120:123], v[236:239], v[56:59]
    v_mfma_f32_16x16x32_bf16 v[64:67], v[104:107], v[236:239], v[64:67]
    s_waitcnt vmcnt(5)
    s_waitcnt lgkmcnt(0)
    s_cmp_eq_u32 s41, 0
    s_cbranch_scc1 slow_50
    v_mfma_f32_16x16x32_bf16 v[60:63], v[140:143], v[240:243], v[60:63]
    v_mfma_f32_16x16x32_bf16 v[64:67], v[140:143], v[244:247], v[64:67]
    v_mfma_f32_16x16x32_bf16 v[60:63], v[176:179], v[248:251], v[60:63]
    v_mfma_f32_16x16x32_bf16 v[64:67], v[176:179], v[252:255], v[64:67]
    v_mov_b32 v194, 0
    v_mov_b32 v195, 0
    v_mfma_f32_16x16x32_bf16 v[44:47], v[124:127], v[240:243], v[44:47]
    v_mov_b32 v196, s74
    v_mov_b32 v197, s74
    v_mfma_f32_16x16x32_bf16 v[44:47], v[144:147], v[244:247], v[44:47]
    v_mov_b32 v198, s74
    v_mov_b32 v199, s74
    v_mfma_f32_16x16x32_bf16 v[44:47], v[160:163], v[248:251], v[44:47]
    v_permlane32_swap_b32 v64, v68
    v_permlane32_swap_b32 v65, v69
    v_mfma_f32_16x16x32_bf16 v[44:47], v[180:183], v[252:255], v[44:47]
    v_permlane32_swap_b32 v66, v70
    v_permlane32_swap_b32 v67, v71
    v_mfma_f32_16x16x32_bf16 v[48:51], v[128:131], v[240:243], v[48:51]
    v_add_f32 v60, v60, v68
    v_mfma_f32_16x16x32_bf16 v[48:51], v[148:151], v[244:247], v[48:51]
    v_add_f32 v61, v61, v69
    v_add_f32 v62, v62, v70
    v_mfma_f32_16x16x32_bf16 v[48:51], v[164:167], v[248:251], v[48:51]
    v_add_f32 v63, v63, v71
    v_cvt_pk_bf16_f32 v192, v60, v61
    v_mfma_f32_16x16x32_bf16 v[48:51], a[0:3], v[252:255], v[48:51]
    v_cvt_pk_bf16_f32 v193, v62, v63
    v_mfma_f32_16x16x32_bf16 v[52:55], v[132:135], v[240:243], v[52:55]
    v_cndmask_b32 v192, 0, v192, s[70:71]
    v_cndmask_b32 v193, 0, v193, s[70:71]
    v_mfma_f32_16x16x32_bf16 v[52:55], v[152:155], v[244:247], v[52:55]
    buffer_store_dwordx2 v[192:193], v12, s[4:7], s61 offen
    v_cvt_pk_bf16_f32 v184, v44, v45
    v_mfma_f32_16x16x32_bf16 v[52:55], v[168:171], v[248:251], v[52:55]
    v_cvt_pk_bf16_f32 v185, v46, v47
    v_mfma_f32_16x16x32_bf16 v[52:55], a[4:7], v[252:255], v[52:55]
    v_cvt_pk_bf16_f32 v186, v48, v49
    v_mfma_f32_16x16x32_bf16 v[56:59], v[136:139], v[240:243], v[56:59]
    v_cvt_pk_bf16_f32 v187, v50, v51
    v_mfma_f32_16x16x32_bf16 v[56:59], v[156:159], v[244:247], v[56:59]
    buffer_store_dwordx4 v[184:187], v1, s[4:7], s56 offen offset:0
    v_mfma_f32_16x16x32_bf16 v[56:59], v[172:175], v[248:251], v[56:59]
    s_nop 1
    v_mfma_f32_16x16x32_bf16 v[56:59], a[8:11], v[252:255], v[56:59]
    v_cvt_pk_bf16_f32 v188, v52, v53
    v_mfma_f32_16x16x32_bf16 v[204:207], v[192:195], v[192:195], 0
    v_cvt_pk_bf16_f32 v189, v54, v55
    v_mfma_f32_16x16x32_bf16 v[200:203], v[196:199], v[192:195], 0
    s_nop 1
    v_mfma_f32_16x16x32_bf16 v[204:207], v[184:187], v[184:187], v[204:207]
    s_nop 1
    v_mfma_f32_16x16x32_bf16 v[200:203], v[196:199], v[184:187], v[200:203]
    v_cvt_pk_bf16_f32 v190, v56, v57
    v_cvt_pk_bf16_f32 v191, v58, v59
    s_nop 1
    v_mfma_f32_16x16x32_bf16 v[204:207], v[188:191], v[188:191], v[204:207]
    buffer_store_dwordx4 v[188:191], v1, s[4:7], s56 offen offset:1024
    v_mfma_f32_16x16x32_bf16 v[200:203], v[196:199], v[188:191], v[200:203]
    v_mov_b32 v26, s44
    s_nop 4
    v_cndmask_b32 v204, v204, v205, s[82:83]
    v_cndmask_b32 v204, v204, v206, s[84:85]
    v_cndmask_b32 v201, v204, v207, s[86:87]
    buffer_store_dwordx2 v[200:201], v13, s[32:35], s46 offen
    s_barrier
    ds_write_b128 v40, a[144:147] offset:0
    ds_write_b128 v40, a[148:151] offset:1024
    ds_write_b128 v40, a[152:155] offset:2048
    s_waitcnt vmcnt(0)
    buffer_store_dword v26, v23, s[32:35], s49 offen
join_51:
    s_add_u32 s46, s46, s3
    s_add_u32 s48, s48, s3
    ds_write_b128 v40, a[156:159] offset:3072
    ds_write_b128 v40, a[160:163] offset:4096
    ds_write_b128 v40, a[164:167] offset:5120
    ds_write_b128 v40, a[168:171] offset:6144
    ds_write_b128 v40, a[172:175] offset:7168
    v_add_u32 v128, 100352, v1
    v_add_u32 v136, 63488, v1
    v_and_b32 v130, 15, v0
    v_min_u32 v130, 11, v130
    v_lshrrev_b32 v131, 4, v0
    v_mul_u32_u24 v131, 192, v131
    v_lshl_add_u32 v130, v130, 4, v131
    v_add_u32 v131, 100352, v130
    s_cmp_eq_u32 s41, 0
    s_cselect_b32 s94, s45, s94
    s_cselect_b32 s56, 1024, 0
    s_add_u32 s56, s56, 18432
    v_add_u32 v138, s56, v1
    s_add_u32 s57, s94, 4096
    s_add_u32 s58, s94, 8192
    s_add_u32 s59, s94, 12288
    s_add_u32 s60, s94, 16384
    s_add_u32 s86, s45, 18432
    s_add_u32 s87, s45, 37888
poll_52:
    buffer_load_dword v24, v16, s[32:35], 0 offen sc1
    s_sub_u32 s43, s43, 1
    s_cselect_b64 s[68:69], 0, -1
    s_max_i32 s43, s43, 0
    s_waitcnt vmcnt(0)
    v_cmp_ne_u32 vcc, s44, v24
    s_and_b64 vcc, vcc, s[68:69]
    s_cbranch_scc1 poll_52
    buffer_load_dwordx4 a[0:3], v1, s[4:7], s94 offen offset:0 sc1
    buffer_load_dwordx4 a[72:75], v138, s[4:7], s94 offen offset:0 sc1
    s_waitcnt lgkmcnt(0)
    s_barrier
    buffer_load_dwordx4 a[4:7], v1, s[4:7], s94 offen offset:1024 sc1
    ds_read_b128 a[196:199], v128 offset:768
    ds_read_b128 a[200:203], v128 offset:1792
    ds_read_b128 a[204:207], v128 offset:2816
    buffer_load_dwordx4 a[76:79], v138, s[4:7], s94 offen offset:1024 sc1
    ds_read_b128 a[208:211], v128 offset:3840
    ds_read_b128 a[212:215], v131 offset:0
    buffer_load_dwordx4 a[8:11], v1, s[4:7], s94 offen offset:2048 sc1
    ds_read_b128 a[216:219], v128 offset:5632
    ds_read_b128 a[220:223], v128 offset:6656
    ds_read_b128 a[224:227], v128 offset:7680
    buffer_load_dwordx4 a[80:83], v138, s[4:7], s94 offen offset:2048 sc1
    ds_read_b128 a[228:231], v128 offset:8704
    ds_read_b128 a[232:235], v131 offset:4864
    s_waitcnt vmcnt(4) lgkmcnt(5)
    v_mfma_f32_16x16x32_bf16 v[64:67], a[196:199], a[0:3], 0
    ds_read_b128 a[236:239], v128 offset:10496
    buffer_load_dwordx4 a[12:15], v1, s[4:7], s94 offen offset:3072 sc1
    v_mfma_f32_16x16x32_bf16 v[68:71], a[196:199], a[72:75], 0
    v_and_b32 v24, 48, v0
    v_add_u32 v24, 160256, v24
    v_mfma_f32_16x16x32_bf16 v[72:75], a[200:203], a[0:3], 0
    ds_read_b128 a[240:243], v128 offset:11520
    v_mfma_f32_16x16x32_bf16 v[76:79], a[200:203], a[72:75], 0
    buffer_load_dwordx4 a[84:87], v138, s[4:7], s94 offen offset:3072 sc1
    s_mov_b32 vcc_lo, 0xffff0000
    v_mfma_f32_16x16x32_bf16 v[80:83], a[204:207], a[0:3], 0
    ds_read_b128 a[244:247], v128 offset:12544
    s_mov_b32 vcc_hi, 0
    v_mfma_f32_16x16x32_bf16 v[84:87], a[204:207], a[72:75], 0
    v_mfma_f32_16x16x32_bf16 v[88:91], a[208:211], a[0:3], 0
    ds_read_b128 a[196:199], v128 offset:13568
    v_mov_b32 v26, 0x3eae1a93
    v_mfma_f32_16x16x32_bf16 v[92:95], a[208:211], a[72:75], 0
    buffer_load_dwordx4 a[16:19], v1, s[4:7], s57 offen offset:0 sc1
    v_cndmask_b32 v26, 1.0, v26, vcc
    v_mfma_f32_16x16x32_bf16 v[96:99], a[212:215], a[0:3], 0
    ds_read_b128 a[200:203], v131 offset:9728
    v_mfma_f32_16x16x32_bf16 v[100:103], a[212:215], a[72:75], 0
    ds_read_b128 v[176:179], v24 offset:0
    s_waitcnt vmcnt(5) lgkmcnt(6)
    v_mfma_f32_16x16x32_bf16 v[64:67], a[216:219], a[4:7], v[64:67]
    ds_read_b128 a[204:207], v128 offset:15360
    ds_read_b128 v[180:183], v24 offset:64
    v_mfma_f32_16x16x32_bf16 v[68:71], a[216:219], a[76:79], v[68:71]
    buffer_load_dwordx4 a[88:91], v138, s[4:7], s57 offen offset:0 sc1
    v_mfma_f32_16x16x32_bf16 v[72:75], a[220:223], a[4:7], v[72:75]
    ds_read_b128 a[208:211], v128 offset:16384
    ds_read_b128 v[184:187], v24 offset:128
    v_mfma_f32_16x16x32_bf16 v[76:79], a[220:223], a[76:79], v[76:79]
    ds_read_b128 v[188:191], v24 offset:192
    v_mfma_f32_16x16x32_bf16 v[80:83], a[224:227], a[4:7], v[80:83]
    ds_read_b128 a[212:215], v128 offset:17408
    v_mfma_f32_16x16x32_bf16 v[84:87], a[224:227], a[76:79], v[84:87]
    buffer_load_dwordx4 a[20:23], v1, s[4:7], s57 offen offset:1024 sc1
    ds_read_b128 v[192:195], v24 offset:256
    v_mfma_f32_16x16x32_bf16 v[88:91], a[228:231], a[4:7], v[88:91]
    ds_read_b128 a[216:219], v128 offset:18432
    v_lshrrev_b32 v35, 5, v0
    v_mfma_f32_16x16x32_bf16 v[92:95], a[228:231], a[76:79], v[92:95]
    v_mfma_f32_16x16x32_bf16 v[96:99], a[232:235], a[4:7], v[96:99]
    ds_read_b128 a[220:223], v131 offset:14592
    v_mul_u32_u24 v35, 36, v35
    v_mfma_f32_16x16x32_bf16 v[100:103], a[232:235], a[76:79], v[100:103]
    buffer_load_dwordx4 a[92:95], v138, s[4:7], s57 offen offset:1024 sc1
    s_waitcnt vmcnt(6) lgkmcnt(10)
    v_mfma_f32_16x16x32_bf16 v[64:67], a[236:239], a[8:11], v[64:67]
    ds_read_b128 a[224:227], v128 offset:20224
    v_sub_u32 v34, v0, v35
    v_mfma_f32_16x16x32_bf16 v[68:71], a[236:239], a[80:83], v[68:71]
    v_cvt_f32_i32 v34, v34
    v_mfma_f32_16x16x32_bf16 v[72:75], a[240:243], a[8:11], v[72:75]
    ds_read_b128 a[228:231], v128 offset:21248
    v_mul_f32 v34, 0x7249f2ca, v34
    v_mfma_f32_16x16x32_bf16 v[76:79], a[240:243], a[80:83], v[76:79]
    buffer_load_dwordx4 a[24:27], v1, s[4:7], s57 offen offset:2048 sc1
    v_mfma_f32_16x16x32_bf16 v[80:83], a[244:247], a[8:11], v[80:83]
    ds_read_b128 a[232:235], v128 offset:22272
    v_mov_b32 v35, 0xf149f2ca
    v_mfma_f32_16x16x32_bf16 v[84:87], a[244:247], a[80:83], v[84:87]
L_hop8:
    s_cbranch_execz L_hopback
    v_mfma_f32_16x16x32_bf16 v[88:91], a[196:199], a[8:11], v[88:91]
    ds_read_b128 a[236:239], v128 offset:23296
    v_add_f32 v160, 0x7149f2ca, v34
    v_mfma_f32_16x16x32_bf16 v[92:95], a[196:199], a[80:83], v[92:95]
    buffer_load_dwordx4 a[96:99], v138, s[4:7], s57 offen offset:2048 sc1
    v_med3_f32 v160, v160, v35, 0
    v_mfma_f32_16x16x32_bf16 v[96:99], a[200:203], a[8:11], v[96:99]
    ds_read_b128 a[240:243], v131 offset:19456
    v_mfma_f32_16x16x32_bf16 v[100:103], a[200:203], a[80:83], v[100:103]
    v_add_f32 v161, 0xf2177617, v34
    s_waitcnt vmcnt(6) lgkmcnt(5)
    v_mfma_f32_16x16x32_bf16 v[64:67], a[204:207], a[12:15], v[64:67]
    ds_read_b128 a[244:247], v128 offset:25088
    v_med3_f32 v161, v161, v35, 0
    v_mfma_f32_16x16x32_bf16 v[68:71], a[204:207], a[84:87], v[68:71]
    buffer_load_dwordx4 a[28:31], v1, s[4:7], s57 offen offset:3072 sc1
    v_mfma_f32_16x16x32_bf16 v[72:75], a[208:211], a[12:15], v[72:75]
    ds_read_b128 a[196:199], v128 offset:26112
    v_add_f32 v162, 0xf2b0b471, v34
    v_mfma_f32_16x16x32_bf16 v[76:79], a[208:211], a[84:87], v[76:79]
    v_med3_f32 v162, v162, v35, 0
    v_mfma_f32_16x16x32_bf16 v[80:83], a[212:215], a[12:15], v[80:83]
    ds_read_b128 a[200:203], v128 offset:27136
    v_mfma_f32_16x16x32_bf16 v[84:87], a[212:215], a[84:87], v[84:87]
    buffer_load_dwordx4 a[100:103], v138, s[4:7], s57 offen offset:3072 sc1
    v_add_f32 v163, 0xf30ad6eb, v34
    v_mfma_f32_16x16x32_bf16 v[88:91], a[216:219], a[12:15], v[88:91]
    ds_read_b128 a[204:207], v128 offset:28160
    v_med3_f32 v163, v163, v35, 0
    v_mfma_f32_16x16x32_bf16 v[92:95], a[216:219], a[84:87], v[92:95]
    v_mfma_f32_16x16x32_bf16 v[96:99], a[220:223], a[12:15], v[96:99]
    ds_read_b128 a[208:211], v131 offset:24320
    v_add_f32 v164, 0xf3c3a333, v34
    v_mfma_f32_16x16x32_bf16 v[100:103], a[220:223], a[84:87], v[100:103]
    buffer_load_dwordx4 a[32:35], v1, s[4:7], s58 offen offset:0 sc1
    s_waitcnt vmcnt(7) lgkmcnt(5)
    v_mfma_f32_16x16x32_bf16 v[64:67], a[224:227], a[16:19], v[64:67]
    ds_read_b128 a[212:215], v128 offset:29952
    v_med3_f32 v164, v164, v35, 0
    v_mfma_f32_16x16x32_bf16 v[68:71], a[224:227], a[88:91], v[68:71]
    v_add_f32 v165, 0xf3dce18d, v34
    v_mfma_f32_16x16x32_bf16 v[72:75], a[228:231], a[16:19], v[72:75]
    ds_read_b128 a[216:219], v128 offset:30976
    buffer_load_dwordx4 a[104:107], v138, s[4:7], s58 offen offset:0 sc1
    v_mfma_f32_16x16x32_bf16 v[76:79], a[228:231], a[88:91], v[76:79]
    v_med3_f32 v165, v165, v35, 0
    v_mfma_f32_16x16x32_bf16 v[80:83], a[232:235], a[16:19], v[80:83]
    ds_read_b128 a[220:223], v128 offset:32000
    v_add_f32 v166, 0xf3f61fe6, v34
    v_mfma_f32_16x16x32_bf16 v[84:87], a[232:235], a[88:91], v[84:87]
    v_med3_f32 v166, v166, v35, 0
    v_mfma_f32_16x16x32_bf16 v[88:91], a[236:239], a[16:19], v[88:91]
    ds_read_b128 a[224:227], v128 offset:33024
    buffer_load_dwordx4 v[140:143], v1, s[32:35], s86 offen sc1
    v_mfma_f32_16x16x32_bf16 v[92:95], a[236:239], a[88:91], v[92:95]
    v_add_f32 v167, 0xf407af20, v34
    v_mfma_f32_16x16x32_bf16 v[96:99], a[240:243], a[16:19], v[96:99]
    ds_read_b128 a[228:231], v131 offset:29184
    v_med3_f32 v167, v167, v35, 0
    v_mfma_f32_16x16x32_bf16 v[100:103], a[240:243], a[88:91], v[100:103]
    s_waitcnt vmcnt(7) lgkmcnt(5)
    v_mfma_f32_16x16x32_bf16 v[64:67], a[244:247], a[20:23], v[64:67]
    ds_read_b128 a[232:235], v128 offset:34816
    buffer_load_dwordx4 v[144:147], v1, s[32:35], s87 offen sc1
    v_mfma_f32_16x16x32_bf16 v[68:71], a[244:247], a[92:95], v[68:71]
    v_add_f32 v168, 0xf446caff, v34
    v_mfma_f32_16x16x32_bf16 v[72:75], a[196:199], a[20:23], v[72:75]
    ds_read_b128 a[236:239], v128 offset:35840
    v_med3_f32 v168, v168, v35, 0
    v_mfma_f32_16x16x32_bf16 v[76:79], a[196:199], a[92:95], v[76:79]
    v_add_f32 v169, 0xf4536a2b, v34
    v_mfma_f32_16x16x32_bf16 v[80:83], a[200:203], a[20:23], v[80:83]
    ds_read_b128 a[240:243], v128 offset:36864
    buffer_load_dwordx4 a[36:39], v1, s[4:7], s58 offen offset:1024 sc1
    v_mfma_f32_16x16x32_bf16 v[84:87], a[200:203], a[92:95], v[84:87]
    v_med3_f32 v169, v169, v35, 0
    v_mfma_f32_16x16x32_bf16 v[88:91], a[204:207], a[20:23], v[88:91]
    ds_read_b128 a[244:247], v128 offset:37888
    v_add_f32 v170, 0xf4600958, v34
    v_mfma_f32_16x16x32_bf16 v[92:95], a[204:207], a[92:95], v[92:95]
    v_mfma_f32_16x16x32_bf16 v[96:99], a[208:211], a[20:23], v[96:99]
    ds_read_b128 a[196:199], v131 offset:34048
    buffer_load_dwordx4 a[108:111], v138, s[4:7], s58 offen offset:1024 sc1
    v_mfma_f32_16x16x32_bf16 v[100:103], a[208:211], a[92:95], v[100:103]
    v_med3_f32 v170, v170, v35, 0
    s_waitcnt vmcnt(8) lgkmcnt(5)
    v_mfma_f32_16x16x32_bf16 v[64:67], a[212:215], a[24:27], v[64:67]
    ds_read_b128 a[200:203], v128 offset:39680
    v_add_f32 v171, 0xf46ca884, v34
    v_mfma_f32_16x16x32_bf16 v[68:71], a[212:215], a[96:99], v[68:71]
    v_med3_f32 v171, v171, v35, 0
    v_mfma_f32_16x16x32_bf16 v[72:75], a[216:219], a[24:27], v[72:75]
    ds_read_b128 a[204:207], v128 offset:40704
    buffer_load_dwordx4 a[40:43], v1, s[4:7], s58 offen offset:2048 sc1
    v_mfma_f32_16x16x32_bf16 v[76:79], a[216:219], a[96:99], v[76:79]
    v_add_f32 v172, 0xf495e232, v34
    v_mfma_f32_16x16x32_bf16 v[80:83], a[220:223], a[24:27], v[80:83]
    ds_read_b128 a[208:211], v128 offset:41728
    v_med3_f32 v172, v172, v35, 0
    v_mfma_f32_16x16x32_bf16 v[84:87], a[220:223], a[96:99], v[84:87]
    v_add_f32 v173, 0xf49c31c8, v34
    v_mfma_f32_16x16x32_bf16 v[88:91], a[224:227], a[24:27], v[88:91]
    ds_read_b128 a[212:215], v128 offset:42752
    buffer_load_dwordx4 a[112:115], v138, s[4:7], s58 offen offset:2048 sc1
    v_mfma_f32_16x16x32_bf16 v[92:95], a[224:227], a[96:99], v[92:95]
    v_med3_f32 v173, v173, v35, 0
    v_mfma_f32_16x16x32_bf16 v[96:99], a[228:231], a[24:27], v[96:99]
    ds_read_b128 a[216:219], v131 offset:38912
    v_add_f32 v174, 0xf4a2815e, v34
    v_mfma_f32_16x16x32_bf16 v[100:103], a[228:231], a[96:99], v[100:103]
    s_waitcnt vmcnt(8) lgkmcnt(5)
    v_mfma_f32_16x16x32_bf16 v[64:67], a[232:235], a[28:31], v[64:67]
    ds_read_b128 a[220:223], v128 offset:44544
    buffer_load_dwordx4 a[44:47], v1, s[4:7], s58 offen offset:3072 sc1
    v_mfma_f32_16x16x32_bf16 v[68:71], a[232:235], a[100:103], v[68:71]
    v_med3_f32 v174, v174, v35, 0
    v_add_f32 v175, 0xf4a8d0f5, v34
    v_mfma_f32_16x16x32_bf16 v[72:75], a[236:239], a[28:31], v[72:75]
    ds_read_b128 a[224:227], v128 offset:45568
    v_mfma_f32_16x16x32_bf16 v[76:79], a[236:239], a[100:103], v[76:79]
    v_med3_f32 v175, v175, v35, 0
    v_mfma_f32_16x16x32_bf16 v[80:83], a[240:243], a[28:31], v[80:83]
    ds_read_b128 a[228:231], v128 offset:46592
    buffer_load_dwordx4 a[116:119], v138, s[4:7], s58 offen offset:3072 sc1
    v_mfma_f32_16x16x32_bf16 v[84:87], a[240:243], a[100:103], v[84:87]
    v_mfma_f32_16x16x32_bf16 v[88:91], a[244:247], a[28:31], v[88:91]
    ds_read_b128 a[232:235], v128 offset:47616
    v_mfma_f32_16x16x32_bf16 v[92:95], a[244:247], a[100:103], v[92:95]
    v_mfma_f32_16x16x32_bf16 v[96:99], a[196:199], a[28:31], v[96:99]
    ds_read_b128 a[236:239], v131 offset:43776
    buffer_load_dwordx4 a[48:51], v1, s[4:7], s59 offen offset:0 sc1
    v_mfma_f32_16x16x32_bf16 v[100:103], a[196:199], a[100:103], v[100:103]
    s_waitcnt vmcnt(9) lgkmcnt(5)
    v_mfma_f32_16x16x32_bf16 v[64:67], a[200:203], a[32:35], v[64:67]
    ds_read_b128 a[240:243], v128 offset:49408
    v_mfma_f32_16x16x32_bf16 v[68:71], a[200:203], a[104:107], v[68:71]
    v_mfma_f32_16x16x32_bf16 v[72:75], a[204:207], a[32:35], v[72:75]
    ds_read_b128 a[244:247], v128 offset:50432
    buffer_load_dwordx4 a[120:123], v138, s[4:7], s59 offen offset:0 sc1
    v_mfma_f32_16x16x32_bf16 v[76:79], a[204:207], a[104:107], v[76:79]
    s_waitcnt vmcnt(9)
    v_add_f32 v140, v140, v142
    v_add_f32 v141, v141, v143
    v_mfma_f32_16x16x32_bf16 v[80:83], a[208:211], a[32:35], v[80:83]
    ds_read_b128 a[196:199], v128 offset:51456
    v_mfma_f32_16x16x32_bf16 v[84:87], a[208:211], a[104:107], v[84:87]
    buffer_load_dwordx4 a[52:55], v1, s[4:7], s59 offen offset:1024 sc1
    s_waitcnt vmcnt(9)
    v_add_f32 v144, v144, v146
    v_mfma_f32_16x16x32_bf16 v[88:91], a[212:215], a[32:35], v[88:91]
    ds_read_b128 a[200:203], v128 offset:52480
    v_add_f32 v145, v145, v147
    v_mfma_f32_16x16x32_bf16 v[92:95], a[212:215], a[104:107], v[92:95]
    v_mfma_f32_16x16x32_bf16 v[96:99], a[216:219], a[32:35], v[96:99]
    ds_read_b128 a[204:207], v131 offset:48640
    v_permlane32_swap_b32 v140, v141
    v_mfma_f32_16x16x32_bf16 v[100:103], a[216:219], a[104:107], v[100:103]
    buffer_load_dwordx4 a[124:127], v138, s[4:7], s59 offen offset:1024 sc1
    s_waitcnt vmcnt(8) lgkmcnt(5)
    v_mfma_f32_16x16x32_bf16 v[64:67], a[220:223], a[36:39], v[64:67]
    ds_read_b128 a[208:211], v128 offset:54272
    v_permlane32_swap_b32 v144, v145
    v_mfma_f32_16x16x32_bf16 v[68:71], a[220:223], a[108:111], v[68:71]
    v_add_f32 v140, v140, v141
    v_mfma_f32_16x16x32_bf16 v[72:75], a[224:227], a[36:39], v[72:75]
    ds_read_b128 a[212:215], v128 offset:55296
    v_mfma_f32_16x16x32_bf16 v[76:79], a[224:227], a[108:111], v[76:79]
    buffer_load_dwordx4 a[56:59], v1, s[4:7], s59 offen offset:2048 sc1
    v_add_f32 v144, v144, v145
    v_mfma_f32_16x16x32_bf16 v[80:83], a[228:231], a[36:39], v[80:83]
    ds_read_b128 a[216:219], v128 offset:56320
    v_permlane16_swap_b32 v140, v144
    v_mfma_f32_16x16x32_bf16 v[84:87], a[228:231], a[108:111], v[84:87]
    v_mfma_f32_16x16x32_bf16 v[88:91], a[232:235], a[36:39], v[88:91]
    ds_read_b128 a[220:223], v1 offset:0
    v_add_f32 v140, v140, v144
    v_mfma_f32_16x16x32_bf16 v[92:95], a[232:235], a[108:111], v[92:95]
    buffer_load_dwordx4 a[128:131], v138, s[4:7], s59 offen offset:2048 sc1
    v_mul_f32 v140, 0x3ae38e39, v140
    v_mfma_f32_16x16x32_bf16 v[96:99], a[236:239], a[36:39], v[96:99]
    ds_read_b128 a[224:227], v131 offset:53504
    v_mfma_f32_16x16x32_bf16 v[100:103], a[236:239], a[108:111], v[100:103]
    v_mov_b32 v144, v140
    s_waitcnt vmcnt(8) lgkmcnt(5)
    v_mfma_f32_16x16x32_bf16 v[64:67], a[240:243], a[40:43], v[64:67]
    ds_read_b128 a[228:231], v1 offset:1792
    v_mfma_f32_16x16x32_bf16 v[68:71], a[240:243], a[112:115], v[68:71]
    buffer_load_dwordx4 a[60:63], v1, s[4:7], s59 offen offset:3072 sc1
    v_permlane32_swap_b32 v140, v144
    v_mfma_f32_16x16x32_bf16 v[72:75], a[244:247], a[40:43], v[72:75]
    ds_read_b128 a[232:235], v1 offset:2816
    v_fma_f32 v144, -v140, v140, v144
    v_mfma_f32_16x16x32_bf16 v[76:79], a[244:247], a[112:115], v[76:79]
    v_mfma_f32_16x16x32_bf16 v[80:83], a[196:199], a[40:43], v[80:83]
    ds_read_b128 a[236:239], v1 offset:3840
    v_max_f32 v144, 0, v144
    v_mfma_f32_16x16x32_bf16 v[84:87], a[196:199], a[112:115], v[84:87]
    buffer_load_dwordx4 a[132:135], v138, s[4:7], s59 offen offset:3072 sc1
    v_add_f32 v144, 0x3727c5ac, v144
    v_mfma_f32_16x16x32_bf16 v[88:91], a[200:203], a[40:43], v[88:91]
    ds_read_b128 a[240:243], v1 offset:4864
    v_mfma_f32_16x16x32_bf16 v[92:95], a[200:203], a[112:115], v[92:95]
    v_rsq_f32 v148, v144
    v_mfma_f32_16x16x32_bf16 v[96:99], a[204:207], a[40:43], v[96:99]
    ds_read_b128 a[244:247], v130 offset:1024
    v_mfma_f32_16x16x32_bf16 v[100:103], a[204:207], a[112:115], v[100:103]
    buffer_load_dwordx4 a[64:67], v1, s[4:7], s60 offen offset:0 sc1
    s_waitcnt vmcnt(9) lgkmcnt(5)
    v_mfma_f32_16x16x32_bf16 v[64:67], a[208:211], a[44:47], v[64:67]
    ds_read_b128 a[196:199], v1 offset:6656
    v_mul_f32 v150, -v140, v148
    v_mfma_f32_16x16x32_bf16 v[68:71], a[208:211], a[116:119], v[68:71]
    v_mov_b32 v149, v148
    v_mfma_f32_16x16x32_bf16 v[72:75], a[212:215], a[44:47], v[72:75]
    ds_read_b128 a[200:203], v1 offset:7680
    v_mov_b32 v151, v150
    v_mfma_f32_16x16x32_bf16 v[76:79], a[212:215], a[116:119], v[76:79]
    buffer_load_dwordx4 a[136:139], v138, s[4:7], s60 offen offset:0 sc1
    v_permlane16_swap_b32 v148, v149
    v_mfma_f32_16x16x32_bf16 v[80:83], a[216:219], a[44:47], v[80:83]
    ds_read_b128 a[204:207], v1 offset:8704
    v_mfma_f32_16x16x32_bf16 v[84:87], a[216:219], a[116:119], v[84:87]
    v_permlane16_swap_b32 v150, v151
    v_mfma_f32_16x16x32_bf16 v[88:91], a[220:223], a[44:47], v[88:91]
    ds_read_b128 a[208:211], v1 offset:9728
    v_mfma_f32_16x16x32_bf16 v[92:95], a[220:223], a[116:119], v[92:95]
    buffer_load_dwordx4 a[68:71], v1, s[4:7], s60 offen offset:1024 sc1
    v_mfma_f32_16x16x32_bf16 v[96:99], a[224:227], a[44:47], v[96:99]
    ds_read_b128 a[212:215], v130 offset:5888
    v_mfma_f32_16x16x32_bf16 v[100:103], a[224:227], a[116:119], v[100:103]
    s_waitcnt vmcnt(9) lgkmcnt(5)
    v_mfma_f32_16x16x32_bf16 v[64:67], a[228:231], a[48:51], v[64:67]
    ds_read_b128 a[216:219], v1 offset:11520
    v_mul_f32 v152, v26, v148
    v_mfma_f32_16x16x32_bf16 v[68:71], a[228:231], a[120:123], v[68:71]
    buffer_load_dwordx4 a[140:143], v138, s[4:7], s60 offen offset:1024 sc1
    v_mul_f32 v153, v26, v149
    v_mfma_f32_16x16x32_bf16 v[72:75], a[232:235], a[48:51], v[72:75]
    ds_read_b128 a[220:223], v1 offset:12544
    v_mul_f32 v154, v26, v150
    v_mfma_f32_16x16x32_bf16 v[76:79], a[232:235], a[120:123], v[76:79]
    v_mfma_f32_16x16x32_bf16 v[80:83], a[236:239], a[48:51], v[80:83]
    ds_read_b128 a[224:227], v1 offset:13568
    v_mul_f32 v155, v26, v151
    v_mfma_f32_16x16x32_bf16 v[84:87], a[236:239], a[120:123], v[84:87]
    s_lshl_b32 s67, s38, 10
    s_add_u32 s66, s67, s75
    s_add_u32 m0, s67, 63488
    s_add_u32 s66, s66, 25462784
    buffer_load_dwordx4 v1, s[32:35], s66 offen lds
    v_mfma_f32_16x16x32_bf16 v[88:91], a[240:243], a[48:51], v[88:91]
    ds_read_b128 a[228:231], v1 offset:14592
    v_mul_f32 v196, v150, v176
    v_mfma_f32_16x16x32_bf16 v[92:95], a[240:243], a[120:123], v[92:95]
    v_mul_f32 v197, v150, v177
    v_mfma_f32_16x16x32_bf16 v[96:99], a[244:247], a[48:51], v[96:99]
    ds_read_b128 a[232:235], v130 offset:10752
    v_mul_f32 v198, v150, v178
    v_mfma_f32_16x16x32_bf16 v[100:103], a[244:247], a[120:123], v[100:103]
    s_add_u32 m0, s67, 67584
    s_add_u32 s66, s66, 4096
    buffer_load_dwordx4 v1, s[32:35], s66 offen lds
    s_waitcnt vmcnt(10) lgkmcnt(5)
    v_mfma_f32_16x16x32_bf16 v[64:67], a[196:199], a[52:55], v[64:67]
    ds_read_b128 a[236:239], v1 offset:16384
    v_mul_f32 v199, v150, v179
    v_mfma_f32_16x16x32_bf16 v[68:71], a[196:199], a[124:127], v[68:71]
    v_mul_f32 v200, v151, v176
    v_mfma_f32_16x16x32_bf16 v[72:75], a[200:203], a[52:55], v[72:75]
    ds_read_b128 a[240:243], v1 offset:17408
    v_mul_f32 v201, v151, v177
    v_mfma_f32_16x16x32_bf16 v[76:79], a[200:203], a[124:127], v[76:79]
    s_add_u32 m0, s67, 71680
    s_add_u32 s66, s66, 4096
    buffer_load_dwordx4 v1, s[32:35], s66 offen lds
    v_mfma_f32_16x16x32_bf16 v[80:83], a[204:207], a[52:55], v[80:83]
    ds_read_b128 a[244:247], v1 offset:18432
    v_mul_f32 v202, v151, v178
    v_mfma_f32_16x16x32_bf16 v[84:87], a[204:207], a[124:127], v[84:87]
    v_mul_f32 v203, v151, v179
    v_mfma_f32_16x16x32_bf16 v[88:91], a[208:211], a[52:55], v[88:91]
    ds_read_b128 a[196:199], v1 offset:19456
    v_mul_f32 v204, v150, v180
    v_mfma_f32_16x16x32_bf16 v[92:95], a[208:211], a[124:127], v[92:95]
    s_add_u32 m0, s67, 75776
    s_add_u32 s66, s66, 4096
    buffer_load_dwordx4 v1, s[32:35], s66 offen lds
    v_mfma_f32_16x16x32_bf16 v[96:99], a[212:215], a[52:55], v[96:99]
    ds_read_b128 a[200:203], v130 offset:15616
    v_mul_f32 v205, v150, v181
    v_mfma_f32_16x16x32_bf16 v[100:103], a[212:215], a[124:127], v[100:103]
    v_mul_f32 v206, v150, v182
    s_waitcnt vmcnt(10) lgkmcnt(5)
    v_mfma_f32_16x16x32_bf16 v[64:67], a[216:219], a[56:59], v[64:67]
    ds_read_b128 a[204:207], v1 offset:21248
    v_mul_f32 v207, v150, v183
    v_mfma_f32_16x16x32_bf16 v[68:71], a[216:219], a[128:131], v[68:71]
    s_add_u32 m0, s67, 79872
    s_add_u32 s66, s66, 4096
    buffer_load_dwordx4 v1, s[32:35], s66 offen lds
    v_mfma_f32_16x16x32_bf16 v[72:75], a[220:223], a[56:59], v[72:75]
    ds_read_b128 a[208:211], v1 offset:22272
    v_mul_f32 v208, v151, v180
    v_mfma_f32_16x16x32_bf16 v[76:79], a[220:223], a[128:131], v[76:79]
    v_mul_f32 v209, v151, v181
    v_mfma_f32_16x16x32_bf16 v[80:83], a[224:227], a[56:59], v[80:83]
    ds_read_b128 a[212:215], v1 offset:23296
    v_mul_f32 v210, v151, v182
    v_mfma_f32_16x16x32_bf16 v[84:87], a[224:227], a[128:131], v[84:87]
    s_add_u32 m0, s67, 83968
    s_add_u32 s66, s66, 4096
    buffer_load_dwordx4 v1, s[32:35], s66 offen lds
    v_mfma_f32_16x16x32_bf16 v[88:91], a[228:231], a[56:59], v[88:91]
    ds_read_b128 a[216:219], v1 offset:24320
    v_mul_f32 v211, v151, v183
    v_mfma_f32_16x16x32_bf16 v[92:95], a[228:231], a[128:131], v[92:95]
    v_mul_f32 v212, v150, v184
    v_mfma_f32_16x16x32_bf16 v[96:99], a[232:235], a[56:59], v[96:99]
    ds_read_b128 a[220:223], v130 offset:20480
    v_mul_f32 v213, v150, v185
    v_mfma_f32_16x16x32_bf16 v[100:103], a[232:235], a[128:131], v[100:103]
    s_add_u32 m0, s67, 88064
    s_add_u32 s66, s66, 4096
    buffer_load_dwordx4 v1, s[32:35], s66 offen lds
    s_waitcnt vmcnt(11) lgkmcnt(5)
    v_mfma_f32_16x16x32_bf16 v[64:67], a[236:239], a[60:63], v[64:67]
    ds_read_b128 a[224:227], v1 offset:26112
    v_mul_f32 v214, v150, v186
    v_mfma_f32_16x16x32_bf16 v[68:71], a[236:239], a[132:135], v[68:71]
    v_mul_f32 v215, v150, v187
    v_mfma_f32_16x16x32_bf16 v[72:75], a[240:243], a[60:63], v[72:75]
    ds_read_b128 a[228:231], v1 offset:27136
    v_mul_f32 v216, v151, v184
    v_mfma_f32_16x16x32_bf16 v[76:79], a[240:243], a[132:135], v[76:79]
    s_add_u32 m0, s67, 92160
    s_add_u32 s66, s66, 4096
    buffer_load_dwordx4 v1, s[32:35], s66 offen lds
    v_mfma_f32_16x16x32_bf16 v[80:83], a[244:247], a[60:63], v[80:83]
    ds_read_b128 a[232:235], v1 offset:28160
    v_mul_f32 v217, v151, v185
    v_mfma_f32_16x16x32_bf16 v[84:87], a[244:247], a[132:135], v[84:87]
    v_mul_f32 v218, v151, v186
    v_mfma_f32_16x16x32_bf16 v[88:91], a[196:199], a[60:63], v[88:91]
    ds_read_b128 a[236:239], v1 offset:29184
    v_mul_f32 v219, v151, v187
    v_mfma_f32_16x16x32_bf16 v[92:95], a[196:199], a[132:135], v[92:95]
    s_add_u32 m0, s67, 96256
    s_add_u32 s66, s66, 4096
    buffer_load_dwordx4 v1, s[32:35], s66 offen lds
    v_mfma_f32_16x16x32_bf16 v[96:99], a[200:203], a[60:63], v[96:99]
    ds_read_b128 a[240:243], v130 offset:25344
    v_mul_f32 v220, v150, v188
    v_mfma_f32_16x16x32_bf16 v[100:103], a[200:203], a[132:135], v[100:103]
    v_mul_f32 v221, v150, v189
    s_waitcnt vmcnt(11) lgkmcnt(5)
    v_mfma_f32_16x16x32_bf16 v[64:67], a[204:207], a[64:67], v[64:67]
    v_mul_f32 v222, v150, v190
    v_mfma_f32_16x16x32_bf16 v[68:71], a[204:207], a[136:139], v[68:71]
    s_or_b32 s64, s2, s38
    s_cselect_b32 s64, 268435456, 0
    s_add_u32 s64, s64, 54665216
    s_add_u32 s65, s29, 1
    v_mfma_f32_16x16x32_bf16 v[72:75], a[208:211], a[64:67], v[72:75]
    v_mul_f32 v223, v150, v191
    v_mfma_f32_16x16x32_bf16 v[76:79], a[208:211], a[136:139], v[76:79]
    v_mul_f32 v224, v151, v188
    v_mfma_f32_16x16x32_bf16 v[80:83], a[212:215], a[64:67], v[80:83]
    v_mfma_f32_16x16x32_bf16 v[84:87], a[212:215], a[136:139], v[84:87]
    v_or_b32 v28, s64, v23
    v_mul_f32 v225, v151, v189
    v_mfma_f32_16x16x32_bf16 v[88:91], a[216:219], a[64:67], v[88:91]
    v_mul_f32 v226, v151, v190
    v_mfma_f32_16x16x32_bf16 v[92:95], a[216:219], a[136:139], v[92:95]
    v_mul_f32 v227, v151, v191
    v_mfma_f32_16x16x32_bf16 v[96:99], a[220:223], a[64:67], v[96:99]
    v_mfma_f32_16x16x32_bf16 v[100:103], a[220:223], a[136:139], v[100:103]
    v_mov_b32 v29, s65
    s_waitcnt vmcnt(9) lgkmcnt(0)
    v_mfma_f32_16x16x32_bf16 v[64:67], a[224:227], a[68:71], v[64:67]
    v_mul_f32 v228, v154, v192
    v_mul_f32 v229, v154, v193
    v_mfma_f32_16x16x32_bf16 v[68:71], a[224:227], a[140:143], v[68:71]
    v_mul_f32 v230, v154, v194
    v_mfma_f32_16x16x32_bf16 v[72:75], a[228:231], a[68:71], v[72:75]
    v_mfma_f32_16x16x32_bf16 v[76:79], a[228:231], a[140:143], v[76:79]
    buffer_store_dword v29, v28, s[32:35], 0 offen sc1
    v_mul_f32 v231, v154, v195
    v_mfma_f32_16x16x32_bf16 v[80:83], a[232:235], a[68:71], v[80:83]
    v_mul_f32 v232, v155, v192
    v_mfma_f32_16x16x32_bf16 v[84:87], a[232:235], a[140:143], v[84:87]
    v_mul_f32 v233, v155, v193
    v_mfma_f32_16x16x32_bf16 v[88:91], a[236:239], a[68:71], v[88:91]
    v_mfma_f32_16x16x32_bf16 v[92:95], a[236:239], a[140:143], v[92:95]
    v_mul_f32 v234, v155, v194
    v_mfma_f32_16x16x32_bf16 v[96:99], a[240:243], a[68:71], v[96:99]
    v_mul_f32 v235, v155, v195
    v_mfma_f32_16x16x32_bf16 v[100:103], a[240:243], a[140:143], v[100:103]
    s_add_u32 s45, s45, s3
    s_mul_i32 s57, s38, 5120
    s_sub_u32 s57, s53, s57
    v_mov_b32 v27, s44
    v_pk_fma_f32 v[64:65], v[64:65], v[148:149], v[196:197] op_sel:[0,0,0] op_sel_hi:[1,0,1]
    v_pk_fma_f32 v[66:67], v[66:67], v[148:149], v[198:199] op_sel:[0,0,0] op_sel_hi:[1,0,1]
    v_pk_fma_f32 v[68:69], v[68:69], v[148:149], v[200:201] op_sel:[0,1,0] op_sel_hi:[1,1,1]
    v_pk_fma_f32 v[70:71], v[70:71], v[148:149], v[202:203] op_sel:[0,1,0] op_sel_hi:[1,1,1]
    v_cvt_pk_bf16_f32 v236, v64, v65
    v_cvt_pk_bf16_f32 v238, v68, v69
    v_cvt_pk_bf16_f32 v237, v66, v67
    v_cvt_pk_bf16_f32 v239, v70, v71
    v_pk_fma_f32 v[72:73], v[72:73], v[148:149], v[204:205] op_sel:[0,0,0] op_sel_hi:[1,0,1]
    v_pk_fma_f32 v[74:75], v[74:75], v[148:149], v[206:207] op_sel:[0,0,0] op_sel_hi:[1,0,1]
    v_permlane16_swap_b32 v236, v238
    v_permlane16_swap_b32 v237, v239
    buffer_store_dwordx4 v[236:239], v3, s[32:35], s57 offen offset:0 sc1
    v_add3_u32 v27, v27, v236, v237
    v_add3_u32 v27, v27, v238, v239
    v_pk_fma_f32 v[76:77], v[76:77], v[148:149], v[208:209] op_sel:[0,1,0] op_sel_hi:[1,1,1]
    v_pk_fma_f32 v[78:79], v[78:79], v[148:149], v[210:211] op_sel:[0,1,0] op_sel_hi:[1,1,1]
    v_cvt_pk_bf16_f32 v240, v72, v73
    v_cvt_pk_bf16_f32 v242, v76, v77
    v_cvt_pk_bf16_f32 v241, v74, v75
    v_cvt_pk_bf16_f32 v243, v78, v79
    v_pk_fma_f32 v[80:81], v[80:81], v[148:149], v[212:213] op_sel:[0,0,0] op_sel_hi:[1,0,1]
    v_pk_fma_f32 v[82:83], v[82:83], v[148:149], v[214:215] op_sel:[0,0,0] op_sel_hi:[1,0,1]
    v_permlane16_swap_b32 v240, v242
    v_permlane16_swap_b32 v241, v243
    buffer_store_dwordx4 v[240:243], v3, s[32:35], s57 offen offset:1024 sc1
    v_add3_u32 v27, v27, v240, v241
    v_add3_u32 v27, v27, v242, v243
    v_pk_fma_f32 v[84:85], v[84:85], v[148:149], v[216:217] op_sel:[0,1,0] op_sel_hi:[1,1,1]
    v_pk_fma_f32 v[86:87], v[86:87], v[148:149], v[218:219] op_sel:[0,1,0] op_sel_hi:[1,1,1]
    v_cvt_pk_bf16_f32 v244, v80, v81
    v_cvt_pk_bf16_f32 v246, v84, v85
    v_cvt_pk_bf16_f32 v245, v82, v83
    v_cvt_pk_bf16_f32 v247, v86, v87
    v_pk_fma_f32 v[88:89], v[88:89], v[148:149], v[220:221] op_sel:[0,0,0] op_sel_hi:[1,0,1]
    v_pk_fma_f32 v[90:91], v[90:91], v[148:149], v[222:223] op_sel:[0,0,0] op_sel_hi:[1,0,1]
    v_permlane16_swap_b32 v244, v246
    v_permlane16_swap_b32 v245, v247
    buffer_store_dwordx4 v[244:247], v18, s[32:35], s57 offen offset:2048 sc1
    v_add3_u32 v27, v27, v244, v245
    v_add3_u32 v27, v27, v246, v247
    v_pk_fma_f32 v[92:93], v[92:93], v[148:149], v[224:225] op_sel:[0,1,0] op_sel_hi:[1,1,1]
    v_pk_fma_f32 v[94:95], v[94:95], v[148:149], v[226:227] op_sel:[0,1,0] op_sel_hi:[1,1,1]
    v_cvt_pk_bf16_f32 v248, v88, v89
    v_cvt_pk_bf16_f32 v250, v92, v93
    v_cvt_pk_bf16_f32 v249, v90, v91
    v_cvt_pk_bf16_f32 v251, v94, v95
    v_pk_fma_f32 v[96:97], v[96:97], v[152:153], v[228:229] op_sel:[0,0,0] op_sel_hi:[1,0,1]
    v_pk_fma_f32 v[98:99], v[98:99], v[152:153], v[230:231] op_sel:[0,0,0] op_sel_hi:[1,0,1]
    v_permlane16_swap_b32 v248, v250
    v_permlane16_swap_b32 v249, v251
    buffer_store_dwordx4 v[248:251], v18, s[32:35], s57 offen offset:3072 sc1
    v_add3_u32 v27, v27, v248, v249
    v_add3_u32 v27, v27, v250, v251
    v_pk_fma_f32 v[100:101], v[100:101], v[152:153], v[232:233] op_sel:[0,1,0] op_sel_hi:[1,1,1]
    v_pk_fma_f32 v[102:103], v[102:103], v[152:153], v[234:235] op_sel:[0,1,0] op_sel_hi:[1,1,1]
    v_cvt_pk_bf16_f32 v252, v96, v97
    v_cvt_pk_bf16_f32 v254, v100, v101
    v_cvt_pk_bf16_f32 v253, v98, v99
    v_cvt_pk_bf16_f32 v255, v102, v103
    v_permlane16_swap_b32 v252, v254
    s_nop 0
    v_permlane16_swap_b32 v253, v255
    v_mov_b32 v30, v254
    v_mov_b32 v31, v255
    v_add3_u32 v27, v27, v252, v253
    v_mov_b32 v254, s74
    v_and_b32 v255, 0xbfffbfff, v27
    buffer_store_dwordx4 v[252:255], v19, s[32:35], s57 offen sc1
    s_waitcnt vmcnt(10)
    s_waitcnt lgkmcnt(0)
    s_barrier
    ds_read_b128 a[196:199], v136 offset:0
    ds_read_b128 a[200:203], v136 offset:1024
    ds_read_b128 a[204:207], v136 offset:2048
    ds_read_b128 a[208:211], v136 offset:3072
    s_waitcnt lgkmcnt(2)
    v_mfma_f32_16x16x32_bf16 v[104:107], a[196:199], a[0:3], 0
    ds_read_b128 a[212:215], v136 offset:4096
    buffer_load_dword v42, v43, s[32:35], 0 offen sc1
    v_mfma_f32_16x16x32_bf16 v[108:111], a[196:199], a[72:75], 0
    v_and_b32 v140, 48, v0
    v_add_u32 v140, 160576, v140
    v_mfma_f32_16x16x32_bf16 v[112:115], a[200:203], a[0:3], 0
    ds_read_b128 a[216:219], v136 offset:5120
    ds_write_b128 v3, v[236:239] offset:40960
    v_mfma_f32_16x16x32_bf16 v[116:119], a[200:203], a[72:75], 0
    ds_read_b128 v[176:179], v140 offset:0
    s_waitcnt lgkmcnt(4)
    v_mfma_f32_16x16x32_bf16 v[104:107], a[204:207], a[4:7], v[104:107]
    ds_read_b128 a[220:223], v136 offset:6144
    ds_read_b128 v[180:183], v140 offset:64
    v_mfma_f32_16x16x32_bf16 v[108:111], a[204:207], a[76:79], v[108:111]
    v_mul_f32 v148, 0x3eae1a93, v148
    v_mul_f32 v149, 0x3eae1a93, v149
    v_mfma_f32_16x16x32_bf16 v[112:115], a[208:211], a[4:7], v[112:115]
    ds_read_b128 a[224:227], v136 offset:7168
    buffer_load_dword v42, v2, s[24:27], 0 offen sc1
    v_mfma_f32_16x16x32_bf16 v[116:119], a[208:211], a[76:79], v[116:119]
    v_mul_f32 v150, 0x3eae1a93, v150
    v_mul_f32 v151, 0x3eae1a93, v151
    s_waitcnt lgkmcnt(5)
    v_mfma_f32_16x16x32_bf16 v[104:107], a[212:215], a[8:11], v[104:107]
    ds_read_b128 a[228:231], v136 offset:8192
    v_mfma_f32_16x16x32_bf16 v[108:111], a[212:215], a[80:83], v[108:111]
    ds_write_b128 v3, v[240:243] offset:41984
    v_mfma_f32_16x16x32_bf16 v[112:115], a[216:219], a[8:11], v[112:115]
    ds_read_b128 a[232:235], v136 offset:9216
    v_mfma_f32_16x16x32_bf16 v[116:119], a[216:219], a[80:83], v[116:119]
    s_waitcnt lgkmcnt(3)
    v_mfma_f32_16x16x32_bf16 v[104:107], a[220:223], a[12:15], v[104:107]
    ds_read_b128 a[236:239], v136 offset:10240
    v_mfma_f32_16x16x32_bf16 v[108:111], a[220:223], a[84:87], v[108:111]
    s_bitcmp1_b32 s36, 0
    s_cselect_b32 s60, 20480, 0
    s_cselect_b32 s8, 0, -1.0
    s_cselect_b32 s9, -1.0, 0
    s_cselect_b32 s62, s38, 0
    v_mfma_f32_16x16x32_bf16 v[112:115], a[224:227], a[12:15], v[112:115]
    ds_read_b128 a[240:243], v136 offset:11264
    v_mfma_f32_16x16x32_bf16 v[116:119], a[224:227], a[84:87], v[116:119]
    s_waitcnt lgkmcnt(2)
    v_mfma_f32_16x16x32_bf16 v[104:107], a[228:231], a[16:19], v[104:107]
    ds_read_b128 a[244:247], v136 offset:12288
    v_mul_f32 v88, v150, v176
    v_mfma_f32_16x16x32_bf16 v[108:111], a[228:231], a[88:91], v[108:111]
    ds_write_b128 v18, v[244:247] offset:43008
    v_mfma_f32_16x16x32_bf16 v[112:115], a[232:235], a[16:19], v[112:115]
    ds_read_b128 a[196:199], v136 offset:13312
    v_mul_f32 v89, v150, v177
    v_mfma_f32_16x16x32_bf16 v[116:119], a[232:235], a[88:91], v[116:119]
    s_waitcnt lgkmcnt(3)
    v_mfma_f32_16x16x32_bf16 v[104:107], a[236:239], a[20:23], v[104:107]
    ds_read_b128 a[200:203], v136 offset:14336
    v_mul_f32 v90, v150, v178
    v_mfma_f32_16x16x32_bf16 v[108:111], a[236:239], a[92:95], v[108:111]
    s_sub_u32 s80, s53, 40960
    s_add_u32 s80, s80, s60
    s_add_u32 s81, s80, 4096
    v_mfma_f32_16x16x32_bf16 v[112:115], a[240:243], a[20:23], v[112:115]
    ds_read_b128 a[204:207], v136 offset:15360
    v_mul_f32 v91, v150, v179
    v_mfma_f32_16x16x32_bf16 v[116:119], a[240:243], a[92:95], v[116:119]
    s_sub_u32 s82, s53, 20480
    s_sub_u32 s82, s82, s60
    s_add_u32 s83, s82, 4096
    s_mul_i32 s62, s62, 5120
    s_cmp_lt_u32 s36, 1
    s_cselect_b32 s60, 268435456, 0
    s_cselect_b32 s84, 0, s44
    s_cselect_b32 s86, 0, s74
    v_add_u32 v208, s60, v1
    s_cmp_lt_u32 s36, 2
    s_cselect_b32 s60, 268435456, 0
    s_cselect_b32 s85, 0, s44
    s_cselect_b32 s87, 0, s74
    v_add_u32 v209, s60, v1
    s_waitcnt lgkmcnt(2)
    v_mfma_f32_16x16x32_bf16 v[104:107], a[244:247], a[24:27], v[104:107]
    ds_read_b128 a[208:211], v136 offset:16384
    ds_write_b128 v18, v[248:251] offset:44032
    v_mfma_f32_16x16x32_bf16 v[108:111], a[244:247], a[96:99], v[108:111]
    v_mul_f32 v92, v151, v176
    v_mul_f32 v210, s8, -v35
    v_mfma_f32_16x16x32_bf16 v[112:115], a[196:199], a[24:27], v[112:115]
    ds_read_b128 a[212:215], v136 offset:17408
    v_mul_f32 v93, v151, v177
    v_mfma_f32_16x16x32_bf16 v[116:119], a[196:199], a[96:99], v[116:119]
    s_waitcnt lgkmcnt(3)
    v_mfma_f32_16x16x32_bf16 v[104:107], a[200:203], a[28:31], v[104:107]
    ds_read_b128 a[216:219], v136 offset:18432
    v_mul_f32 v94, v151, v178
    v_mfma_f32_16x16x32_bf16 v[108:111], a[200:203], a[100:103], v[108:111]
    v_mfma_f32_16x16x32_bf16 v[112:115], a[204:207], a[28:31], v[112:115]
    ds_read_b128 a[220:223], v136 offset:19456
    v_mfma_f32_16x16x32_bf16 v[116:119], a[204:207], a[100:103], v[116:119]
    v_mul_f32 v95, v151, v179
    s_waitcnt vmcnt(8)
    s_barrier
L_hop9:
    s_cbranch_execz L_hopback
    s_waitcnt lgkmcnt(2)
    v_mfma_f32_16x16x32_bf16 v[104:107], a[208:211], a[32:35], v[104:107]
    ds_read_b128 a[224:227], v136 offset:20480
    ds_write_b128 v19, v[252:255] offset:40960
    v_mfma_f32_16x16x32_bf16 v[108:111], a[208:211], a[104:107], v[108:111]
    v_mul_f32 v96, v150, v180
    v_mul_f32 v211, s9, -v35
    v_mfma_f32_16x16x32_bf16 v[112:115], a[212:215], a[32:35], v[112:115]
    ds_read_b128 a[228:231], v136 offset:21504
    v_mfma_f32_16x16x32_bf16 v[116:119], a[212:215], a[104:107], v[116:119]
    v_mul_f32 v97, v150, v181
    s_waitcnt lgkmcnt(3)
    v_mfma_f32_16x16x32_bf16 v[104:107], a[216:219], a[36:39], v[104:107]
    ds_read_b128 a[232:235], v136 offset:22528
    v_mfma_f32_16x16x32_bf16 v[108:111], a[216:219], a[108:111], v[108:111]
    v_mul_f32 v98, v150, v182
    v_mfma_f32_16x16x32_bf16 v[112:115], a[220:223], a[36:39], v[112:115]
    ds_read_b128 a[236:239], v136 offset:23552
    v_mfma_f32_16x16x32_bf16 v[116:119], a[220:223], a[108:111], v[116:119]
    v_mul_f32 v99, v150, v183
    s_waitcnt lgkmcnt(2)
    v_mfma_f32_16x16x32_bf16 v[104:107], a[224:227], a[40:43], v[104:107]
    ds_read_b128 a[240:243], v136 offset:24576
    s_mul_i32 s61, s38, 5120
    s_add_u32 m0, s61, 20480
    s_nop 0
    buffer_load_dwordx4 v209, s[32:35], s82 offen offset:0 sc1 lds
    v_mfma_f32_16x16x32_bf16 v[108:111], a[224:227], a[112:115], v[108:111]
    v_mul_f32 v100, v151, v180
    v_mfma_f32_16x16x32_bf16 v[112:115], a[228:231], a[40:43], v[112:115]
    ds_read_b128 a[244:247], v136 offset:25600
    v_mfma_f32_16x16x32_bf16 v[116:119], a[228:231], a[112:115], v[116:119]
    s_waitcnt lgkmcnt(2)
    v_mfma_f32_16x16x32_bf16 v[104:107], a[232:235], a[44:47], v[104:107]
    ds_read_b128 a[196:199], v136 offset:26624
    buffer_load_dwordx4 v209, s[32:35], s82 offen offset:1024 sc1 lds
    v_mul_f32 v101, v151, v181
    v_mfma_f32_16x16x32_bf16 v[108:111], a[232:235], a[116:119], v[108:111]
    v_mfma_f32_16x16x32_bf16 v[112:115], a[236:239], a[44:47], v[112:115]
    ds_read_b128 a[200:203], v136 offset:27648
    v_mul_f32 v102, v151, v182
    v_mfma_f32_16x16x32_bf16 v[116:119], a[236:239], a[116:119], v[116:119]
    s_waitcnt lgkmcnt(2)
    v_mfma_f32_16x16x32_bf16 v[104:107], a[240:243], a[48:51], v[104:107]
    ds_read_b128 a[204:207], v136 offset:28672
    buffer_load_dwordx4 v209, s[32:35], s82 offen offset:2048 sc1 lds
    v_mul_f32 v103, v151, v183
    v_mfma_f32_16x16x32_bf16 v[108:111], a[240:243], a[120:123], v[108:111]
    v_fma_f32 v232, v160, s9, v211
    v_fma_f32 v233, v161, s9, v211
    v_mfma_f32_16x16x32_bf16 v[112:115], a[244:247], a[48:51], v[112:115]
    ds_read_b128 a[208:211], v136 offset:29696
    v_add_u32 v38, 100352, v1
    v_mfma_f32_16x16x32_bf16 v[116:119], a[244:247], a[120:123], v[116:119]
    v_fma_f32 v234, v162, s9, v211
    s_waitcnt lgkmcnt(2)
    v_mfma_f32_16x16x32_bf16 v[104:107], a[196:199], a[52:55], v[104:107]
    ds_read_b128 a[212:215], v136 offset:30720
    buffer_load_dwordx4 v209, s[32:35], s82 offen offset:3072 sc1 lds
    v_add_u32 v39, 63488, v1
    v_mfma_f32_16x16x32_bf16 v[108:111], a[196:199], a[124:127], v[108:111]
    v_fma_f32 v235, v163, s9, v211
    v_fma_f32 v236, v164, s9, v211
    v_mfma_f32_16x16x32_bf16 v[112:115], a[200:203], a[52:55], v[112:115]
    ds_read_b128 a[216:219], v136 offset:31744
    v_mov_b32 v73, 0
    v_mfma_f32_16x16x32_bf16 v[116:119], a[200:203], a[124:127], v[116:119]
    v_fma_f32 v237, v165, s9, v211
    s_waitcnt lgkmcnt(2)
    v_mfma_f32_16x16x32_bf16 v[104:107], a[204:207], a[56:59], v[104:107]
    ds_read_b128 a[220:223], v136 offset:32768
    s_add_u32 m0, s61, 24576
    s_nop 0
    buffer_load_dwordx4 v209, s[32:35], s83 offen offset:0 sc1 lds
    v_mov_b32 v74, 0
    v_mfma_f32_16x16x32_bf16 v[108:111], a[204:207], a[128:131], v[108:111]
    v_fma_f32 v238, v166, s9, v211
    v_fma_f32 v239, v167, s9, v211
    v_mfma_f32_16x16x32_bf16 v[112:115], a[208:211], a[56:59], v[112:115]
    ds_read_b128 a[224:227], v136 offset:33792
    v_fma_f32 v240, v168, s9, v211
    v_mfma_f32_16x16x32_bf16 v[116:119], a[208:211], a[128:131], v[116:119]
    v_mov_b32 v75, 0
    s_waitcnt lgkmcnt(2)
    v_mfma_f32_16x16x32_bf16 v[104:107], a[212:215], a[60:63], v[104:107]
    ds_read_b128 a[228:231], v136 offset:34816
    v_fma_f32 v241, v169, s9, v211
    v_mfma_f32_16x16x32_bf16 v[108:111], a[212:215], a[132:135], v[108:111]
    v_mov_b32 v76, 0
    v_fma_f32 v242, v170, s9, v211
    v_mfma_f32_16x16x32_bf16 v[112:115], a[216:219], a[60:63], v[112:115]
    ds_read_b128 a[232:235], v136 offset:35840
    v_fma_f32 v243, v171, s9, v211
    v_mfma_f32_16x16x32_bf16 v[116:119], a[216:219], a[132:135], v[116:119]
    v_mov_b32 v78, 0
    s_waitcnt lgkmcnt(2)
    v_mfma_f32_16x16x32_bf16 v[104:107], a[220:223], a[64:67], v[104:107]
    v_fma_f32 v244, v172, s9, v211
    v_fma_f32 v245, v173, s9, v211
    v_mfma_f32_16x16x32_bf16 v[108:111], a[220:223], a[136:139], v[108:111]
    v_mov_b32 v79, 0
    v_fma_f32 v246, v174, s9, v211
    v_mfma_f32_16x16x32_bf16 v[112:115], a[224:227], a[64:67], v[112:115]
    v_fma_f32 v247, v175, s9, v211
    v_mfma_f32_16x16x32_bf16 v[116:119], a[224:227], a[136:139], v[116:119]
    v_cndmask_b32 v72, 0, v30, s[70:71]
    s_waitcnt lgkmcnt(0)
    v_mfma_f32_16x16x32_bf16 v[104:107], a[228:231], a[68:71], v[104:107]
    v_subrev_u32 v248, s62, v3
    v_subrev_u32 v249, s62, v19
    v_mfma_f32_16x16x32_bf16 v[108:111], a[228:231], a[140:143], v[108:111]
    v_cndmask_b32 v77, 0, v31, s[70:71]
    v_subrev_u32 v250, s62, v4
    v_mfma_f32_16x16x32_bf16 v[112:115], a[232:235], a[68:71], v[112:115]
    v_subrev_u32 v251, s62, v5
    v_mfma_f32_16x16x32_bf16 v[116:119], a[232:235], a[140:143], v[116:119]
    ds_read_b128 v[192:195], v3 offset:40960
    ds_read_b128 v[200:203], v19 offset:40960
    ds_read_b128 v[196:199], v3 offset:41984
    ds_read_b64_tr_b16 v[176:177], v4 offset:40960
    ds_read_b64_tr_b16 v[178:179], v4 offset:41088
    ds_read_b64_tr_b16 v[180:181], v4 offset:41216
    ds_read_b64_tr_b16 v[182:183], v4 offset:41344
    v_pk_fma_f32 v[104:105], v[104:105], v[148:149], v[88:89] op_sel:[0,0,0] op_sel_hi:[1,0,1]
    v_pk_fma_f32 v[106:107], v[106:107], v[148:149], v[90:91] op_sel:[0,0,0] op_sel_hi:[1,0,1]
    v_pk_fma_f32 v[108:109], v[108:109], v[148:149], v[92:93] op_sel:[0,1,0] op_sel_hi:[1,1,1]
    v_pk_fma_f32 v[110:111], v[110:111], v[148:149], v[94:95] op_sel:[0,1,0] op_sel_hi:[1,1,1]
    v_cvt_pk_bf16_f32 v64, v104, v105
    v_cvt_pk_bf16_f32 v66, v108, v109
    v_cvt_pk_bf16_f32 v65, v106, v107
    v_cvt_pk_bf16_f32 v67, v110, v111
    v_pk_fma_f32 v[112:113], v[112:113], v[148:149], v[96:97] op_sel:[0,0,0] op_sel_hi:[1,0,1]
    v_pk_fma_f32 v[114:115], v[114:115], v[148:149], v[98:99] op_sel:[0,0,0] op_sel_hi:[1,0,1]
    v_permlane16_swap_b32 v64, v66
    v_permlane16_swap_b32 v65, v67
    v_pk_fma_f32 v[116:117], v[116:117], v[148:149], v[100:101] op_sel:[0,1,0] op_sel_hi:[1,1,1]
    v_pk_fma_f32 v[118:119], v[118:119], v[148:149], v[102:103] op_sel:[0,1,0] op_sel_hi:[1,1,1]
    s_waitcnt lgkmcnt(6)
    v_mfma_f32_32x32x16_bf16 v[80:95], v[192:195], v[64:67], v[160:175]
    v_cvt_pk_bf16_f32 v68, v112, v113
    v_cvt_pk_bf16_f32 v70, v116, v117
    v_cvt_pk_bf16_f32 v69, v114, v115
    v_cvt_pk_bf16_f32 v71, v118, v119
    s_waitcnt lgkmcnt(5)
    v_mfma_f32_32x32x16_bf16 v[80:95], v[200:203], v[72:75], v[80:95]
    v_permlane16_swap_b32 v68, v70
    v_permlane16_swap_b32 v69, v71
L_rerun3:
    s_nop 9
    v_exp_f32 v80, v80
    v_exp_f32 v81, v81
    v_exp_f32 v82, v82
    v_exp_f32 v83, v83
    s_waitcnt lgkmcnt(4)
    v_mfma_f32_32x32x16_bf16 v[96:111], v[196:199], v[68:71], v[160:175]
    v_exp_f32 v84, v84
    v_cvt_pk_bf16_f32 v112, v80, v81
    v_exp_f32 v85, v85
    v_cvt_pk_bf16_f32 v113, v82, v83
    v_exp_f32 v86, v86
    v_exp_f32 v87, v87
    v_mfma_f32_32x32x16_bf16 v[96:111], v[200:203], v[76:79], v[96:111]
    v_exp_f32 v88, v88
    v_cvt_pk_bf16_f32 v114, v84, v85
    v_exp_f32 v89, v89
    v_cvt_pk_bf16_f32 v115, v86, v87
    v_exp_f32 v90, v90
    v_exp_f32 v91, v91
    v_exp_f32 v92, v92
    v_cvt_pk_bf16_f32 v116, v88, v89
    v_exp_f32 v93, v93
    v_cvt_pk_bf16_f32 v117, v90, v91
    v_exp_f32 v94, v94
    v_exp_f32 v95, v95
    s_waitcnt lgkmcnt(0)
    v_mfma_f32_32x32x16_bf16 v[128:143], v[176:179], v[112:115], 0
    ds_read_b64_tr_b16 v[184:185], v5 offset:40960
    ds_read_b64_tr_b16 v[186:187], v5 offset:41088
    ds_read_b64_tr_b16 v[188:189], v5 offset:41216
    s_waitcnt vmcnt(0)
    ds_read_b128 v[212:215], v3 offset:20480
    ds_read_b128 v[216:219], v3 offset:21504
    ds_read_b128 v[220:223], v18 offset:22528
    ds_read_b128 v[224:227], v18 offset:23552
    ds_read_b128 v[228:231], v19 offset:20480
    v_exp_f32 v96, v96
    v_cvt_pk_bf16_f32 v118, v92, v93
    v_exp_f32 v97, v97
    v_cvt_pk_bf16_f32 v119, v94, v95
    v_exp_f32 v98, v98
    v_exp_f32 v99, v99
    v_mfma_f32_32x32x16_bf16 v[128:143], v[180:183], v[116:119], v[128:143]
    ds_read_b64_tr_b16 v[190:191], v5 offset:41344
    v_exp_f32 v100, v100
    v_cvt_pk_bf16_f32 v120, v96, v97
    v_exp_f32 v101, v101
    v_cvt_pk_bf16_f32 v121, v98, v99
    v_exp_f32 v102, v102
    v_exp_f32 v103, v103
    s_cmp_lg_u32 s55, 0
    s_cbranch_scc1 rr_53
    s_waitcnt lgkmcnt(1)
chk_55:
    s_sub_u32 s43, s43, 1
    s_cselect_b64 s[68:69], 0, -1
    s_max_i32 s43, s43, 0
    v_add3_u32 v24, s85, v212, v213
    v_add3_u32 v24, v24, v214, v215
    v_add3_u32 v24, v24, v216, v217
    v_add3_u32 v24, v24, v218, v219
    v_add3_u32 v24, v24, v220, v221
    v_add3_u32 v24, v24, v222, v223
    v_add3_u32 v24, v24, v224, v225
    v_add3_u32 v24, v24, v226, v227
    v_add3_u32 v24, v24, v228, v229
    v_cmp_ne_u32 s[56:57], s87, v230
    v_and_b32 v24, 0xbfffbfff, v24
    v_cmp_ne_u32 vcc, v24, v231
    s_or_b64 vcc, vcc, s[56:57]
    s_and_b64 vcc, vcc, s[68:69]
    s_cbranch_scc0 ok_56
    s_nop 1
    s_mov_b32 s58, m0
    s_mul_i32 s61, s38, 5120
    s_add_u32 m0, s61, 20480
    s_nop 0
    buffer_load_dwordx4 v209, s[32:35], s82 offen offset:0 sc1 lds
    buffer_load_dwordx4 v209, s[32:35], s82 offen offset:1024 sc1 lds
    buffer_load_dwordx4 v209, s[32:35], s82 offen offset:2048 sc1 lds
    buffer_load_dwordx4 v209, s[32:35], s82 offen offset:3072 sc1 lds
    s_add_u32 m0, s61, 24576
    s_nop 0
    buffer_load_dwordx4 v209, s[32:35], s83 offen offset:0 sc1 lds
    s_waitcnt vmcnt(0)
    ds_read_b128 v[212:215], v3 offset:20480
    ds_read_b128 v[216:219], v3 offset:21504
    ds_read_b128 v[220:223], v18 offset:22528
    ds_read_b128 v[224:227], v18 offset:23552
    ds_read_b128 v[228:231], v19 offset:20480
    s_mov_b32 m0, s58
    s_waitcnt lgkmcnt(0)
    s_branch chk_55
ok_56:
    s_waitcnt lgkmcnt(0)
    s_barrier
rb_54:
    ds_read_b128 v[192:195], v3 offset:35840
    ds_read_b128 v[204:207], v19 offset:35840
    ds_read_b128 v[196:199], v3 offset:36864
    v_exp_f32 v104, v104
    v_cvt_pk_bf16_f32 v122, v100, v101
    v_exp_f32 v105, v105
    v_cvt_pk_bf16_f32 v123, v102, v103
    v_exp_f32 v106, v106
    v_exp_f32 v107, v107
    v_exp_f32 v108, v108
    v_cvt_pk_bf16_f32 v124, v104, v105
    v_exp_f32 v109, v109
    v_cvt_pk_bf16_f32 v125, v106, v107
    v_exp_f32 v110, v110
    v_exp_f32 v111, v111
    v_cvt_pk_bf16_f32 v126, v108, v109
    v_cvt_pk_bf16_f32 v127, v110, v111
    s_waitcnt lgkmcnt(2)
    v_mfma_f32_32x32x16_bf16 v[80:95], v[192:195], v[64:67], 0
    v_fma_f32 v160, v160, s8, v210
    v_fma_f32 v161, v161, s8, v210
    v_fma_f32 v162, v162, s8, v210
    v_fma_f32 v163, v163, s8, v210
    v_fma_f32 v164, v164, s8, v210
    v_fma_f32 v165, v165, s8, v210
    s_waitcnt lgkmcnt(1)
    v_mfma_f32_32x32x16_bf16 v[80:95], v[204:207], v[72:75], v[80:95]
    v_fma_f32 v166, v166, s8, v210
    v_fma_f32 v167, v167, s8, v210
    v_fma_f32 v168, v168, s8, v210
    v_fma_f32 v169, v169, s8, v210
    v_fma_f32 v170, v170, s8, v210
    v_fma_f32 v171, v171, s8, v210
    v_fma_f32 v172, v172, s8, v210
    v_fma_f32 v173, v173, s8, v210
    v_fma_f32 v174, v174, s8, v210
    v_fma_f32 v175, v175, s8, v210
    s_waitcnt lgkmcnt(0)
    v_mfma_f32_32x32x16_bf16 v[144:159], v[184:187], v[120:123], 0
    ds_read_b64_tr_b16 v[176:177], v4 offset:35840
    ds_read_b64_tr_b16 v[178:179], v4 offset:35968
    ds_read_b64_tr_b16 v[180:181], v4 offset:36096
    v_exp_f32 v80, v80
    v_exp_f32 v81, v81
    v_exp_f32 v82, v82
    v_exp_f32 v83, v83
    v_mfma_f32_32x32x16_bf16 v[96:111], v[196:199], v[68:71], 0
    ds_read_b64_tr_b16 v[182:183], v4 offset:36224
    ds_read_b128 v[192:195], v3 offset:30720
    ds_read_b128 v[200:203], v19 offset:30720
    s_mul_i32 s61, s38, 5120
    s_add_u32 m0, s61, 0
    s_nop 0
    buffer_load_dwordx4 v208, s[32:35], s80 offen offset:0 sc1 lds
    v_exp_f32 v84, v84
    v_cvt_pk_bf16_f32 v112, v80, v81
    v_exp_f32 v85, v85
    v_cvt_pk_bf16_f32 v113, v82, v83
    v_exp_f32 v86, v86
    v_exp_f32 v87, v87
    v_mfma_f32_32x32x16_bf16 v[96:111], v[204:207], v[76:79], v[96:111]
    buffer_load_dwordx4 v208, s[32:35], s80 offen offset:1024 sc1 lds
    v_exp_f32 v88, v88
    v_cvt_pk_bf16_f32 v114, v84, v85
    v_exp_f32 v89, v89
    v_cvt_pk_bf16_f32 v115, v86, v87
    v_exp_f32 v90, v90
    v_exp_f32 v91, v91
    v_mfma_f32_32x32x16_bf16 v[144:159], v[188:191], v[124:127], v[144:159]
    buffer_load_dwordx4 v208, s[32:35], s80 offen offset:2048 sc1 lds
    v_exp_f32 v92, v92
    v_cvt_pk_bf16_f32 v116, v88, v89
    v_exp_f32 v93, v93
    v_cvt_pk_bf16_f32 v117, v90, v91
    v_exp_f32 v94, v94
    v_exp_f32 v95, v95
    s_waitcnt lgkmcnt(0)
    v_mfma_f32_32x32x16_bf16 v[128:143], v[176:179], v[112:115], v[128:143]
    ds_read_b64_tr_b16 v[184:185], v5 offset:35840
    ds_read_b64_tr_b16 v[186:187], v5 offset:35968
    ds_read_b64_tr_b16 v[188:189], v5 offset:36096
    v_exp_f32 v96, v96
    v_cvt_pk_bf16_f32 v118, v92, v93
    v_exp_f32 v97, v97
    v_cvt_pk_bf16_f32 v119, v94, v95
    v_exp_f32 v98, v98
    v_exp_f32 v99, v99
    v_mfma_f32_32x32x16_bf16 v[80:95], v[192:195], v[64:67], 0
    ds_read_b64_tr_b16 v[190:191], v5 offset:36224
    ds_read_b128 v[196:199], v3 offset:31744
    buffer_load_dwordx4 v208, s[32:35], s80 offen offset:3072 sc1 lds
    v_exp_f32 v100, v100
    v_cvt_pk_bf16_f32 v120, v96, v97
    v_exp_f32 v101, v101
    v_cvt_pk_bf16_f32 v121, v98, v99
    v_exp_f32 v102, v102
    v_exp_f32 v103, v103
    v_mfma_f32_32x32x16_bf16 v[80:95], v[200:203], v[72:75], v[80:95]
    s_add_u32 m0, s61, 4096
    s_nop 0
    buffer_load_dwordx4 v208, s[32:35], s81 offen offset:0 sc1 lds
    v_exp_f32 v104, v104
    v_cvt_pk_bf16_f32 v122, v100, v101
    v_exp_f32 v105, v105
    v_cvt_pk_bf16_f32 v123, v102, v103
    v_exp_f32 v106, v106
    v_exp_f32 v107, v107
    v_mfma_f32_32x32x16_bf16 v[128:143], v[180:183], v[116:119], v[128:143]
    v_exp_f32 v108, v108
    v_cvt_pk_bf16_f32 v124, v104, v105
    v_exp_f32 v109, v109
    v_cvt_pk_bf16_f32 v125, v106, v107
    v_exp_f32 v110, v110
    v_exp_f32 v111, v111
    s_waitcnt lgkmcnt(0)
    v_mfma_f32_32x32x16_bf16 v[144:159], v[184:187], v[120:123], v[144:159]
    ds_read_b64_tr_b16 v[176:177], v4 offset:30720
    ds_read_b64_tr_b16 v[178:179], v4 offset:30848
    ds_read_b64_tr_b16 v[180:181], v4 offset:30976
    v_exp_f32 v80, v80
    v_cvt_pk_bf16_f32 v126, v108, v109
    v_exp_f32 v81, v81
    v_cvt_pk_bf16_f32 v127, v110, v111
    v_exp_f32 v82, v82
    v_exp_f32 v83, v83
    v_mfma_f32_32x32x16_bf16 v[96:111], v[196:199], v[68:71], 0
    ds_read_b64_tr_b16 v[182:183], v4 offset:31104
    ds_read_b128 v[192:195], v3 offset:25600
    ds_read_b128 v[204:207], v19 offset:25600
    v_exp_f32 v84, v84
    v_cvt_pk_bf16_f32 v112, v80, v81
    v_exp_f32 v85, v85
    v_cvt_pk_bf16_f32 v113, v82, v83
    v_exp_f32 v86, v86
    v_exp_f32 v87, v87
    v_mfma_f32_32x32x16_bf16 v[96:111], v[200:203], v[76:79], v[96:111]
    v_exp_f32 v88, v88
    v_cvt_pk_bf16_f32 v114, v84, v85
    v_exp_f32 v89, v89
    v_cvt_pk_bf16_f32 v115, v86, v87
    v_exp_f32 v90, v90
    v_exp_f32 v91, v91
    v_mfma_f32_32x32x16_bf16 v[144:159], v[188:191], v[124:127], v[144:159]
    v_exp_f32 v92, v92
    v_cvt_pk_bf16_f32 v116, v88, v89
    v_exp_f32 v93, v93
    v_cvt_pk_bf16_f32 v117, v90, v91
    v_exp_f32 v94, v94
    v_exp_f32 v95, v95
    s_waitcnt lgkmcnt(0)
    v_mfma_f32_32x32x16_bf16 v[128:143], v[176:179], v[112:115], v[128:143]
    ds_read_b64_tr_b16 v[184:185], v5 offset:30720
    ds_read_b64_tr_b16 v[186:187], v5 offset:30848
    ds_read_b64_tr_b16 v[188:189], v5 offset:30976
    v_exp_f32 v96, v96
    v_cvt_pk_bf16_f32 v118, v92, v93
    v_exp_f32 v97, v97
    v_cvt_pk_bf16_f32 v119, v94, v95
    v_exp_f32 v98, v98
    v_exp_f32 v99, v99
    v_mfma_f32_32x32x16_bf16 v[80:95], v[192:195], v[64:67], 0
    ds_read_b64_tr_b16 v[190:191], v5 offset:31104
    ds_read_b128 v[196:199], v3 offset:26624
    v_exp_f32 v100, v100
    v_cvt_pk_bf16_f32 v120, v96, v97
    v_exp_f32 v101, v101
    v_cvt_pk_bf16_f32 v121, v98, v99
    v_exp_f32 v102, v102
    v_exp_f32 v103, v103
    v_mfma_f32_32x32x16_bf16 v[80:95], v[204:207], v[72:75], v[80:95]
    v_exp_f32 v104, v104
    v_cvt_pk_bf16_f32 v122, v100, v101
    v_exp_f32 v105, v105
    v_cvt_pk_bf16_f32 v123, v102, v103
    v_exp_f32 v106, v106
    v_exp_f32 v107, v107
    v_mfma_f32_32x32x16_bf16 v[128:143], v[180:183], v[116:119], v[128:143]
    v_exp_f32 v108, v108
    v_cvt_pk_bf16_f32 v124, v104, v105
    v_exp_f32 v109, v109
    v_cvt_pk_bf16_f32 v125, v106, v107
    v_exp_f32 v110, v110
    v_exp_f32 v111, v111
    s_waitcnt lgkmcnt(0)
    v_mfma_f32_32x32x16_bf16 v[144:159], v[184:187], v[120:123], v[144:159]
    ds_read_b64_tr_b16 v[176:177], v4 offset:25600
    ds_read_b64_tr_b16 v[178:179], v4 offset:25728
    ds_read_b64_tr_b16 v[180:181], v4 offset:25856
    v_exp_f32 v80, v80
    v_cvt_pk_bf16_f32 v126, v108, v109
    v_exp_f32 v81, v81
    v_cvt_pk_bf16_f32 v127, v110, v111
    v_exp_f32 v82, v82
    v_exp_f32 v83, v83
    v_mfma_f32_32x32x16_bf16 v[96:111], v[196:199], v[68:71], 0
    ds_read_b64_tr_b16 v[182:183], v4 offset:25984
    ds_read_b128 v[192:195], v3 offset:20480
    ds_read_b128 v[200:203], v19 offset:20480
    v_exp_f32 v84, v84
    v_cvt_pk_bf16_f32 v112, v80, v81
    v_exp_f32 v85, v85
    v_cvt_pk_bf16_f32 v113, v82, v83
    v_exp_f32 v86, v86
    v_exp_f32 v87, v87
    v_mfma_f32_32x32x16_bf16 v[96:111], v[204:207], v[76:79], v[96:111]
    v_exp_f32 v88, v88
    v_cvt_pk_bf16_f32 v114, v84, v85
    v_exp_f32 v89, v89
    v_cvt_pk_bf16_f32 v115, v86, v87
    v_exp_f32 v90, v90
    v_exp_f32 v91, v91
    v_mfma_f32_32x32x16_bf16 v[144:159], v[188:191], v[124:127], v[144:159]
    v_exp_f32 v92, v92
    v_cvt_pk_bf16_f32 v116, v88, v89
    v_exp_f32 v93, v93
    v_cvt_pk_bf16_f32 v117, v90, v91
    v_exp_f32 v94, v94
    v_exp_f32 v95, v95
    s_waitcnt lgkmcnt(0)
    v_mfma_f32_32x32x16_bf16 v[128:143], v[176:179], v[112:115], v[128:143]
    ds_read_b64_tr_b16 v[184:185], v5 offset:25600
    ds_read_b64_tr_b16 v[186:187], v5 offset:25728
    ds_read_b64_tr_b16 v[188:189], v5 offset:25856
    v_exp_f32 v96, v96
    v_cvt_pk_bf16_f32 v118, v92, v93
    v_exp_f32 v97, v97
    v_cvt_pk_bf16_f32 v119, v94, v95
    v_exp_f32 v98, v98
    v_exp_f32 v99, v99
    v_mfma_f32_32x32x16_bf16 v[80:95], v[192:195], v[64:67], v[232:247]
    ds_read_b64_tr_b16 v[190:191], v5 offset:25984
    ds_read_b128 v[196:199], v3 offset:21504
    v_exp_f32 v100, v100
    v_cvt_pk_bf16_f32 v120, v96, v97
    v_exp_f32 v101, v101
    v_cvt_pk_bf16_f32 v121, v98, v99
    v_exp_f32 v102, v102
    v_exp_f32 v103, v103
    v_mfma_f32_32x32x16_bf16 v[80:95], v[200:203], v[72:75], v[80:95]
    s_waitcnt vmcnt(0)
    ds_read_b128 v[212:215], v3 offset:0
    ds_read_b128 v[216:219], v3 offset:1024
    ds_read_b128 v[220:223], v18 offset:2048
    ds_read_b128 v[224:227], v18 offset:3072
    ds_read_b128 v[228:231], v19 offset:0
    v_exp_f32 v104, v104
    v_cvt_pk_bf16_f32 v122, v100, v101
    v_exp_f32 v105, v105
    v_cvt_pk_bf16_f32 v123, v102, v103
    v_exp_f32 v106, v106
    v_exp_f32 v107, v107
    v_mfma_f32_32x32x16_bf16 v[128:143], v[180:183], v[116:119], v[128:143]
    v_exp_f32 v108, v108
    v_cvt_pk_bf16_f32 v124, v104, v105
    v_exp_f32 v109, v109
    v_cvt_pk_bf16_f32 v125, v106, v107
    v_exp_f32 v110, v110
    v_exp_f32 v111, v111
    s_waitcnt lgkmcnt(0)
    s_cmp_lg_u32 s55, 0
    s_cbranch_scc1 rr_57
chk_59:
    s_sub_u32 s43, s43, 1
    s_cselect_b64 s[68:69], 0, -1
    s_max_i32 s43, s43, 0
    v_add3_u32 v24, s84, v212, v213
    v_add3_u32 v24, v24, v214, v215
    v_add3_u32 v24, v24, v216, v217
    v_add3_u32 v24, v24, v218, v219
    v_add3_u32 v24, v24, v220, v221
    v_add3_u32 v24, v24, v222, v223
    v_add3_u32 v24, v24, v224, v225
    v_add3_u32 v24, v24, v226, v227
    v_add3_u32 v24, v24, v228, v229
    v_cmp_ne_u32 s[56:57], s86, v230
    v_and_b32 v24, 0xbfffbfff, v24
    v_cmp_ne_u32 vcc, v24, v231
    s_or_b64 vcc, vcc, s[56:57]
    s_and_b64 vcc, vcc, s[68:69]
    s_cbranch_scc0 ok_60
    s_nop 1
    s_mov_b32 s58, m0
    s_mul_i32 s61, s38, 5120
    s_add_u32 m0, s61, 0
    s_nop 0
    buffer_load_dwordx4 v208, s[32:35], s80 offen offset:0 sc1 lds
    buffer_load_dwordx4 v208, s[32:35], s80 offen offset:1024 sc1 lds
    buffer_load_dwordx4 v208, s[32:35], s80 offen offset:2048 sc1 lds
    buffer_load_dwordx4 v208, s[32:35], s80 offen offset:3072 sc1 lds
    s_add_u32 m0, s61, 4096
    s_nop 0
    buffer_load_dwordx4 v208, s[32:35], s81 offen offset:0 sc1 lds
    s_waitcnt vmcnt(0)
    ds_read_b128 v[212:215], v3 offset:0
    ds_read_b128 v[216:219], v3 offset:1024
    ds_read_b128 v[220:223], v18 offset:2048
    ds_read_b128 v[224:227], v18 offset:3072
    ds_read_b128 v[228:231], v19 offset:0
    s_mov_b32 m0, s58
    s_waitcnt lgkmcnt(0)
    s_branch chk_59
ok_60:
    s_waitcnt lgkmcnt(0)
    s_barrier
rb_58:
    v_mfma_f32_32x32x16_bf16 v[144:159], v[184:187], v[120:123], v[144:159]
    ds_read_b64_tr_b16 v[176:177], v4 offset:20480
    ds_read_b64_tr_b16 v[178:179], v4 offset:20608
    ds_read_b64_tr_b16 v[180:181], v4 offset:20736
    v_exp_f32 v80, v80
    v_cvt_pk_bf16_f32 v126, v108, v109
    v_exp_f32 v81, v81
    v_cvt_pk_bf16_f32 v127, v110, v111
    v_exp_f32 v82, v82
    v_exp_f32 v83, v83
    v_mfma_f32_32x32x16_bf16 v[96:111], v[196:199], v[68:71], v[232:247]
    ds_read_b64_tr_b16 v[182:183], v4 offset:20864
    ds_read_b128 v[192:195], v248 offset:15360
    ds_read_b128 v[204:207], v249 offset:15360
    s_mul_i32 s67, s38, 14336
    s_add_u32 s66, s67, s89
    s_add_u32 m0, s67, 100352
    s_add_u32 s66, s66, 46802944
    buffer_load_dwordx4 v1, s[32:35], s66 offen lds
    v_exp_f32 v84, v84
    v_cvt_pk_bf16_f32 v112, v80, v81
    v_exp_f32 v85, v85
    v_cvt_pk_bf16_f32 v113, v82, v83
    v_exp_f32 v86, v86
    v_exp_f32 v87, v87
    v_mfma_f32_32x32x16_bf16 v[96:111], v[200:203], v[76:79], v[96:111]
    buffer_load_dwordx4 v1, s[32:35], s66 offen offset:1024 lds
    v_exp_f32 v88, v88
    v_cvt_pk_bf16_f32 v114, v84, v85
    v_exp_f32 v89, v89
    v_cvt_pk_bf16_f32 v115, v86, v87
    v_exp_f32 v90, v90
    v_exp_f32 v91, v91
    v_mfma_f32_32x32x16_bf16 v[144:159], v[188:191], v[124:127], v[144:159]
    buffer_load_dwordx4 v1, s[32:35], s66 offen offset:2048 lds
    v_exp_f32 v92, v92
    v_cvt_pk_bf16_f32 v116, v88, v89
    v_exp_f32 v93, v93
    v_cvt_pk_bf16_f32 v117, v90, v91
    v_exp_f32 v94, v94
    v_exp_f32 v95, v95
    s_waitcnt lgkmcnt(0)
    v_mfma_f32_32x32x16_bf16 v[128:143], v[176:179], v[112:115], v[128:143]
    ds_read_b64_tr_b16 v[184:185], v5 offset:20480
    ds_read_b64_tr_b16 v[186:187], v5 offset:20608
    ds_read_b64_tr_b16 v[188:189], v5 offset:20736
    v_exp_f32 v96, v96
    v_cvt_pk_bf16_f32 v118, v92, v93
    v_exp_f32 v97, v97
    v_cvt_pk_bf16_f32 v119, v94, v95
    v_exp_f32 v98, v98
    v_exp_f32 v99, v99
    v_mfma_f32_32x32x16_bf16 v[80:95], v[192:195], v[64:67], 0
    ds_read_b64_tr_b16 v[190:191], v5 offset:20864
    ds_read_b128 v[196:199], v248 offset:16384
    buffer_load_dwordx4 v1, s[32:35], s66 offen offset:3072 lds
    v_exp_f32 v100, v100
    v_cvt_pk_bf16_f32 v120, v96, v97
    v_exp_f32 v101, v101
    v_cvt_pk_bf16_f32 v121, v98, v99
    v_exp_f32 v102, v102
    v_exp_f32 v103, v103
    v_mfma_f32_32x32x16_bf16 v[80:95], v[204:207], v[72:75], v[80:95]
    s_add_u32 m0, s67, 104448
    s_add_u32 s66, s66, 4096
    buffer_load_dwordx4 v1, s[32:35], s66 offen lds
    v_exp_f32 v104, v104
    v_cvt_pk_bf16_f32 v122, v100, v101
    v_exp_f32 v105, v105
    v_cvt_pk_bf16_f32 v123, v102, v103
    v_exp_f32 v106, v106
    v_exp_f32 v107, v107
    v_mfma_f32_32x32x16_bf16 v[128:143], v[180:183], v[116:119], v[128:143]
    buffer_load_dwordx4 v1, s[32:35], s66 offen offset:1024 lds
    v_exp_f32 v108, v108
    v_cvt_pk_bf16_f32 v124, v104, v105
    v_exp_f32 v109, v109
    v_cvt_pk_bf16_f32 v125, v106, v107
    v_exp_f32 v110, v110
    v_exp_f32 v111, v111
    s_waitcnt lgkmcnt(0)
    v_mfma_f32_32x32x16_bf16 v[144:159], v[184:187], v[120:123], v[144:159]
    ds_read_b64_tr_b16 v[176:177], v250 offset:15360
    ds_read_b64_tr_b16 v[178:179], v250 offset:15488
    ds_read_b64_tr_b16 v[180:181], v250 offset:15616
    v_exp_f32 v80, v80
    v_cvt_pk_bf16_f32 v126, v108, v109
    v_exp_f32 v81, v81
    v_cvt_pk_bf16_f32 v127, v110, v111
    v_exp_f32 v82, v82
    v_exp_f32 v83, v83
    v_mfma_f32_32x32x16_bf16 v[96:111], v[196:199], v[68:71], 0
    ds_read_b64_tr_b16 v[182:183], v250 offset:15744
    ds_read_b128 v[192:195], v248 offset:10240
    ds_read_b128 v[200:203], v249 offset:10240
    buffer_load_dwordx4 v1, s[32:35], s66 offen offset:2048 lds
    v_exp_f32 v84, v84
    v_cvt_pk_bf16_f32 v112, v80, v81
L_hop10:
    s_cbranch_execz L_hopback
    v_exp_f32 v85, v85
    v_cvt_pk_bf16_f32 v113, v82, v83
    v_exp_f32 v86, v86
    v_exp_f32 v87, v87
    v_mfma_f32_32x32x16_bf16 v[96:111], v[204:207], v[76:79], v[96:111]
    buffer_load_dwordx4 v1, s[32:35], s66 offen offset:3072 lds
    v_exp_f32 v88, v88
    v_cvt_pk_bf16_f32 v114, v84, v85
    v_exp_f32 v89, v89
    v_cvt_pk_bf16_f32 v115, v86, v87
    v_exp_f32 v90, v90
    v_exp_f32 v91, v91
    v_mfma_f32_32x32x16_bf16 v[144:159], v[188:191], v[124:127], v[144:159]
    s_add_u32 m0, s67, 108544
    s_add_u32 s66, s66, 4096
    buffer_load_dwordx4 v1, s[32:35], s66 offen lds
    v_exp_f32 v92, v92
    v_cvt_pk_bf16_f32 v116, v88, v89
    v_exp_f32 v93, v93
    v_cvt_pk_bf16_f32 v117, v90, v91
    v_exp_f32 v94, v94
    v_exp_f32 v95, v95
    s_waitcnt lgkmcnt(0)
    v_mfma_f32_32x32x16_bf16 v[128:143], v[176:179], v[112:115], v[128:143]
    ds_read_b64_tr_b16 v[184:185], v251 offset:15360
    ds_read_b64_tr_b16 v[186:187], v251 offset:15488
    ds_read_b64_tr_b16 v[188:189], v251 offset:15616
    v_exp_f32 v96, v96
    v_cvt_pk_bf16_f32 v118, v92, v93
    v_exp_f32 v97, v97
    v_cvt_pk_bf16_f32 v119, v94, v95
    v_exp_f32 v98, v98
    v_exp_f32 v99, v99
    v_mfma_f32_32x32x16_bf16 v[80:95], v[192:195], v[64:67], 0
    ds_read_b64_tr_b16 v[190:191], v251 offset:15744
    ds_read_b128 v[196:199], v248 offset:11264
    buffer_load_dwordx4 v1, s[32:35], s66 offen offset:1024 lds
    v_exp_f32 v100, v100
    v_cvt_pk_bf16_f32 v120, v96, v97
    v_exp_f32 v101, v101
    v_cvt_pk_bf16_f32 v121, v98, v99
    v_exp_f32 v102, v102
    v_exp_f32 v103, v103
    v_mfma_f32_32x32x16_bf16 v[80:95], v[200:203], v[72:75], v[80:95]
    buffer_load_dwordx4 v1, s[32:35], s66 offen offset:2048 lds
    v_exp_f32 v104, v104
    v_cvt_pk_bf16_f32 v122, v100, v101
    v_exp_f32 v105, v105
    v_cvt_pk_bf16_f32 v123, v102, v103
    v_exp_f32 v106, v106
    v_exp_f32 v107, v107
    v_mfma_f32_32x32x16_bf16 v[128:143], v[180:183], v[116:119], v[128:143]
    buffer_load_dwordx4 v1, s[32:35], s66 offen offset:3072 lds
    v_exp_f32 v108, v108
    v_cvt_pk_bf16_f32 v124, v104, v105
    v_exp_f32 v109, v109
    v_cvt_pk_bf16_f32 v125, v106, v107
    v_exp_f32 v110, v110
    v_exp_f32 v111, v111
    s_waitcnt lgkmcnt(0)
    v_mfma_f32_32x32x16_bf16 v[144:159], v[184:187], v[120:123], v[144:159]
    ds_read_b64_tr_b16 v[176:177], v250 offset:10240
    ds_read_b64_tr_b16 v[178:179], v250 offset:10368
    ds_read_b64_tr_b16 v[180:181], v250 offset:10496
    v_exp_f32 v80, v80
    v_cvt_pk_bf16_f32 v126, v108, v109
    v_exp_f32 v81, v81
    v_cvt_pk_bf16_f32 v127, v110, v111
    v_exp_f32 v82, v82
    v_exp_f32 v83, v83
    v_mfma_f32_32x32x16_bf16 v[96:111], v[196:199], v[68:71], 0
    ds_read_b64_tr_b16 v[182:183], v250 offset:10624
    ds_read_b128 v[192:195], v248 offset:5120
    ds_read_b128 v[204:207], v249 offset:5120
    s_add_u32 m0, s67, 112640
    s_add_u32 s66, s66, 4096
    buffer_load_dwordx4 v1, s[32:35], s66 offen lds
    v_exp_f32 v84, v84
    v_cvt_pk_bf16_f32 v112, v80, v81
    v_exp_f32 v85, v85
    v_cvt_pk_bf16_f32 v113, v82, v83
    v_exp_f32 v86, v86
    v_exp_f32 v87, v87
    v_mfma_f32_32x32x16_bf16 v[96:111], v[200:203], v[76:79], v[96:111]
    buffer_load_dwordx4 v1, s[32:35], s66 offen offset:1024 lds
    v_exp_f32 v88, v88
    v_cvt_pk_bf16_f32 v114, v84, v85
    v_exp_f32 v89, v89
    v_cvt_pk_bf16_f32 v115, v86, v87
    v_exp_f32 v90, v90
    v_exp_f32 v91, v91
    v_mfma_f32_32x32x16_bf16 v[144:159], v[188:191], v[124:127], v[144:159]
    s_mul_i32 s67, s38, 7168
    s_min_u32 s67, s67, 18432
    s_add_u32 s66, s67, s89
    s_add_u32 m0, s67, 63488
    s_add_u32 s66, s66, 46860288
    buffer_load_dwordx4 v1, s[32:35], s66 offen lds
    v_exp_f32 v92, v92
    v_cvt_pk_bf16_f32 v116, v88, v89
    v_exp_f32 v93, v93
    v_cvt_pk_bf16_f32 v117, v90, v91
    v_exp_f32 v94, v94
    v_exp_f32 v95, v95
    s_waitcnt lgkmcnt(0)
    v_mfma_f32_32x32x16_bf16 v[128:143], v[176:179], v[112:115], v[128:143]
    ds_read_b64_tr_b16 v[184:185], v251 offset:10240
    ds_read_b64_tr_b16 v[186:187], v251 offset:10368
    ds_read_b64_tr_b16 v[188:189], v251 offset:10496
    v_exp_f32 v96, v96
    v_cvt_pk_bf16_f32 v118, v92, v93
    v_exp_f32 v97, v97
    v_cvt_pk_bf16_f32 v119, v94, v95
    v_exp_f32 v98, v98
    v_exp_f32 v99, v99
    v_mfma_f32_32x32x16_bf16 v[80:95], v[192:195], v[64:67], 0
    ds_read_b64_tr_b16 v[190:191], v251 offset:10624
    ds_read_b128 v[196:199], v248 offset:6144
    buffer_load_dwordx4 v1, s[32:35], s66 offen offset:1024 lds
    v_exp_f32 v100, v100
    v_cvt_pk_bf16_f32 v120, v96, v97
    v_exp_f32 v101, v101
    v_cvt_pk_bf16_f32 v121, v98, v99
    v_exp_f32 v102, v102
    v_exp_f32 v103, v103
    v_mfma_f32_32x32x16_bf16 v[80:95], v[204:207], v[72:75], v[80:95]
    buffer_load_dwordx4 v1, s[32:35], s66 offen offset:2048 lds
    v_exp_f32 v104, v104
    v_cvt_pk_bf16_f32 v122, v100, v101
    v_exp_f32 v105, v105
    v_cvt_pk_bf16_f32 v123, v102, v103
    v_exp_f32 v106, v106
    v_exp_f32 v107, v107
    v_mfma_f32_32x32x16_bf16 v[128:143], v[180:183], v[116:119], v[128:143]
    buffer_load_dwordx4 v1, s[32:35], s66 offen offset:3072 lds
    v_exp_f32 v108, v108
    v_cvt_pk_bf16_f32 v124, v104, v105
    v_exp_f32 v109, v109
    v_cvt_pk_bf16_f32 v125, v106, v107
    v_exp_f32 v110, v110
    v_exp_f32 v111, v111
    s_waitcnt lgkmcnt(0)
    v_mfma_f32_32x32x16_bf16 v[144:159], v[184:187], v[120:123], v[144:159]
    ds_read_b64_tr_b16 v[176:177], v250 offset:5120
    ds_read_b64_tr_b16 v[178:179], v250 offset:5248
    ds_read_b64_tr_b16 v[180:181], v250 offset:5376
    v_exp_f32 v80, v80
    v_cvt_pk_bf16_f32 v126, v108, v109
    v_exp_f32 v81, v81
    v_cvt_pk_bf16_f32 v127, v110, v111
    v_exp_f32 v82, v82
    v_exp_f32 v83, v83
    v_mfma_f32_32x32x16_bf16 v[96:111], v[196:199], v[68:71], 0
    ds_read_b64_tr_b16 v[182:183], v250 offset:5504
    ds_read_b128 v[192:195], v248 offset:0
    ds_read_b128 v[200:203], v249 offset:0
    s_add_u32 m0, s67, 67584
    s_add_u32 s66, s66, 4096
    buffer_load_dwordx4 v1, s[32:35], s66 offen lds
    v_exp_f32 v84, v84
    v_cvt_pk_bf16_f32 v112, v80, v81
    v_exp_f32 v85, v85
    v_cvt_pk_bf16_f32 v113, v82, v83
    v_exp_f32 v86, v86
    v_exp_f32 v87, v87
    v_mfma_f32_32x32x16_bf16 v[96:111], v[204:207], v[76:79], v[96:111]
    buffer_load_dwordx4 v1, s[32:35], s66 offen offset:1024 lds
    v_exp_f32 v88, v88
    v_cvt_pk_bf16_f32 v114, v84, v85
    v_exp_f32 v89, v89
    v_cvt_pk_bf16_f32 v115, v86, v87
    v_exp_f32 v90, v90
    v_exp_f32 v91, v91
    v_mfma_f32_32x32x16_bf16 v[144:159], v[188:191], v[124:127], v[144:159]
    buffer_load_dwordx4 v1, s[32:35], s66 offen offset:2048 lds
    v_exp_f32 v92, v92
    v_cvt_pk_bf16_f32 v116, v88, v89
    v_exp_f32 v93, v93
    v_cvt_pk_bf16_f32 v117, v90, v91
    v_exp_f32 v94, v94
    v_exp_f32 v95, v95
    s_waitcnt lgkmcnt(0)
    v_mfma_f32_32x32x16_bf16 v[128:143], v[176:179], v[112:115], v[128:143]
    ds_read_b64_tr_b16 v[184:185], v251 offset:5120
    ds_read_b64_tr_b16 v[186:187], v251 offset:5248
    ds_read_b64_tr_b16 v[188:189], v251 offset:5376
    v_exp_f32 v96, v96
    v_cvt_pk_bf16_f32 v118, v92, v93
    v_exp_f32 v97, v97
    v_cvt_pk_bf16_f32 v119, v94, v95
    v_exp_f32 v98, v98
    v_exp_f32 v99, v99
    v_mfma_f32_32x32x16_bf16 v[80:95], v[192:195], v[64:67], v[160:175]
    ds_read_b64_tr_b16 v[190:191], v251 offset:5504
    ds_read_b128 v[196:199], v248 offset:1024
    buffer_load_dword v42, v43, s[32:35], 0 offen sc1
    v_exp_f32 v100, v100
    v_cvt_pk_bf16_f32 v120, v96, v97
    v_exp_f32 v101, v101
    v_cvt_pk_bf16_f32 v121, v98, v99
    v_exp_f32 v102, v102
    v_exp_f32 v103, v103
    v_mfma_f32_32x32x16_bf16 v[80:95], v[200:203], v[72:75], v[80:95]
    buffer_load_dword v42, v2, s[24:27], 0 offen sc1
    v_exp_f32 v104, v104
    v_cvt_pk_bf16_f32 v122, v100, v101
    v_exp_f32 v105, v105
    v_cvt_pk_bf16_f32 v123, v102, v103
    v_exp_f32 v106, v106
    v_exp_f32 v107, v107
    v_mfma_f32_32x32x16_bf16 v[128:143], v[180:183], v[116:119], v[128:143]
    v_exp_f32 v108, v108
    v_cvt_pk_bf16_f32 v124, v104, v105
    v_exp_f32 v109, v109
    v_cvt_pk_bf16_f32 v125, v106, v107
    v_exp_f32 v110, v110
    v_exp_f32 v111, v111
    s_waitcnt lgkmcnt(0)
    v_mfma_f32_32x32x16_bf16 v[144:159], v[184:187], v[120:123], v[144:159]
    ds_read_b64_tr_b16 v[176:177], v250 offset:0
    ds_read_b64_tr_b16 v[178:179], v250 offset:128
    ds_read_b64_tr_b16 v[180:181], v250 offset:256
    v_exp_f32 v80, v80
    v_cvt_pk_bf16_f32 v126, v108, v109
    v_exp_f32 v81, v81
    v_cvt_pk_bf16_f32 v127, v110, v111
    v_exp_f32 v82, v82
    v_exp_f32 v83, v83
    v_mfma_f32_32x32x16_bf16 v[96:111], v[196:199], v[68:71], v[160:175]
    ds_read_b64_tr_b16 v[182:183], v250 offset:384
    v_exp_f32 v84, v84
    v_cvt_pk_bf16_f32 v112, v80, v81
    v_exp_f32 v85, v85
    v_cvt_pk_bf16_f32 v113, v82, v83
    v_exp_f32 v86, v86
    v_exp_f32 v87, v87
    v_mfma_f32_32x32x16_bf16 v[96:111], v[200:203], v[76:79], v[96:111]
    v_exp_f32 v88, v88
    v_cvt_pk_bf16_f32 v114, v84, v85
    v_exp_f32 v89, v89
    v_cvt_pk_bf16_f32 v115, v86, v87
    v_exp_f32 v90, v90
    v_exp_f32 v91, v91
    v_mfma_f32_32x32x16_bf16 v[144:159], v[188:191], v[124:127], v[144:159]
    v_exp_f32 v92, v92
    v_cvt_pk_bf16_f32 v116, v88, v89
    v_exp_f32 v93, v93
    v_cvt_pk_bf16_f32 v117, v90, v91
    v_exp_f32 v94, v94
    v_exp_f32 v95, v95
    s_waitcnt lgkmcnt(0)
    v_mfma_f32_32x32x16_bf16 v[128:143], v[176:179], v[112:115], v[128:143]
    ds_read_b64_tr_b16 v[184:185], v251 offset:0
    ds_read_b64_tr_b16 v[186:187], v251 offset:128
    ds_read_b64_tr_b16 v[188:189], v251 offset:256
    v_exp_f32 v96, v96
    v_cvt_pk_bf16_f32 v118, v92, v93
    v_exp_f32 v97, v97
    v_cvt_pk_bf16_f32 v119, v94, v95
    v_exp_f32 v98, v98
    v_exp_f32 v99, v99
    ds_read_b64_tr_b16 v[190:191], v251 offset:384
    v_exp_f32 v100, v100
    v_cvt_pk_bf16_f32 v120, v96, v97
    v_exp_f32 v101, v101
    v_cvt_pk_bf16_f32 v121, v98, v99
    v_exp_f32 v102, v102
    v_exp_f32 v103, v103
    v_exp_f32 v104, v104
    v_cvt_pk_bf16_f32 v122, v100, v101
    v_exp_f32 v105, v105
    v_cvt_pk_bf16_f32 v123, v102, v103
    v_exp_f32 v106, v106
    v_exp_f32 v107, v107
    v_mfma_f32_32x32x16_bf16 v[128:143], v[180:183], v[116:119], v[128:143]
    v_exp_f32 v108, v108
    v_cvt_pk_bf16_f32 v124, v104, v105
    v_exp_f32 v109, v109
    v_cvt_pk_bf16_f32 v125, v106, v107
    v_exp_f32 v110, v110
    v_exp_f32 v111, v111
    s_waitcnt lgkmcnt(2)
    v_mfma_f32_32x32x16_bf16 v[144:159], v[184:187], v[120:123], v[144:159]
    v_cvt_pk_bf16_f32 v126, v108, v109
    v_cvt_pk_bf16_f32 v127, v110, v111
    s_waitcnt lgkmcnt(0)
    s_nop 0
    v_mfma_f32_32x32x16_bf16 v[144:159], v[188:191], v[124:127], v[144:159]
    v_rcp_f32 v142, v140
    v_mov_b32 v24, s44
    v_pk_mul_f32 v[128:129], v[128:129], v[142:143] op_sel_hi:[1,0]
    v_pk_mul_f32 v[130:131], v[130:131], v[142:143] op_sel_hi:[1,0]
    v_pk_mul_f32 v[132:133], v[132:133], v[142:143] op_sel_hi:[1,0]
    v_pk_mul_f32 v[134:135], v[134:135], v[142:143] op_sel_hi:[1,0]
    v_pk_mul_f32 v[136:137], v[136:137], v[142:143] op_sel_hi:[1,0]
    v_cvt_pk_bf16_f32 v28, v128, v129
    v_cvt_pk_bf16_f32 v29, v130, v131
    v_cvt_pk_bf16_f32 v30, v132, v133
    v_cvt_pk_bf16_f32 v31, v134, v135
    v_cvt_pk_bf16_f32 v36, v136, v137
    v_rcp_f32 v158, v156
    v_min_u32 v26, v140, v156
    v_max_u32 v25, v140, v156
    v_cmp_gt_u32 vcc, 0x12800000, v26
    v_pk_mul_f32 v[144:145], v[144:145], v[158:159] op_sel_hi:[1,0]
    v_pk_mul_f32 v[146:147], v[146:147], v[158:159] op_sel_hi:[1,0]
    s_mov_b64 s[56:57], vcc
    v_cmp_lt_u32 vcc, 0x6c800000, v25
    v_pk_mul_f32 v[148:149], v[148:149], v[158:159] op_sel_hi:[1,0]
    v_pk_mul_f32 v[150:151], v[150:151], v[158:159] op_sel_hi:[1,0]
    v_pk_mul_f32 v[154:155], v[154:155], v[158:159] op_sel_hi:[1,0]
    v_cvt_pk_bf16_f32 v32, v144, v145
    v_cvt_pk_bf16_f32 v33, v146, v147
    v_cvt_pk_bf16_f32 v34, v148, v149
    v_cvt_pk_bf16_f32 v35, v150, v151
    v_cvt_pk_bf16_f32 v37, v154, v155
    s_or_b64 vcc, vcc, s[56:57]
    s_cbranch_scc1 L_fallback3
L_attn_done3:
    s_cmp_eq_u32 s41, 0
    s_cbranch_scc1 slow_61
    buffer_store_dwordx4 v[28:31], v14, s[32:35], s47 offen
    buffer_store_dwordx4 v[32:35], v14, s[32:35], s47 offen offset:512
    buffer_store_dwordx2 v[36:37], v15, s[32:35], s47 offen
join_62:
    s_mov_b32 s55, 0
    s_waitcnt vmcnt(5)
    s_barrier
    ds_read_b128 a[0:3], v38 offset:0
    ds_read_b128 a[4:7], v38 offset:1024
    ds_read_b128 a[8:11], v38 offset:2048
    ds_read_b128 a[12:15], v38 offset:3072
    ds_read_b128 a[16:19], v39 offset:16384
    ds_read_b128 a[20:23], v38 offset:4096
    ds_read_b128 a[24:27], v38 offset:5120
    ds_read_b128 a[28:31], v38 offset:6144
    ds_read_b128 a[32:35], v38 offset:7168
    ds_read_b128 a[36:39], v38 offset:8192
    ds_read_b128 a[40:43], v38 offset:9216
    ds_read_b128 a[44:47], v38 offset:10240
    ds_read_b128 a[48:51], v38 offset:11264
    ds_read_b128 a[52:55], v39 offset:17408
    ds_read_b128 a[56:59], v38 offset:12288
    ds_read_b128 a[60:63], v38 offset:13312
    ds_read_b128 a[64:67], v38 offset:14336
    ds_read_b128 a[68:71], v38 offset:15360
    ds_read_b128 a[72:75], v38 offset:16384
    ds_read_b128 a[76:79], v38 offset:17408
    s_cmp_eq_u32 s41, 0
    s_cbranch_scc1 slow_63
    s_waitcnt vmcnt(0)
    buffer_store_dword v24, v23, s[32:35], s50 offen
join_64:
L_mark3:
    ds_read_b128 a[80:83], v38 offset:18432
    ds_read_b128 a[84:87], v38 offset:19456
    ds_read_b128 a[88:91], v39 offset:18432
    ds_read_b128 a[92:95], v38 offset:20480
    ds_read_b128 a[96:99], v38 offset:21504
    ds_read_b128 a[100:103], v38 offset:22528
    ds_read_b128 a[104:107], v38 offset:23552
    ds_read_b128 a[108:111], v38 offset:24576
    ds_read_b128 a[112:115], v38 offset:25600
    ds_read_b128 a[116:119], v38 offset:26624
    ds_read_b128 a[120:123], v38 offset:27648
    ds_read_b128 a[124:127], v39 offset:19456
    ds_read_b128 a[128:131], v38 offset:28672
    ds_read_b128 a[132:135], v38 offset:29696
    ds_read_b128 a[136:139], v38 offset:30720
    ds_read_b128 a[140:143], v38 offset:31744
    ds_read_b128 a[144:147], v38 offset:32768
    ds_read_b128 a[148:151], v38 offset:33792
    ds_read_b128 a[152:155], v38 offset:34816
    ds_read_b128 a[156:159], v38 offset:35840
    s_add_u32 s57, s48, 4096
    s_add_u32 s58, s48, 8192
    s_add_u32 s59, s48, 12288
    s_add_u32 s60, s48, 16384
poll_65:
    buffer_load_dword v24, v17, s[32:35], 0 offen sc1
    s_sub_u32 s43, s43, 1
    s_cselect_b64 s[68:69], 0, -1
    s_max_i32 s43, s43, 0
    s_waitcnt vmcnt(0)
    v_cmp_ne_u32 vcc, s44, v24
    s_and_b64 vcc, vcc, s[68:69]
    s_cbranch_scc1 poll_65
    buffer_load_dwordx4 v[184:187], v1, s[32:35], s48 offen offset:0 sc1
    ds_read_b128 a[160:163], v39 offset:20480
    ds_read_b128 a[164:167], v38 offset:36864
    ds_read_b128 a[168:171], v38 offset:37888
    buffer_load_dwordx4 v[188:191], v1, s[32:35], s48 offen offset:1024 sc1
    ds_read_b128 a[172:175], v38 offset:38912
    ds_read_b128 a[176:179], v38 offset:39936
    ds_read_b128 a[180:183], v38 offset:40960
    buffer_load_dwordx4 v[192:195], v1, s[32:35], s48 offen offset:2048 sc1
    ds_read_b128 a[184:187], v38 offset:41984
    ds_read_b128 a[188:191], v38 offset:43008
    ds_read_b128 a[192:195], v38 offset:44032
    buffer_load_dwordx4 v[196:199], v1, s[32:35], s48 offen offset:3072 sc1
    ds_read_b128 a[196:199], v39 offset:21504
    ds_read_b128 a[200:203], v38 offset:45056
    ds_read_b128 a[204:207], v38 offset:46080
    buffer_load_dwordx4 v[200:203], v1, s[32:35], s57 offen offset:0 sc1
    ds_read_b128 v[68:71], v38 offset:47104
    ds_read_b128 v[72:75], v38 offset:48128
    ds_read_b128 v[76:79], v38 offset:49152
    buffer_load_dwordx4 v[204:207], v1, s[32:35], s57 offen offset:1024 sc1
    ds_read_b128 v[80:83], v38 offset:50176
    ds_read_b128 v[84:87], v38 offset:51200
    ds_read_b128 v[88:91], v38 offset:52224
    buffer_load_dwordx4 v[208:211], v1, s[32:35], s57 offen offset:2048 sc1
    ds_read_b128 v[92:95], v39 offset:22528
    ds_read_b128 v[96:99], v38 offset:53248
    s_waitcnt vmcnt(6) lgkmcnt(15)
    v_mfma_f32_16x16x32_bf16 v[44:47], a[0:3], v[184:187], v[44:47]
    buffer_load_dwordx4 v[212:215], v1, s[32:35], s57 offen offset:3072 sc1
    ds_read_b128 v[100:103], v38 offset:54272
    v_mfma_f32_16x16x32_bf16 v[48:51], a[4:7], v[184:187], v[48:51]
    v_mfma_f32_16x16x32_bf16 v[52:55], a[8:11], v[184:187], v[52:55]
    ds_read_b128 v[104:107], v38 offset:55296
    v_mfma_f32_16x16x32_bf16 v[56:59], a[12:15], v[184:187], v[56:59]
    v_mfma_f32_16x16x32_bf16 v[60:63], a[16:19], v[184:187], v[60:63]
    buffer_load_dwordx4 v[216:219], v1, s[32:35], s58 offen offset:0 sc1
    s_waitcnt vmcnt(7)
    v_mfma_f32_16x16x32_bf16 v[44:47], a[20:23], v[188:191], v[44:47]
    ds_read_b128 v[108:111], v38 offset:56320
    v_mfma_f32_16x16x32_bf16 v[48:51], a[24:27], v[188:191], v[48:51]
    v_mfma_f32_16x16x32_bf16 v[52:55], a[28:31], v[188:191], v[52:55]
    v_mfma_f32_16x16x32_bf16 v[56:59], a[32:35], v[188:191], v[56:59]
    buffer_load_dwordx4 v[220:223], v1, s[32:35], s58 offen offset:1024 sc1
    ds_read_b128 v[112:115], v39 offset:0
    v_mfma_f32_16x16x32_bf16 v[64:67], a[16:19], v[188:191], 0
    s_waitcnt vmcnt(7)
    v_mfma_f32_16x16x32_bf16 v[44:47], a[36:39], v[192:195], v[44:47]
    v_mfma_f32_16x16x32_bf16 v[48:51], a[40:43], v[192:195], v[48:51]
    ds_read_b128 v[116:119], v39 offset:1024
    v_mfma_f32_16x16x32_bf16 v[52:55], a[44:47], v[192:195], v[52:55]
    buffer_load_dwordx4 v[224:227], v1, s[32:35], s58 offen offset:2048 sc1
    v_mfma_f32_16x16x32_bf16 v[56:59], a[48:51], v[192:195], v[56:59]
    v_mfma_f32_16x16x32_bf16 v[60:63], a[52:55], v[192:195], v[60:63]
    ds_read_b128 v[120:123], v39 offset:2048
    s_waitcnt vmcnt(7)
    v_mfma_f32_16x16x32_bf16 v[44:47], a[56:59], v[196:199], v[44:47]
    v_mfma_f32_16x16x32_bf16 v[48:51], a[60:63], v[196:199], v[48:51]
    buffer_load_dwordx4 v[228:231], v1, s[32:35], s58 offen offset:3072 sc1
    v_mfma_f32_16x16x32_bf16 v[52:55], a[64:67], v[196:199], v[52:55]
    ds_read_b128 v[124:127], v39 offset:3072
    v_mfma_f32_16x16x32_bf16 v[56:59], a[68:71], v[196:199], v[56:59]
    v_mfma_f32_16x16x32_bf16 v[64:67], a[52:55], v[196:199], v[64:67]
    s_waitcnt vmcnt(7)
    v_mfma_f32_16x16x32_bf16 v[44:47], a[72:75], v[200:203], v[44:47]
    buffer_load_dwordx4 v[232:235], v1, s[32:35], s59 offen offset:0 sc1
    ds_read_b128 v[128:131], v39 offset:23552
    v_mfma_f32_16x16x32_bf16 v[48:51], a[76:79], v[200:203], v[48:51]
    v_mfma_f32_16x16x32_bf16 v[52:55], a[80:83], v[200:203], v[52:55]
    v_mfma_f32_16x16x32_bf16 v[56:59], a[84:87], v[200:203], v[56:59]
    ds_read_b128 v[132:135], v39 offset:4096
    v_mfma_f32_16x16x32_bf16 v[60:63], a[88:91], v[200:203], v[60:63]
    buffer_load_dwordx4 v[236:239], v1, s[32:35], s59 offen offset:1024 sc1
    s_waitcnt vmcnt(8)
    v_mfma_f32_16x16x32_bf16 v[44:47], a[92:95], v[204:207], v[44:47]
    v_mfma_f32_16x16x32_bf16 v[48:51], a[96:99], v[204:207], v[48:51]
    ds_read_b128 v[136:139], v39 offset:5120
    v_mfma_f32_16x16x32_bf16 v[52:55], a[100:103], v[204:207], v[52:55]
    v_mfma_f32_16x16x32_bf16 v[56:59], a[104:107], v[204:207], v[56:59]
    buffer_load_dwordx4 v[240:243], v1, s[32:35], s59 offen offset:2048 sc1
    v_mfma_f32_16x16x32_bf16 v[64:67], a[88:91], v[204:207], v[64:67]
    ds_read_b128 v[140:143], v39 offset:6144
    s_waitcnt vmcnt(8)
    v_mfma_f32_16x16x32_bf16 v[44:47], a[108:111], v[208:211], v[44:47]
    v_mfma_f32_16x16x32_bf16 v[48:51], a[112:115], v[208:211], v[48:51]
    v_mfma_f32_16x16x32_bf16 v[52:55], a[116:119], v[208:211], v[52:55]
    buffer_load_dwordx4 v[244:247], v1, s[32:35], s59 offen offset:3072 sc1
    ds_read_b128 v[144:147], v39 offset:7168
    v_mfma_f32_16x16x32_bf16 v[56:59], a[120:123], v[208:211], v[56:59]
    v_mfma_f32_16x16x32_bf16 v[60:63], a[124:127], v[208:211], v[60:63]
    s_waitcnt vmcnt(8)
    v_mfma_f32_16x16x32_bf16 v[44:47], a[128:131], v[212:215], v[44:47]
    ds_read_b128 v[148:151], v39 offset:8192
    v_mfma_f32_16x16x32_bf16 v[48:51], a[132:135], v[212:215], v[48:51]
    buffer_load_dwordx4 v[248:251], v1, s[32:35], s60 offen offset:0 sc1
    v_mfma_f32_16x16x32_bf16 v[52:55], a[136:139], v[212:215], v[52:55]
    v_mfma_f32_16x16x32_bf16 v[56:59], a[140:143], v[212:215], v[56:59]
    ds_read_b128 v[152:155], v39 offset:9216
    v_mfma_f32_16x16x32_bf16 v[64:67], a[124:127], v[212:215], v[64:67]
    s_waitcnt vmcnt(8)
    v_mfma_f32_16x16x32_bf16 v[44:47], a[144:147], v[216:219], v[44:47]
    buffer_load_dwordx4 v[252:255], v1, s[32:35], s60 offen offset:1024 sc1
    v_mfma_f32_16x16x32_bf16 v[48:51], a[148:151], v[216:219], v[48:51]
    ds_read_b128 v[156:159], v39 offset:10240
    v_mfma_f32_16x16x32_bf16 v[52:55], a[152:155], v[216:219], v[52:55]
    s_mul_i32 s63, s38, 2304
    s_add_u32 s63, s63, 0
    v_mfma_f32_16x16x32_bf16 v[56:59], a[156:159], v[216:219], v[56:59]
    v_and_b32 v28, 15, v0
    v_mfma_f32_16x16x32_bf16 v[60:63], a[160:163], v[216:219], v[60:63]
    ds_read_b128 v[160:163], v39 offset:11264
    s_waitcnt vmcnt(8)
    v_mfma_f32_16x16x32_bf16 v[44:47], a[164:167], v[220:223], v[44:47]
    v_mul_u32_u24 v28, 144, v28
    v_mfma_f32_16x16x32_bf16 v[48:51], a[168:171], v[220:223], v[48:51]
    v_mfma_f32_16x16x32_bf16 v[52:55], a[172:175], v[220:223], v[52:55]
    ds_read_b128 v[164:167], v39 offset:24576
    v_mfma_f32_16x16x32_bf16 v[56:59], a[176:179], v[220:223], v[56:59]
    v_lshrrev_b32 v29, 4, v0
    v_mfma_f32_16x16x32_bf16 v[64:67], a[160:163], v[220:223], v[64:67]
    s_waitcnt vmcnt(7) lgkmcnt(15)
    v_mfma_f32_16x16x32_bf16 v[44:47], a[180:183], v[224:227], v[44:47]
    ds_read_b128 v[168:171], v39 offset:12288
    v_mfma_f32_16x16x32_bf16 v[48:51], a[184:187], v[224:227], v[48:51]
    v_lshl_add_u32 v28, v29, 3, v28
    v_mfma_f32_16x16x32_bf16 v[52:55], a[188:191], v[224:227], v[52:55]
    v_mfma_f32_16x16x32_bf16 v[56:59], a[192:195], v[224:227], v[56:59]
    ds_read_b128 v[172:175], v39 offset:13312
    v_mfma_f32_16x16x32_bf16 v[60:63], a[196:199], v[224:227], v[60:63]
    v_add_u32 v28, s63, v28
    s_waitcnt vmcnt(6)
    v_mfma_f32_16x16x32_bf16 v[44:47], a[200:203], v[228:231], v[44:47]
    v_mfma_f32_16x16x32_bf16 v[48:51], a[204:207], v[228:231], v[48:51]
    ds_read_b128 v[176:179], v39 offset:14336
    v_add_u32 v29, s63, v1
    v_mfma_f32_16x16x32_bf16 v[52:55], v[68:71], v[228:231], v[52:55]
    v_mfma_f32_16x16x32_bf16 v[56:59], v[72:75], v[228:231], v[56:59]
    v_mfma_f32_16x16x32_bf16 v[64:67], a[196:199], v[228:231], v[64:67]
    ds_read_b128 v[180:183], v39 offset:15360
    s_waitcnt vmcnt(5)
    v_mfma_f32_16x16x32_bf16 v[44:47], v[76:79], v[232:235], v[44:47]
    s_add_u32 s61, s54, 8064
    v_mfma_f32_16x16x32_bf16 v[48:51], v[80:83], v[232:235], v[48:51]
    v_mfma_f32_16x16x32_bf16 v[52:55], v[84:87], v[232:235], v[52:55]
    s_add_u32 s62, s54, 16128
    v_mfma_f32_16x16x32_bf16 v[56:59], v[88:91], v[232:235], v[56:59]
    v_mfma_f32_16x16x32_bf16 v[60:63], v[92:95], v[232:235], v[60:63]
    s_waitcnt vmcnt(4) lgkmcnt(15)
    v_mfma_f32_16x16x32_bf16 v[44:47], v[96:99], v[236:239], v[44:47]
    v_mov_b32 v24, s44
    v_mfma_f32_16x16x32_bf16 v[48:51], v[100:103], v[236:239], v[48:51]
    v_mfma_f32_16x16x32_bf16 v[52:55], v[104:107], v[236:239], v[52:55]
    v_mfma_f32_16x16x32_bf16 v[56:59], v[108:111], v[236:239], v[56:59]
    v_mfma_f32_16x16x32_bf16 v[64:67], v[92:95], v[236:239], v[64:67]
    s_waitcnt vmcnt(0)
    s_waitcnt lgkmcnt(0)
    v_mfma_f32_16x16x32_bf16 v[60:63], v[128:131], v[240:243], v[60:63]
    v_mfma_f32_16x16x32_bf16 v[64:67], v[128:131], v[244:247], v[64:67]
    v_mfma_f32_16x16x32_bf16 v[60:63], v[164:167], v[248:251], v[60:63]
    v_mfma_f32_16x16x32_bf16 v[64:67], v[164:167], v[252:255], v[64:67]
    s_nop 1
    v_mfma_f32_16x16x32_bf16 v[44:47], v[112:115], v[240:243], v[44:47]
    s_nop 1
    v_mfma_f32_16x16x32_bf16 v[44:47], v[132:135], v[244:247], v[44:47]
    s_nop 1
    v_mfma_f32_16x16x32_bf16 v[44:47], v[148:151], v[248:251], v[44:47]
    v_permlane32_swap_b32 v64, v68
    v_permlane32_swap_b32 v65, v69
    v_mfma_f32_16x16x32_bf16 v[44:47], v[168:171], v[252:255], v[44:47]
    v_permlane32_swap_b32 v66, v70
    v_mfma_f32_16x16x32_bf16 v[48:51], v[116:119], v[240:243], v[48:51]
    v_permlane32_swap_b32 v67, v71
    v_add_f32 v60, v60, v68
    v_mfma_f32_16x16x32_bf16 v[48:51], v[136:139], v[244:247], v[48:51]
    v_add_f32 v61, v61, v69
    v_mfma_f32_16x16x32_bf16 v[48:51], v[152:155], v[248:251], v[48:51]
    v_add_f32 v62, v62, v70
    v_mfma_f32_16x16x32_bf16 v[48:51], v[172:175], v[252:255], v[48:51]
    v_add_f32 v63, v63, v71
    v_cvt_pk_bf16_f32 v192, v60, v61
    v_mfma_f32_16x16x32_bf16 v[52:55], v[120:123], v[240:243], v[52:55]
    v_cvt_pk_bf16_f32 v193, v62, v63
    v_mfma_f32_16x16x32_bf16 v[52:55], v[140:143], v[244:247], v[52:55]
    s_mov_b32 exec_hi, 0
    ds_write_b64 v28, v[192:193] offset:128
    s_mov_b32 exec_hi, -1
    v_cvt_pk_bf16_f32 v184, v44, v45
    v_cvt_pk_bf16_f32 v185, v46, v47
    v_mfma_f32_16x16x32_bf16 v[52:55], v[156:159], v[248:251], v[52:55]
    ds_write_b64 v28, v[184:185] offset:0
    v_mfma_f32_16x16x32_bf16 v[52:55], v[176:179], v[252:255], v[52:55]
    v_cvt_pk_bf16_f32 v186, v48, v49
    v_mfma_f32_16x16x32_bf16 v[56:59], v[124:127], v[240:243], v[56:59]
    v_cvt_pk_bf16_f32 v187, v50, v51
    v_mfma_f32_16x16x32_bf16 v[56:59], v[144:147], v[244:247], v[56:59]
    ds_write_b64 v28, v[186:187] offset:32
    v_mfma_f32_16x16x32_bf16 v[56:59], v[160:163], v[248:251], v[56:59]
    s_nop 1
    v_mfma_f32_16x16x32_bf16 v[56:59], v[180:183], v[252:255], v[56:59]
    v_cvt_pk_bf16_f32 v188, v52, v53
    v_cvt_pk_bf16_f32 v189, v54, v55
    ds_write_b64 v28, v[188:189] offset:64
    s_nop 4
    v_cvt_pk_bf16_f32 v190, v56, v57
    v_cvt_pk_bf16_f32 v191, v58, v59
    ds_write_b64 v28, v[190:191] offset:96
    s_mov_b32 exec_hi, 0x7fffffff
    ds_read_b128 v[80:83], v29 offset:0
    ds_read_b128 v[84:87], v29 offset:1008
    ds_read_b128 v[88:91], v29 offset:2016
    s_cmp_eq_u32 s41, 0
    s_cbranch_scc1 slow_66
    s_waitcnt lgkmcnt(2)
    buffer_store_dwordx4 v[80:83], v20, s[24:27], s54 offen
    s_waitcnt lgkmcnt(1)
    buffer_store_dwordx4 v[84:87], v20, s[24:27], s61 offen
    s_mov_b64 exec, 0x3ffff
    s_waitcnt lgkmcnt(0)
    buffer_store_dwordx4 v[88:91], v20, s[24:27], s62 offen
join_67:
    s_mov_b64 exec, -1
L_end:
    s_endpgm
L_cold:
L_fallback1:
    s_cmp_lg_u32 s55, 0
    s_cbranch_scc1 L_attn_done1
    s_mov_b32 s55, 1
    v_mov_b32 v24, 0xff61b1e6
    v_mov_b32 v25, 0xff61b1e6
    s_sub_u32 s56, 8, s38
    s_cmp_lt_u32 s36, 2
    s_cselect_b32 s56, s56, 0
L_fb1_7:
    s_cmp_gt_u32 s56, 7
    s_cbranch_scc1 L_fb1_3
    ds_read_b128 v[200:203], v19 offset:35840
    ds_read_b128 v[192:195], v3 offset:35840
    s_waitcnt lgkmcnt(0)
    v_mfma_f32_32x32x16_bf16 v[80:95], v[192:195], v[64:67], 0
    v_mfma_f32_32x32x16_bf16 v[80:95], v[200:203], v[72:75], v[80:95]
    ds_read_b128 v[196:199], v3 offset:36864
    s_waitcnt lgkmcnt(0)
    v_mfma_f32_32x32x16_bf16 v[96:111], v[196:199], v[68:71], 0
    v_mfma_f32_32x32x16_bf16 v[96:111], v[200:203], v[76:79], v[96:111]
    s_nop 7
    v_max3_f32 v24, v24, v80, v81
    v_max3_f32 v24, v24, v82, v83
    v_max3_f32 v24, v24, v84, v85
    v_max3_f32 v24, v24, v86, v87
    v_max3_f32 v24, v24, v88, v89
    v_max3_f32 v24, v24, v90, v91
    v_max3_f32 v24, v24, v92, v93
    v_max3_f32 v24, v24, v94, v95
    v_max3_f32 v25, v25, v96, v97
    v_max3_f32 v25, v25, v98, v99
    v_max3_f32 v25, v25, v100, v101
    v_max3_f32 v25, v25, v102, v103
    v_max3_f32 v25, v25, v104, v105
    v_max3_f32 v25, v25, v106, v107
    v_max3_f32 v25, v25, v108, v109
    v_max3_f32 v25, v25, v110, v111
    s_nop 2
L_fb1_6:
    s_cmp_gt_u32 s56, 6
    s_cbranch_scc1 L_fb1_3
    ds_read_b128 v[200:203], v19 offset:30720
    ds_read_b128 v[192:195], v3 offset:30720
    s_waitcnt lgkmcnt(0)
    v_mfma_f32_32x32x16_bf16 v[80:95], v[192:195], v[64:67], 0
    v_mfma_f32_32x32x16_bf16 v[80:95], v[200:203], v[72:75], v[80:95]
    ds_read_b128 v[196:199], v3 offset:31744
    s_waitcnt lgkmcnt(0)
    v_mfma_f32_32x32x16_bf16 v[96:111], v[196:199], v[68:71], 0
    v_mfma_f32_32x32x16_bf16 v[96:111], v[200:203], v[76:79], v[96:111]
    s_nop 7
    v_max3_f32 v24, v24, v80, v81
    v_max3_f32 v24, v24, v82, v83
    v_max3_f32 v24, v24, v84, v85
    v_max3_f32 v24, v24, v86, v87
    v_max3_f32 v24, v24, v88, v89
    v_max3_f32 v24, v24, v90, v91
    v_max3_f32 v24, v24, v92, v93
    v_max3_f32 v24, v24, v94, v95
    v_max3_f32 v25, v25, v96, v97
    v_max3_f32 v25, v25, v98, v99
    v_max3_f32 v25, v25, v100, v101
    v_max3_f32 v25, v25, v102, v103
    v_max3_f32 v25, v25, v104, v105
    v_max3_f32 v25, v25, v106, v107
    v_max3_f32 v25, v25, v108, v109
    v_max3_f32 v25, v25, v110, v111
    s_nop 2
L_fb1_5:
    s_cmp_gt_u32 s56, 5
    s_cbranch_scc1 L_fb1_3
    ds_read_b128 v[200:203], v19 offset:25600
    ds_read_b128 v[192:195], v3 offset:25600
    s_waitcnt lgkmcnt(0)
    v_mfma_f32_32x32x16_bf16 v[80:95], v[192:195], v[64:67], 0
    v_mfma_f32_32x32x16_bf16 v[80:95], v[200:203], v[72:75], v[80:95]
    ds_read_b128 v[196:199], v3 offset:26624
    s_waitcnt lgkmcnt(0)
    v_mfma_f32_32x32x16_bf16 v[96:111], v[196:199], v[68:71], 0
    v_mfma_f32_32x32x16_bf16 v[96:111], v[200:203], v[76:79], v[96:111]
    s_nop 7
    v_max3_f32 v24, v24, v80, v81
    v_max3_f32 v24, v24, v82, v83
    v_max3_f32 v24, v24, v84, v85
    v_max3_f32 v24, v24, v86, v87
    v_max3_f32 v24, v24, v88, v89
    v_max3_f32 v24, v24, v90, v91
    v_max3_f32 v24, v24, v92, v93
    v_max3_f32 v24, v24, v94, v95
    v_max3_f32 v25, v25, v96, v97
    v_max3_f32 v25, v25, v98, v99
    v_max3_f32 v25, v25, v100, v101
    v_max3_f32 v25, v25, v102, v103
    v_max3_f32 v25, v25, v104, v105
    v_max3_f32 v25, v25, v106, v107
    v_max3_f32 v25, v25, v108, v109
    v_max3_f32 v25, v25, v110, v111
    s_nop 2
L_fb1_4:
    s_cmp_gt_u32 s56, 4
    s_cbranch_scc1 L_fb1_3
    ds_read_b128 v[200:203], v19 offset:20480
    ds_read_b128 v[192:195], v3 offset:20480
    s_waitcnt lgkmcnt(0)
    v_mfma_f32_32x32x16_bf16 v[80:95], v[192:195], v[64:67], v[232:247]
    v_mfma_f32_32x32x16_bf16 v[80:95], v[200:203], v[72:75], v[80:95]
    ds_read_b128 v[196:199], v3 offset:21504
    s_waitcnt lgkmcnt(0)
    v_mfma_f32_32x32x16_bf16 v[96:111], v[196:199], v[68:71], v[232:247]
    v_mfma_f32_32x32x16_bf16 v[96:111], v[200:203], v[76:79], v[96:111]
    s_nop 7
    v_max3_f32 v24, v24, v80, v81
    v_max3_f32 v24, v24, v82, v83
    v_max3_f32 v24, v24, v84, v85
    v_max3_f32 v24, v24, v86, v87
    v_max3_f32 v24, v24, v88, v89
    v_max3_f32 v24, v24, v90, v91
    v_max3_f32 v24, v24, v92, v93
    v_max3_f32 v24, v24, v94, v95
    v_max3_f32 v25, v25, v96, v97
    v_max3_f32 v25, v25, v98, v99
    v_max3_f32 v25, v25, v100, v101
    v_max3_f32 v25, v25, v102, v103
    v_max3_f32 v25, v25, v104, v105
    v_max3_f32 v25, v25, v106, v107
    v_max3_f32 v25, v25, v108, v109
    v_max3_f32 v25, v25, v110, v111
    s_nop 2
L_fb1_3:
    s_cmp_eq_u32 s36, 0
    s_cbranch_scc1 L_fb1_8
    ds_read_b128 v[200:203], v249 offset:15360
    ds_read_b128 v[192:195], v248 offset:15360
    s_waitcnt lgkmcnt(0)
    v_mfma_f32_32x32x16_bf16 v[80:95], v[192:195], v[64:67], 0
    v_mfma_f32_32x32x16_bf16 v[80:95], v[200:203], v[72:75], v[80:95]
    ds_read_b128 v[196:199], v248 offset:16384
    s_waitcnt lgkmcnt(0)
    v_mfma_f32_32x32x16_bf16 v[96:111], v[196:199], v[68:71], 0
    v_mfma_f32_32x32x16_bf16 v[96:111], v[200:203], v[76:79], v[96:111]
    s_nop 7
    v_max3_f32 v24, v24, v80, v81
    v_max3_f32 v24, v24, v82, v83
    v_max3_f32 v24, v24, v84, v85
    v_max3_f32 v24, v24, v86, v87
    v_max3_f32 v24, v24, v88, v89
    v_max3_f32 v24, v24, v90, v91
    v_max3_f32 v24, v24, v92, v93
    v_max3_f32 v24, v24, v94, v95
    v_max3_f32 v25, v25, v96, v97
    v_max3_f32 v25, v25, v98, v99
    v_max3_f32 v25, v25, v100, v101
    v_max3_f32 v25, v25, v102, v103
    v_max3_f32 v25, v25, v104, v105
    v_max3_f32 v25, v25, v106, v107
    v_max3_f32 v25, v25, v108, v109
    v_max3_f32 v25, v25, v110, v111
    s_nop 2
L_fb1_2:
    ds_read_b128 v[200:203], v249 offset:10240
    ds_read_b128 v[192:195], v248 offset:10240
    s_waitcnt lgkmcnt(0)
    v_mfma_f32_32x32x16_bf16 v[80:95], v[192:195], v[64:67], 0
    v_mfma_f32_32x32x16_bf16 v[80:95], v[200:203], v[72:75], v[80:95]
    ds_read_b128 v[196:199], v248 offset:11264
    s_waitcnt lgkmcnt(0)
    v_mfma_f32_32x32x16_bf16 v[96:111], v[196:199], v[68:71], 0
    v_mfma_f32_32x32x16_bf16 v[96:111], v[200:203], v[76:79], v[96:111]
    s_nop 7
    v_max3_f32 v24, v24, v80, v81
    v_max3_f32 v24, v24, v82, v83
    v_max3_f32 v24, v24, v84, v85
    v_max3_f32 v24, v24, v86, v87
    v_max3_f32 v24, v24, v88, v89
    v_max3_f32 v24, v24, v90, v91
    v_max3_f32 v24, v24, v92, v93
    v_max3_f32 v24, v24, v94, v95
    v_max3_f32 v25, v25, v96, v97
    v_max3_f32 v25, v25, v98, v99
    v_max3_f32 v25, v25, v100, v101
    v_max3_f32 v25, v25, v102, v103
    v_max3_f32 v25, v25, v104, v105
    v_max3_f32 v25, v25, v106, v107
    v_max3_f32 v25, v25, v108, v109
    v_max3_f32 v25, v25, v110, v111
    s_nop 2
L_fb1_1:
    ds_read_b128 v[200:203], v249 offset:5120
    ds_read_b128 v[192:195], v248 offset:5120
    s_waitcnt lgkmcnt(0)
    v_mfma_f32_32x32x16_bf16 v[80:95], v[192:195], v[64:67], 0
    v_mfma_f32_32x32x16_bf16 v[80:95], v[200:203], v[72:75], v[80:95]
    ds_read_b128 v[196:199], v248 offset:6144
    s_waitcnt lgkmcnt(0)
    v_mfma_f32_32x32x16_bf16 v[96:111], v[196:199], v[68:71], 0
    v_mfma_f32_32x32x16_bf16 v[96:111], v[200:203], v[76:79], v[96:111]
    s_nop 7
    v_max3_f32 v24, v24, v80, v81
    v_max3_f32 v24, v24, v82, v83
    v_max3_f32 v24, v24, v84, v85
    v_max3_f32 v24, v24, v86, v87
    v_max3_f32 v24, v24, v88, v89
    v_max3_f32 v24, v24, v90, v91
    v_max3_f32 v24, v24, v92, v93
    v_max3_f32 v24, v24, v94, v95
    v_max3_f32 v25, v25, v96, v97
    v_max3_f32 v25, v25, v98, v99
    v_max3_f32 v25, v25, v100, v101
    v_max3_f32 v25, v25, v102, v103
    v_max3_f32 v25, v25, v104, v105
    v_max3_f32 v25, v25, v106, v107
    v_max3_f32 v25, v25, v108, v109
    v_max3_f32 v25, v25, v110, v111
    s_nop 2
L_fb1_0:
    ds_read_b128 v[200:203], v249 offset:0
    ds_read_b128 v[192:195], v248 offset:0
    s_waitcnt lgkmcnt(0)
    v_mfma_f32_32x32x16_bf16 v[80:95], v[192:195], v[64:67], v[160:175]
    v_mfma_f32_32x32x16_bf16 v[80:95], v[200:203], v[72:75], v[80:95]
    ds_read_b128 v[196:199], v248 offset:1024
    s_waitcnt lgkmcnt(0)
    v_mfma_f32_32x32x16_bf16 v[96:111], v[196:199], v[68:71], v[160:175]
    v_mfma_f32_32x32x16_bf16 v[96:111], v[200:203], v[76:79], v[96:111]
    s_nop 7
    v_max3_f32 v24, v24, v80, v81
    v_max3_f32 v24, v24, v82, v83
    v_max3_f32 v24, v24, v84, v85
    v_max3_f32 v24, v24, v86, v87
    v_max3_f32 v24, v24, v88, v89
    v_max3_f32 v24, v24, v90, v91
    v_max3_f32 v24, v24, v92, v93
    v_max3_f32 v24, v24, v94, v95
    v_max3_f32 v25, v25, v96, v97
    v_max3_f32 v25, v25, v98, v99
    v_max3_f32 v25, v25, v100, v101
    v_max3_f32 v25, v25, v102, v103
    v_max3_f32 v25, v25, v104, v105
    v_max3_f32 v25, v25, v106, v107
    v_max3_f32 v25, v25, v108, v109
    v_max3_f32 v25, v25, v110, v111
    s_nop 2
L_fb1_8:
    v_add_f32 v160, v160, v232
    v_add_f32 v161, v161, v233
    v_add_f32 v162, v162, v234
    v_add_f32 v163, v163, v235
    v_add_f32 v164, v164, v236
    v_add_f32 v165, v165, v237
    v_add_f32 v166, v166, v238
    v_add_f32 v167, v167, v239
    v_add_f32 v168, v168, v240
    v_add_f32 v169, v169, v241
    v_add_f32 v170, v170, v242
    v_add_f32 v171, v171, v243
    v_add_f32 v172, v172, v244
    v_add_f32 v173, v173, v245
    v_add_f32 v174, v174, v246
    v_add_f32 v175, v175, v247
    v_sub_f32 v160, 0xf149f2ca, v160
    v_sub_f32 v161, 0xf149f2ca, v161
    v_sub_f32 v162, 0xf149f2ca, v162
    v_sub_f32 v163, 0xf149f2ca, v163
    v_sub_f32 v164, 0xf149f2ca, v164
    v_sub_f32 v165, 0xf149f2ca, v165
    v_sub_f32 v166, 0xf149f2ca, v166
    v_sub_f32 v167, 0xf149f2ca, v167
    v_sub_f32 v168, 0xf149f2ca, v168
    v_sub_f32 v169, 0xf149f2ca, v169
    v_sub_f32 v170, 0xf149f2ca, v170
    v_sub_f32 v171, 0xf149f2ca, v171
    v_sub_f32 v172, 0xf149f2ca, v172
    v_sub_f32 v173, 0xf149f2ca, v173
    v_sub_f32 v174, 0xf149f2ca, v174
    v_sub_f32 v175, 0xf149f2ca, v175
    ds_read_b128 v[200:203], v19 offset:40960
    ds_read_b128 v[192:195], v3 offset:40960
    s_waitcnt lgkmcnt(0)
    v_mfma_f32_32x32x16_bf16 v[80:95], v[192:195], v[64:67], v[160:175]
    v_mfma_f32_32x32x16_bf16 v[80:95], v[200:203], v[72:75], v[80:95]
    ds_read_b128 v[196:199], v3 offset:41984
    s_waitcnt lgkmcnt(0)
    v_mfma_f32_32x32x16_bf16 v[96:111], v[196:199], v[68:71], v[160:175]
    v_mfma_f32_32x32x16_bf16 v[96:111], v[200:203], v[76:79], v[96:111]
    s_nop 7
    v_max3_f32 v24, v24, v80, v81
    v_max3_f32 v24, v24, v82, v83
    v_max3_f32 v24, v24, v84, v85
    v_max3_f32 v24, v24, v86, v87
    v_max3_f32 v24, v24, v88, v89
    v_max3_f32 v24, v24, v90, v91
    v_max3_f32 v24, v24, v92, v93
    v_max3_f32 v24, v24, v94, v95
    v_max3_f32 v25, v25, v96, v97
    v_max3_f32 v25, v25, v98, v99
    v_max3_f32 v25, v25, v100, v101
    v_max3_f32 v25, v25, v102, v103
    v_max3_f32 v25, v25, v104, v105
    v_max3_f32 v25, v25, v106, v107
    v_max3_f32 v25, v25, v108, v109
    v_max3_f32 v25, v25, v110, v111
    v_mov_b32 v26, v24
    s_nop 1
    v_permlane32_swap_b32 v24, v26
    v_max_f32 v26, v24, v26
    v_sub_f32 v26, 0, v26
    v_and_b32 v27, 0xffff0000, v26
    v_sub_f32 v26, v26, v27
    v_and_b32 v28, 0xffff0000, v26
    v_sub_f32 v26, v26, v28
    v_lshrrev_b32 v27, 16, v27
    v_or_b32 v27, v27, v28
    v_lshrrev_b32 v26, 16, v26
    v_cndmask_b32 v74, v26, v27, s[70:71]
    v_mov_b32 v26, v25
    s_nop 1
    v_permlane32_swap_b32 v25, v26
    v_max_f32 v26, v25, v26
    v_sub_f32 v26, 0, v26
    v_and_b32 v27, 0xffff0000, v26
    v_sub_f32 v26, v26, v27
    v_and_b32 v28, 0xffff0000, v26
    v_sub_f32 v26, v26, v28
    v_lshrrev_b32 v27, 16, v27
    v_or_b32 v27, v27, v28
    v_lshrrev_b32 v26, 16, v26
    v_cndmask_b32 v78, v26, v27, s[70:71]
    ds_read_b128 v[192:195], v3 offset:40960
    ds_read_b128 v[200:203], v19 offset:40960
    ds_read_b128 v[196:199], v3 offset:41984
    ds_read_b64_tr_b16 v[176:177], v4 offset:40960
    ds_read_b64_tr_b16 v[178:179], v4 offset:41088
    ds_read_b64_tr_b16 v[180:181], v4 offset:41216
    ds_read_b64_tr_b16 v[182:183], v4 offset:41344
    s_waitcnt lgkmcnt(6)
    v_mfma_f32_32x32x16_bf16 v[80:95], v[192:195], v[64:67], v[160:175]
    s_waitcnt lgkmcnt(5)
    v_mfma_f32_32x32x16_bf16 v[80:95], v[200:203], v[72:75], v[80:95]
    s_waitcnt lgkmcnt(0)
    s_nop 10
    s_branch L_rerun1
L_fallback3:
    s_cmp_lg_u32 s55, 0
    s_cbranch_scc1 L_attn_done3
    s_mov_b32 s55, 1
    v_mov_b32 v24, 0xff61b1e6
    v_mov_b32 v25, 0xff61b1e6
    s_sub_u32 s56, 8, s38
    s_cmp_lt_u32 s36, 2
    s_cselect_b32 s56, s56, 0
L_fb3_7:
    s_cmp_gt_u32 s56, 7
    s_cbranch_scc1 L_fb3_3
    ds_read_b128 v[200:203], v19 offset:35840
    ds_read_b128 v[192:195], v3 offset:35840
    s_waitcnt lgkmcnt(0)
    v_mfma_f32_32x32x16_bf16 v[80:95], v[192:195], v[64:67], 0
    v_mfma_f32_32x32x16_bf16 v[80:95], v[200:203], v[72:75], v[80:95]
    ds_read_b128 v[196:199], v3 offset:36864
    s_waitcnt lgkmcnt(0)
    v_mfma_f32_32x32x16_bf16 v[96:111], v[196:199], v[68:71], 0
    v_mfma_f32_32x32x16_bf16 v[96:111], v[200:203], v[76:79], v[96:111]
    s_nop 7
    v_max3_f32 v24, v24, v80, v81
    v_max3_f32 v24, v24, v82, v83
    v_max3_f32 v24, v24, v84, v85
    v_max3_f32 v24, v24, v86, v87
    v_max3_f32 v24, v24, v88, v89
    v_max3_f32 v24, v24, v90, v91
    v_max3_f32 v24, v24, v92, v93
    v_max3_f32 v24, v24, v94, v95
    v_max3_f32 v25, v25, v96, v97
    v_max3_f32 v25, v25, v98, v99
    v_max3_f32 v25, v25, v100, v101
    v_max3_f32 v25, v25, v102, v103
    v_max3_f32 v25, v25, v104, v105
    v_max3_f32 v25, v25, v106, v107
    v_max3_f32 v25, v25, v108, v109
    v_max3_f32 v25, v25, v110, v111
    s_nop 2
L_fb3_6:
    s_cmp_gt_u32 s56, 6
    s_cbranch_scc1 L_fb3_3
    ds_read_b128 v[200:203], v19 offset:30720
    ds_read_b128 v[192:195], v3 offset:30720
    s_waitcnt lgkmcnt(0)
    v_mfma_f32_32x32x16_bf16 v[80:95], v[192:195], v[64:67], 0
    v_mfma_f32_32x32x16_bf16 v[80:95], v[200:203], v[72:75], v[80:95]
    ds_read_b128 v[196:199], v3 offset:31744
    s_waitcnt lgkmcnt(0)
    v_mfma_f32_32x32x16_bf16 v[96:111], v[196:199], v[68:71], 0
    v_mfma_f32_32x32x16_bf16 v[96:111], v[200:203], v[76:79], v[96:111]
    s_nop 7
    v_max3_f32 v24, v24, v80, v81
    v_max3_f32 v24, v24, v82, v83
    v_max3_f32 v24, v24, v84, v85
    v_max3_f32 v24, v24, v86, v87
    v_max3_f32 v24, v24, v88, v89
    v_max3_f32 v24, v24, v90, v91
    v_max3_f32 v24, v24, v92, v93
    v_max3_f32 v24, v24, v94, v95
    v_max3_f32 v25, v25, v96, v97
    v_max3_f32 v25, v25, v98, v99
    v_max3_f32 v25, v25, v100, v101
    v_max3_f32 v25, v25, v102, v103
    v_max3_f32 v25, v25, v104, v105
    v_max3_f32 v25, v25, v106, v107
    v_max3_f32 v25, v25, v108, v109
    v_max3_f32 v25, v25, v110, v111
    s_nop 2
L_fb3_5:
    s_cmp_gt_u32 s56, 5
    s_cbranch_scc1 L_fb3_3
    ds_read_b128 v[200:203], v19 offset:25600
    ds_read_b128 v[192:195], v3 offset:25600
    s_waitcnt lgkmcnt(0)
    v_mfma_f32_32x32x16_bf16 v[80:95], v[192:195], v[64:67], 0
    v_mfma_f32_32x32x16_bf16 v[80:95], v[200:203], v[72:75], v[80:95]
    ds_read_b128 v[196:199], v3 offset:26624
    s_waitcnt lgkmcnt(0)
    v_mfma_f32_32x32x16_bf16 v[96:111], v[196:199], v[68:71], 0
    v_mfma_f32_32x32x16_bf16 v[96:111], v[200:203], v[76:79], v[96:111]
    s_nop 7
    v_max3_f32 v24, v24, v80, v81
    v_max3_f32 v24, v24, v82, v83
    v_max3_f32 v24, v24, v84, v85
    v_max3_f32 v24, v24, v86, v87
    v_max3_f32 v24, v24, v88, v89
    v_max3_f32 v24, v24, v90, v91
    v_max3_f32 v24, v24, v92, v93
    v_max3_f32 v24, v24, v94, v95
    v_max3_f32 v25, v25, v96, v97
    v_max3_f32 v25, v25, v98, v99
    v_max3_f32 v25, v25, v100, v101
    v_max3_f32 v25, v25, v102, v103
    v_max3_f32 v25, v25, v104, v105
    v_max3_f32 v25, v25, v106, v107
    v_max3_f32 v25, v25, v108, v109
    v_max3_f32 v25, v25, v110, v111
    s_nop 2
L_fb3_4:
    s_cmp_gt_u32 s56, 4
    s_cbranch_scc1 L_fb3_3
    ds_read_b128 v[200:203], v19 offset:20480
    ds_read_b128 v[192:195], v3 offset:20480
    s_waitcnt lgkmcnt(0)
    v_mfma_f32_32x32x16_bf16 v[80:95], v[192:195], v[64:67], v[232:247]
    v_mfma_f32_32x32x16_bf16 v[80:95], v[200:203], v[72:75], v[80:95]
    ds_read_b128 v[196:199], v3 offset:21504
    s_waitcnt lgkmcnt(0)
    v_mfma_f32_32x32x16_bf16 v[96:111], v[196:199], v[68:71], v[232:247]
    v_mfma_f32_32x32x16_bf16 v[96:111], v[200:203], v[76:79], v[96:111]
    s_nop 7
    v_max3_f32 v24, v24, v80, v81
    v_max3_f32 v24, v24, v82, v83
    v_max3_f32 v24, v24, v84, v85
    v_max3_f32 v24, v24, v86, v87
    v_max3_f32 v24, v24, v88, v89
    v_max3_f32 v24, v24, v90, v91
    v_max3_f32 v24, v24, v92, v93
    v_max3_f32 v24, v24, v94, v95
    v_max3_f32 v25, v25, v96, v97
    v_max3_f32 v25, v25, v98, v99
    v_max3_f32 v25, v25, v100, v101
    v_max3_f32 v25, v25, v102, v103
    v_max3_f32 v25, v25, v104, v105
    v_max3_f32 v25, v25, v106, v107
    v_max3_f32 v25, v25, v108, v109
    v_max3_f32 v25, v25, v110, v111
    s_nop 2
L_fb3_3:
    s_cmp_eq_u32 s36, 0
    s_cbranch_scc1 L_fb3_8
    ds_read_b128 v[200:203], v249 offset:15360
    ds_read_b128 v[192:195], v248 offset:15360
    s_waitcnt lgkmcnt(0)
    v_mfma_f32_32x32x16_bf16 v[80:95], v[192:195], v[64:67], 0
    v_mfma_f32_32x32x16_bf16 v[80:95], v[200:203], v[72:75], v[80:95]
    ds_read_b128 v[196:199], v248 offset:16384
    s_waitcnt lgkmcnt(0)
    v_mfma_f32_32x32x16_bf16 v[96:111], v[196:199], v[68:71], 0
    v_mfma_f32_32x32x16_bf16 v[96:111], v[200:203], v[76:79], v[96:111]
    s_nop 7
    v_max3_f32 v24, v24, v80, v81
    v_max3_f32 v24, v24, v82, v83
    v_max3_f32 v24, v24, v84, v85
    v_max3_f32 v24, v24, v86, v87
    v_max3_f32 v24, v24, v88, v89
    v_max3_f32 v24, v24, v90, v91
    v_max3_f32 v24, v24, v92, v93
    v_max3_f32 v24, v24, v94, v95
    v_max3_f32 v25, v25, v96, v97
    v_max3_f32 v25, v25, v98, v99
    v_max3_f32 v25, v25, v100, v101
    v_max3_f32 v25, v25, v102, v103
    v_max3_f32 v25, v25, v104, v105
    v_max3_f32 v25, v25, v106, v107
    v_max3_f32 v25, v25, v108, v109
    v_max3_f32 v25, v25, v110, v111
    s_nop 2
L_fb3_2:
    ds_read_b128 v[200:203], v249 offset:10240
    ds_read_b128 v[192:195], v248 offset:10240
    s_waitcnt lgkmcnt(0)
    v_mfma_f32_32x32x16_bf16 v[80:95], v[192:195], v[64:67], 0
    v_mfma_f32_32x32x16_bf16 v[80:95], v[200:203], v[72:75], v[80:95]
    ds_read_b128 v[196:199], v248 offset:11264
    s_waitcnt lgkmcnt(0)
    v_mfma_f32_32x32x16_bf16 v[96:111], v[196:199], v[68:71], 0
    v_mfma_f32_32x32x16_bf16 v[96:111], v[200:203], v[76:79], v[96:111]
    s_nop 7
    v_max3_f32 v24, v24, v80, v81
    v_max3_f32 v24, v24, v82, v83
    v_max3_f32 v24, v24, v84, v85
    v_max3_f32 v24, v24, v86, v87
    v_max3_f32 v24, v24, v88, v89
    v_max3_f32 v24, v24, v90, v91
    v_max3_f32 v24, v24, v92, v93
    v_max3_f32 v24, v24, v94, v95
    v_max3_f32 v25, v25, v96, v97
    v_max3_f32 v25, v25, v98, v99
    v_max3_f32 v25, v25, v100, v101
    v_max3_f32 v25, v25, v102, v103
    v_max3_f32 v25, v25, v104, v105
    v_max3_f32 v25, v25, v106, v107
    v_max3_f32 v25, v25, v108, v109
    v_max3_f32 v25, v25, v110, v111
    s_nop 2
L_fb3_1:
    ds_read_b128 v[200:203], v249 offset:5120
    ds_read_b128 v[192:195], v248 offset:5120
    s_waitcnt lgkmcnt(0)
    v_mfma_f32_32x32x16_bf16 v[80:95], v[192:195], v[64:67], 0
    v_mfma_f32_32x32x16_bf16 v[80:95], v[200:203], v[72:75], v[80:95]
    ds_read_b128 v[196:199], v248 offset:6144
    s_waitcnt lgkmcnt(0)
    v_mfma_f32_32x32x16_bf16 v[96:111], v[196:199], v[68:71], 0
    v_mfma_f32_32x32x16_bf16 v[96:111], v[200:203], v[76:79], v[96:111]
    s_nop 7
    v_max3_f32 v24, v24, v80, v81
    v_max3_f32 v24, v24, v82, v83
    v_max3_f32 v24, v24, v84, v85
    v_max3_f32 v24, v24, v86, v87
    v_max3_f32 v24, v24, v88, v89
    v_max3_f32 v24, v24, v90, v91
    v_max3_f32 v24, v24, v92, v93
    v_max3_f32 v24, v24, v94, v95
    v_max3_f32 v25, v25, v96, v97
    v_max3_f32 v25, v25, v98, v99
    v_max3_f32 v25, v25, v100, v101
    v_max3_f32 v25, v25, v102, v103
    v_max3_f32 v25, v25, v104, v105
    v_max3_f32 v25, v25, v106, v107
    v_max3_f32 v25, v25, v108, v109
    v_max3_f32 v25, v25, v110, v111
    s_nop 2
L_fb3_0:
    ds_read_b128 v[200:203], v249 offset:0
    ds_read_b128 v[192:195], v248 offset:0
    s_waitcnt lgkmcnt(0)
    v_mfma_f32_32x32x16_bf16 v[80:95], v[192:195], v[64:67], v[160:175]
    v_mfma_f32_32x32x16_bf16 v[80:95], v[200:203], v[72:75], v[80:95]
    ds_read_b128 v[196:199], v248 offset:1024
    s_waitcnt lgkmcnt(0)
    v_mfma_f32_32x32x16_bf16 v[96:111], v[196:199], v[68:71], v[160:175]
    v_mfma_f32_32x32x16_bf16 v[96:111], v[200:203], v[76:79], v[96:111]
    s_nop 7
    v_max3_f32 v24, v24, v80, v81
    v_max3_f32 v24, v24, v82, v83
    v_max3_f32 v24, v24, v84, v85
    v_max3_f32 v24, v24, v86, v87
    v_max3_f32 v24, v24, v88, v89
    v_max3_f32 v24, v24, v90, v91
    v_max3_f32 v24, v24, v92, v93
    v_max3_f32 v24, v24, v94, v95
    v_max3_f32 v25, v25, v96, v97
    v_max3_f32 v25, v25, v98, v99
    v_max3_f32 v25, v25, v100, v101
    v_max3_f32 v25, v25, v102, v103
    v_max3_f32 v25, v25, v104, v105
    v_max3_f32 v25, v25, v106, v107
    v_max3_f32 v25, v25, v108, v109
    v_max3_f32 v25, v25, v110, v111
    s_nop 2
L_fb3_8:
    v_add_f32 v160, v160, v232
    v_add_f32 v161, v161, v233
    v_add_f32 v162, v162, v234
    v_add_f32 v163, v163, v235
    v_add_f32 v164, v164, v236
    v_add_f32 v165, v165, v237
    v_add_f32 v166, v166, v238
    v_add_f32 v167, v167, v239
    v_add_f32 v168, v168, v240
    v_add_f32 v169, v169, v241
    v_add_f32 v170, v170, v242
    v_add_f32 v171, v171, v243
    v_add_f32 v172, v172, v244
    v_add_f32 v173, v173, v245
    v_add_f32 v174, v174, v246
    v_add_f32 v175, v175, v247
    v_sub_f32 v160, 0xf149f2ca, v160
    v_sub_f32 v161, 0xf149f2ca, v161
    v_sub_f32 v162, 0xf149f2ca, v162
    v_sub_f32 v163, 0xf149f2ca, v163
    v_sub_f32 v164, 0xf149f2ca, v164
    v_sub_f32 v165, 0xf149f2ca, v165
    v_sub_f32 v166, 0xf149f2ca, v166
    v_sub_f32 v167, 0xf149f2ca, v167
    v_sub_f32 v168, 0xf149f2ca, v168
    v_sub_f32 v169, 0xf149f2ca, v169
    v_sub_f32 v170, 0xf149f2ca, v170
    v_sub_f32 v171, 0xf149f2ca, v171
    v_sub_f32 v172, 0xf149f2ca, v172
    v_sub_f32 v173, 0xf149f2ca, v173
    v_sub_f32 v174, 0xf149f2ca, v174
    v_sub_f32 v175, 0xf149f2ca, v175
    ds_read_b128 v[200:203], v19 offset:40960
    ds_read_b128 v[192:195], v3 offset:40960
    s_waitcnt lgkmcnt(0)
    v_mfma_f32_32x32x16_bf16 v[80:95], v[192:195], v[64:67], v[160:175]
    v_mfma_f32_32x32x16_bf16 v[80:95], v[200:203], v[72:75], v[80:95]
    ds_read_b128 v[196:199], v3 offset:41984
    s_waitcnt lgkmcnt(0)
    v_mfma_f32_32x32x16_bf16 v[96:111], v[196:199], v[68:71], v[160:175]
    v_mfma_f32_32x32x16_bf16 v[96:111], v[200:203], v[76:79], v[96:111]
    s_nop 7
    v_max3_f32 v24, v24, v80, v81
    v_max3_f32 v24, v24, v82, v83
    v_max3_f32 v24, v24, v84, v85
    v_max3_f32 v24, v24, v86, v87
    v_max3_f32 v24, v24, v88, v89
    v_max3_f32 v24, v24, v90, v91
    v_max3_f32 v24, v24, v92, v93
    v_max3_f32 v24, v24, v94, v95
    v_max3_f32 v25, v25, v96, v97
    v_max3_f32 v25, v25, v98, v99
    v_max3_f32 v25, v25, v100, v101
    v_max3_f32 v25, v25, v102, v103
    v_max3_f32 v25, v25, v104, v105
    v_max3_f32 v25, v25, v106, v107
    v_max3_f32 v25, v25, v108, v109
    v_max3_f32 v25, v25, v110, v111
    v_mov_b32 v26, v24
    s_nop 1
    v_permlane32_swap_b32 v24, v26
    v_max_f32 v26, v24, v26
    v_sub_f32 v26, 0, v26
    v_and_b32 v27, 0xffff0000, v26
    v_sub_f32 v26, v26, v27
    v_and_b32 v28, 0xffff0000, v26
    v_sub_f32 v26, v26, v28
    v_lshrrev_b32 v27, 16, v27
    v_or_b32 v27, v27, v28
    v_lshrrev_b32 v26, 16, v26
    v_cndmask_b32 v74, v26, v27, s[70:71]
    v_mov_b32 v26, v25
    s_nop 1
    v_permlane32_swap_b32 v25, v26
    v_max_f32 v26, v25, v26
    v_sub_f32 v26, 0, v26
    v_and_b32 v27, 0xffff0000, v26
    v_sub_f32 v26, v26, v27
    v_and_b32 v28, 0xffff0000, v26
    v_sub_f32 v26, v26, v28
    v_lshrrev_b32 v27, 16, v27
    v_or_b32 v27, v27, v28
    v_lshrrev_b32 v26, 16, v26
    v_cndmask_b32 v78, v26, v27, s[70:71]
    ds_read_b128 v[192:195], v3 offset:40960
    ds_read_b128 v[200:203], v19 offset:40960
    ds_read_b128 v[196:199], v3 offset:41984
    ds_read_b64_tr_b16 v[176:177], v4 offset:40960
    ds_read_b64_tr_b16 v[178:179], v4 offset:41088
    ds_read_b64_tr_b16 v[180:181], v4 offset:41216
    ds_read_b64_tr_b16 v[182:183], v4 offset:41344
    s_waitcnt lgkmcnt(6)
    v_mfma_f32_32x32x16_bf16 v[80:95], v[192:195], v[64:67], v[160:175]
    s_waitcnt lgkmcnt(5)
    v_mfma_f32_32x32x16_bf16 v[80:95], v[200:203], v[72:75], v[80:95]
    s_waitcnt lgkmcnt(0)
    s_nop 10
    s_branch L_rerun3
L_goslow:
    buffer_store_dword v64, v65, s[32:35], s99 offen offset:3712 sc1
    buffer_wbl2 sc1
    s_waitcnt vmcnt(0)
    s_mov_b64 s[4:5], s[32:33]
    s_mov_b32 s6, 67108864
    s_mov_b32 s41, 0
    s_mov_b32 s3, 303104
    s_add_u32 s45, s45, s3
    s_add_u32 s46, s46, s3
    s_add_u32 s47, s47, s3
    s_add_u32 s48, s48, s3
    s_add_u32 s49, s49, 1024
    s_add_u32 s50, s50, 1024
    v_add_u32 v16, 1024, v16
    v_add_u32 v17, 1024, v17
    s_lshl_b32 s56, s39, 11
    s_add_u32 s56, s56, s46
    buffer_store_dwordx4 v[140:143], v1, s[32:35], s56 offen sc1
    buffer_store_dwordx4 v[144:147], v1, s[32:35], s56 offen offset:1024 sc1
    buffer_store_dwordx2 v[148:149], v12, s[32:35], s46 offen sc1
    s_mov_b32 s62, s82
    v_mov_b32 v150, 0
    v_mov_b32 v151, 0
    v_mov_b32 v152, s74
    v_mov_b32 v153, s74
    v_mov_b32 v154, s74
    v_mov_b32 v155, s74
    s_mov_b32 s82, 0x22222222
    s_mov_b32 s83, 0x22222222
    s_mov_b32 s84, 0x44444444
    s_mov_b32 s85, 0x44444444
    s_mov_b32 s86, 0x88888888
    s_mov_b32 s87, 0x88888888
    v_mfma_f32_16x16x32_bf16 v[160:163], v[140:143], v[140:143], 0
    v_mfma_f32_16x16x32_bf16 v[156:159], v[152:155], v[140:143], 0
    v_mfma_f32_16x16x32_bf16 v[160:163], v[144:147], v[144:147], v[160:163]
    v_mfma_f32_16x16x32_bf16 v[156:159], v[152:155], v[144:147], v[156:159]
    v_mfma_f32_16x16x32_bf16 v[160:163], v[148:151], v[148:151], v[160:163]
    v_mfma_f32_16x16x32_bf16 v[156:159], v[152:155], v[148:151], v[156:159]
    v_mov_b32 v26, s44
    s_nop 5
    v_cndmask_b32 v160, v160, v161, s[82:83]
    v_cndmask_b32 v160, v160, v162, s[84:85]
    v_cndmask_b32 v157, v160, v163, s[86:87]
    buffer_store_dwordx2 v[156:157], v13, s[32:35], s46 offen sc1
    s_mov_b32 s82, s62
    s_waitcnt vmcnt(0)
    buffer_store_dword v26, v23, s[32:35], s49 offen sc1
    s_add_u32 s46, s46, s3
poll_8:
    buffer_load_dword v24, v16, s[32:35], 0 offen sc1
    s_sub_u32 s43, s43, 1
    s_cselect_b64 s[68:69], 0, -1
    s_max_i32 s43, s43, 0
    s_waitcnt vmcnt(0)
    v_cmp_ne_u32 vcc, s44, v24
    s_and_b64 vcc, vcc, s[68:69]
    s_cbranch_scc1 poll_8
    s_nop 2
    s_branch L_decided
slow_18:
    buffer_store_dwordx4 v[28:31], v14, s[32:35], s47 offen sc1
    buffer_store_dwordx4 v[32:35], v14, s[32:35], s47 offen offset:512 sc1
    buffer_store_dwordx2 v[36:37], v15, s[32:35], s47 offen sc1
    s_nop 0
    s_branch join_19
slow_20:
    s_waitcnt vmcnt(0)
    buffer_store_dword v24, v23, s[32:35], s50 offen sc1
    s_branch join_21
slow_23:
    v_mfma_f32_16x16x32_bf16 v[60:63], v[140:143], v[240:243], v[60:63]
    v_mfma_f32_16x16x32_bf16 v[64:67], v[140:143], v[244:247], v[64:67]
    v_mfma_f32_16x16x32_bf16 v[60:63], v[176:179], v[248:251], v[60:63]
    v_mfma_f32_16x16x32_bf16 v[64:67], v[176:179], v[252:255], v[64:67]
    v_mov_b32 v194, 0
    v_mov_b32 v195, 0
    v_mfma_f32_16x16x32_bf16 v[44:47], v[124:127], v[240:243], v[44:47]
    v_mov_b32 v196, s74
    v_mov_b32 v197, s74
    v_mfma_f32_16x16x32_bf16 v[44:47], v[144:147], v[244:247], v[44:47]
    v_mov_b32 v198, s74
    v_mov_b32 v199, s74
    v_mfma_f32_16x16x32_bf16 v[44:47], v[160:163], v[248:251], v[44:47]
    v_permlane32_swap_b32 v64, v68
    v_permlane32_swap_b32 v65, v69
    v_mfma_f32_16x16x32_bf16 v[44:47], v[180:183], v[252:255], v[44:47]
    v_permlane32_swap_b32 v66, v70
    v_permlane32_swap_b32 v67, v71
    v_mfma_f32_16x16x32_bf16 v[48:51], v[128:131], v[240:243], v[48:51]
    v_add_f32 v60, v60, v68
    v_mfma_f32_16x16x32_bf16 v[48:51], v[148:151], v[244:247], v[48:51]
    v_add_f32 v61, v61, v69
    v_add_f32 v62, v62, v70
    v_mfma_f32_16x16x32_bf16 v[48:51], v[164:167], v[248:251], v[48:51]
    v_add_f32 v63, v63, v71
    v_cvt_pk_bf16_f32 v192, v60, v61
    v_mfma_f32_16x16x32_bf16 v[48:51], a[0:3], v[252:255], v[48:51]
    v_cvt_pk_bf16_f32 v193, v62, v63
    v_mfma_f32_16x16x32_bf16 v[52:55], v[132:135], v[240:243], v[52:55]
    v_cndmask_b32 v192, 0, v192, s[70:71]
    v_cndmask_b32 v193, 0, v193, s[70:71]
    v_mfma_f32_16x16x32_bf16 v[52:55], v[152:155], v[244:247], v[52:55]
    buffer_store_dwordx2 v[192:193], v12, s[4:7], s61 offen sc1
    v_cvt_pk_bf16_f32 v184, v44, v45
    v_mfma_f32_16x16x32_bf16 v[52:55], v[168:171], v[248:251], v[52:55]
    v_cvt_pk_bf16_f32 v185, v46, v47
    v_mfma_f32_16x16x32_bf16 v[52:55], a[4:7], v[252:255], v[52:55]
    v_cvt_pk_bf16_f32 v186, v48, v49
    v_mfma_f32_16x16x32_bf16 v[56:59], v[136:139], v[240:243], v[56:59]
    v_cvt_pk_bf16_f32 v187, v50, v51
    v_mfma_f32_16x16x32_bf16 v[56:59], v[156:159], v[244:247], v[56:59]
    buffer_store_dwordx4 v[184:187], v1, s[4:7], s56 offen offset:0 sc1
    v_mfma_f32_16x16x32_bf16 v[56:59], v[172:175], v[248:251], v[56:59]
    s_nop 1
    v_mfma_f32_16x16x32_bf16 v[56:59], a[8:11], v[252:255], v[56:59]
    v_cvt_pk_bf16_f32 v188, v52, v53
    v_mfma_f32_16x16x32_bf16 v[204:207], v[192:195], v[192:195], 0
    v_cvt_pk_bf16_f32 v189, v54, v55
    v_mfma_f32_16x16x32_bf16 v[200:203], v[196:199], v[192:195], 0
    s_nop 1
    v_mfma_f32_16x16x32_bf16 v[204:207], v[184:187], v[184:187], v[204:207]
    s_nop 1
    v_mfma_f32_16x16x32_bf16 v[200:203], v[196:199], v[184:187], v[200:203]
    v_cvt_pk_bf16_f32 v190, v56, v57
    v_cvt_pk_bf16_f32 v191, v58, v59
    s_nop 1
    v_mfma_f32_16x16x32_bf16 v[204:207], v[188:191], v[188:191], v[204:207]
    buffer_store_dwordx4 v[188:191], v1, s[4:7], s56 offen offset:1024 sc1
    v_mfma_f32_16x16x32_bf16 v[200:203], v[196:199], v[188:191], v[200:203]
    v_mov_b32 v26, s44
    s_nop 4
    v_cndmask_b32 v204, v204, v205, s[82:83]
    v_cndmask_b32 v204, v204, v206, s[84:85]
    v_cndmask_b32 v201, v204, v207, s[86:87]
    buffer_store_dwordx2 v[200:201], v13, s[32:35], s46 offen sc1
    s_barrier
    s_mul_i32 s67, s38, 8192
    s_min_u32 s67, s67, 23552
    s_add_u32 s66, s67, s75
    s_add_u32 m0, s67, 0
    s_add_u32 s66, s66, 25370624
    buffer_load_dwordx4 v1, s[32:35], s66 offen lds
    buffer_load_dwordx4 v1, s[32:35], s66 offen offset:1024 lds
    buffer_load_dwordx4 v1, s[32:35], s66 offen offset:2048 lds
    s_waitcnt vmcnt(3)
    buffer_store_dword v26, v23, s[32:35], s49 offen sc1
    s_branch join_24
rr_26:
    s_nop 2
    s_waitcnt vmcnt(0) lgkmcnt(0)
    s_nop 15
    s_branch rb_27
rr_30:
    s_nop 2
    s_waitcnt vmcnt(0) lgkmcnt(0)
    s_nop 15
    s_branch rb_31
slow_34:
    buffer_store_dwordx4 v[28:31], v14, s[32:35], s47 offen sc1
    buffer_store_dwordx4 v[32:35], v14, s[32:35], s47 offen offset:512 sc1
    buffer_store_dwordx2 v[36:37], v15, s[32:35], s47 offen sc1
    s_nop 0
    s_branch join_35
slow_36:
    s_waitcnt vmcnt(0)
    buffer_store_dword v24, v23, s[32:35], s50 offen sc1
    s_branch join_37
slow_39:
    v_mfma_f32_16x16x32_bf16 v[60:63], a[8:11], v[240:243], v[60:63]
    v_mfma_f32_16x16x32_bf16 v[64:67], a[8:11], v[244:247], v[64:67]
    v_mfma_f32_16x16x32_bf16 v[60:63], a[44:47], v[248:251], v[60:63]
    v_mfma_f32_16x16x32_bf16 v[64:67], a[44:47], v[252:255], v[64:67]
    v_mov_b32 v194, 0
    v_mov_b32 v195, 0
    v_mfma_f32_16x16x32_bf16 v[44:47], v[176:179], v[240:243], v[44:47]
    v_mov_b32 v196, s74
    v_mov_b32 v197, s74
    v_mfma_f32_16x16x32_bf16 v[44:47], a[12:15], v[244:247], v[44:47]
    v_mov_b32 v198, s74
    v_mov_b32 v199, s74
    v_mfma_f32_16x16x32_bf16 v[44:47], a[28:31], v[248:251], v[44:47]
    v_permlane32_swap_b32 v64, v68
    v_permlane32_swap_b32 v65, v69
    v_mfma_f32_16x16x32_bf16 v[44:47], a[48:51], v[252:255], v[44:47]
    v_permlane32_swap_b32 v66, v70
    v_permlane32_swap_b32 v67, v71
    v_mfma_f32_16x16x32_bf16 v[48:51], v[180:183], v[240:243], v[48:51]
    v_add_f32 v60, v60, v68
    v_mfma_f32_16x16x32_bf16 v[48:51], a[16:19], v[244:247], v[48:51]
    v_add_f32 v61, v61, v69
    v_add_f32 v62, v62, v70
    v_mfma_f32_16x16x32_bf16 v[48:51], a[32:35], v[248:251], v[48:51]
    v_add_f32 v63, v63, v71
    v_cvt_pk_bf16_f32 v192, v60, v61
    v_mfma_f32_16x16x32_bf16 v[48:51], a[52:55], v[252:255], v[48:51]
    v_cvt_pk_bf16_f32 v193, v62, v63
    v_mfma_f32_16x16x32_bf16 v[52:55], a[0:3], v[240:243], v[52:55]
    v_cndmask_b32 v192, 0, v192, s[70:71]
    v_cndmask_b32 v193, 0, v193, s[70:71]
    v_mfma_f32_16x16x32_bf16 v[52:55], a[20:23], v[244:247], v[52:55]
    buffer_store_dwordx2 v[192:193], v12, s[4:7], s61 offen sc1
    v_cvt_pk_bf16_f32 v184, v44, v45
    v_mfma_f32_16x16x32_bf16 v[52:55], a[36:39], v[248:251], v[52:55]
    v_cvt_pk_bf16_f32 v185, v46, v47
    v_mfma_f32_16x16x32_bf16 v[52:55], a[56:59], v[252:255], v[52:55]
    v_cvt_pk_bf16_f32 v186, v48, v49
    v_mfma_f32_16x16x32_bf16 v[56:59], a[4:7], v[240:243], v[56:59]
    v_cvt_pk_bf16_f32 v187, v50, v51
    v_mfma_f32_16x16x32_bf16 v[56:59], a[24:27], v[244:247], v[56:59]
    buffer_store_dwordx4 v[184:187], v1, s[4:7], s56 offen offset:0 sc1
    v_mfma_f32_16x16x32_bf16 v[56:59], a[40:43], v[248:251], v[56:59]
    s_nop 1
    v_mfma_f32_16x16x32_bf16 v[56:59], a[60:63], v[252:255], v[56:59]
    v_cvt_pk_bf16_f32 v188, v52, v53
    v_mfma_f32_16x16x32_bf16 v[204:207], v[192:195], v[192:195], 0
    v_cvt_pk_bf16_f32 v189, v54, v55
    v_mfma_f32_16x16x32_bf16 v[200:203], v[196:199], v[192:195], 0
    s_nop 1
    v_mfma_f32_16x16x32_bf16 v[204:207], v[184:187], v[184:187], v[204:207]
    s_nop 1
    v_mfma_f32_16x16x32_bf16 v[200:203], v[196:199], v[184:187], v[200:203]
    v_cvt_pk_bf16_f32 v190, v56, v57
    v_cvt_pk_bf16_f32 v191, v58, v59
    s_nop 1
    v_mfma_f32_16x16x32_bf16 v[204:207], v[188:191], v[188:191], v[204:207]
    buffer_store_dwordx4 v[188:191], v1, s[4:7], s56 offen offset:1024 sc1
    v_mfma_f32_16x16x32_bf16 v[200:203], v[196:199], v[188:191], v[200:203]
    v_mov_b32 v26, s44
    s_nop 4
    v_cndmask_b32 v204, v204, v205, s[82:83]
    v_cndmask_b32 v204, v204, v206, s[84:85]
    v_cndmask_b32 v201, v204, v207, s[86:87]
    buffer_store_dwordx2 v[200:201], v13, s[32:35], s46 offen sc1
    s_barrier
    ds_write_b128 v40, a[196:199] offset:0
    ds_write_b128 v40, a[200:203] offset:1024
    ds_write_b128 v40, a[204:207] offset:2048
    s_waitcnt vmcnt(0)
    buffer_store_dword v26, v23, s[32:35], s49 offen sc1
    s_branch join_40
slow_45:
    buffer_store_dwordx4 v[28:31], v14, s[32:35], s47 offen sc1
    buffer_store_dwordx4 v[32:35], v14, s[32:35], s47 offen offset:512 sc1
    buffer_store_dwordx2 v[36:37], v15, s[32:35], s47 offen sc1
    s_nop 0
    s_branch join_46
slow_47:
    s_waitcnt vmcnt(0)
    buffer_store_dword v24, v23, s[32:35], s50 offen sc1
    s_branch join_48
slow_50:
    v_mfma_f32_16x16x32_bf16 v[60:63], v[140:143], v[240:243], v[60:63]
    v_mfma_f32_16x16x32_bf16 v[64:67], v[140:143], v[244:247], v[64:67]
    v_mfma_f32_16x16x32_bf16 v[60:63], v[176:179], v[248:251], v[60:63]
    v_mfma_f32_16x16x32_bf16 v[64:67], v[176:179], v[252:255], v[64:67]
    v_mov_b32 v194, 0
    v_mov_b32 v195, 0
    v_mfma_f32_16x16x32_bf16 v[44:47], v[124:127], v[240:243], v[44:47]
    v_mov_b32 v196, s74
    v_mov_b32 v197, s74
    v_mfma_f32_16x16x32_bf16 v[44:47], v[144:147], v[244:247], v[44:47]
    v_mov_b32 v198, s74
    v_mov_b32 v199, s74
    v_mfma_f32_16x16x32_bf16 v[44:47], v[160:163], v[248:251], v[44:47]
    v_permlane32_swap_b32 v64, v68
    v_permlane32_swap_b32 v65, v69
    v_mfma_f32_16x16x32_bf16 v[44:47], v[180:183], v[252:255], v[44:47]
    v_permlane32_swap_b32 v66, v70
    v_permlane32_swap_b32 v67, v71
    v_mfma_f32_16x16x32_bf16 v[48:51], v[128:131], v[240:243], v[48:51]
    v_add_f32 v60, v60, v68
    v_mfma_f32_16x16x32_bf16 v[48:51], v[148:151], v[244:247], v[48:51]
    v_add_f32 v61, v61, v69
    v_add_f32 v62, v62, v70
    v_mfma_f32_16x16x32_bf16 v[48:51], v[164:167], v[248:251], v[48:51]
    v_add_f32 v63, v63, v71
    v_cvt_pk_bf16_f32 v192, v60, v61
    v_mfma_f32_16x16x32_bf16 v[48:51], a[0:3], v[252:255], v[48:51]
    v_cvt_pk_bf16_f32 v193, v62, v63
    v_mfma_f32_16x16x32_bf16 v[52:55], v[132:135], v[240:243], v[52:55]
    v_cndmask_b32 v192, 0, v192, s[70:71]
    v_cndmask_b32 v193, 0, v193, s[70:71]
    v_mfma_f32_16x16x32_bf16 v[52:55], v[152:155], v[244:247], v[52:55]
    buffer_store_dwordx2 v[192:193], v12, s[4:7], s61 offen sc1
    v_cvt_pk_bf16_f32 v184, v44, v45
    v_mfma_f32_16x16x32_bf16 v[52:55], v[168:171], v[248:251], v[52:55]
    v_cvt_pk_bf16_f32 v185, v46, v47
    v_mfma_f32_16x16x32_bf16 v[52:55], a[4:7], v[252:255], v[52:55]
    v_cvt_pk_bf16_f32 v186, v48, v49
    v_mfma_f32_16x16x32_bf16 v[56:59], v[136:139], v[240:243], v[56:59]
    v_cvt_pk_bf16_f32 v187, v50, v51
    v_mfma_f32_16x16x32_bf16 v[56:59], v[156:159], v[244:247], v[56:59]
    buffer_store_dwordx4 v[184:187], v1, s[4:7], s56 offen offset:0 sc1
    v_mfma_f32_16x16x32_bf16 v[56:59], v[172:175], v[248:251], v[56:59]
    s_nop 1
    v_mfma_f32_16x16x32_bf16 v[56:59], a[8:11], v[252:255], v[56:59]
    v_cvt_pk_bf16_f32 v188, v52, v53
    v_mfma_f32_16x16x32_bf16 v[204:207], v[192:195], v[192:195], 0
    v_cvt_pk_bf16_f32 v189, v54, v55
    v_mfma_f32_16x16x32_bf16 v[200:203], v[196:199], v[192:195], 0
    s_nop 1
    v_mfma_f32_16x16x32_bf16 v[204:207], v[184:187], v[184:187], v[204:207]
    s_nop 1
    v_mfma_f32_16x16x32_bf16 v[200:203], v[196:199], v[184:187], v[200:203]
    v_cvt_pk_bf16_f32 v190, v56, v57
    v_cvt_pk_bf16_f32 v191, v58, v59
    s_nop 1
    v_mfma_f32_16x16x32_bf16 v[204:207], v[188:191], v[188:191], v[204:207]
    buffer_store_dwordx4 v[188:191], v1, s[4:7], s56 offen offset:1024 sc1
    v_mfma_f32_16x16x32_bf16 v[200:203], v[196:199], v[188:191], v[200:203]
    v_mov_b32 v26, s44
    s_nop 4
    v_cndmask_b32 v204, v204, v205, s[82:83]
    v_cndmask_b32 v204, v204, v206, s[84:85]
    v_cndmask_b32 v201, v204, v207, s[86:87]
    buffer_store_dwordx2 v[200:201], v13, s[32:35], s46 offen sc1
    s_barrier
    ds_write_b128 v40, a[144:147] offset:0
    ds_write_b128 v40, a[148:151] offset:1024
    ds_write_b128 v40, a[152:155] offset:2048
    s_waitcnt vmcnt(0)
    buffer_store_dword v26, v23, s[32:35], s49 offen sc1
    s_branch join_51
rr_53:
    s_nop 2
    s_waitcnt vmcnt(0) lgkmcnt(0)
    s_nop 15
    s_branch rb_54
rr_57:
    s_nop 2
    s_waitcnt vmcnt(0) lgkmcnt(0)
    s_nop 15
    s_branch rb_58
slow_61:
    buffer_store_dwordx4 v[28:31], v14, s[32:35], s47 offen sc1
    buffer_store_dwordx4 v[32:35], v14, s[32:35], s47 offen offset:512 sc1
    buffer_store_dwordx2 v[36:37], v15, s[32:35], s47 offen sc1
    s_nop 0
    s_branch join_62
slow_63:
    s_waitcnt vmcnt(0)
    buffer_store_dword v24, v23, s[32:35], s50 offen sc1
    s_branch join_64
slow_66:
    s_waitcnt lgkmcnt(2)
    buffer_store_dwordx4 v[80:83], v20, s[24:27], s54 offen sc1
    s_waitcnt lgkmcnt(1)
    buffer_store_dwordx4 v[84:87], v20, s[24:27], s61 offen sc1
    s_mov_b64 exec, 0x3ffff
    s_waitcnt lgkmcnt(0)
    buffer_store_dwordx4 v[88:91], v20, s[24:27], s62 offen sc1
    s_nop 1
    s_branch join_67
.section .rodata,"a"
.p2align 6
.amdhsa_kernel interleave_layers__linear_attn_block__sliding_block__prompt_kernel
  .amdhsa_next_free_vgpr 512
  .amdhsa_next_free_sgpr 102
  .amdhsa_accum_offset 256
  .amdhsa_group_segment_fixed_size 0
  .amdhsa_kernarg_size 72
  .amdhsa_user_sgpr_count 2
  .amdhsa_user_sgpr_kernarg_segment_ptr 1
  .amdhsa_system_sgpr_workgroup_id_x 1
.end_amdhsa_kernel
```
